```python
import torch

def _softmax(x, axis=-1):
    return torch.softmax(x, dim=axis)

def _gelu(x):
    return torch.nn.functional.gelu(x, approximate='tanh')

def _silu(x):
    return torch.nn.functional.silu(x)

def _sigmoid(x):
    return torch.sigmoid(x)

def _layernorm(x, axis=-1, eps=1e-05):
    m = x.mean(dim=axis, keepdim=True)
    v = x.var(dim=axis, keepdim=True, unbiased=False)
    return (x - m) / torch.sqrt(v + eps)

def _scatter_add(tgt, idx, src, axis=0):
    return tgt.clone().index_add_(axis, idx, src)

def _segment_sum(src, seg, n):
    out = torch.zeros((n,) + src.shape[1:], dtype=src.dtype)
    return out.index_add_(0, seg, src)

def _pad(x, pw):
    flat = tuple((v for pair in reversed(pw) for v in pair))
    return torch.nn.functional.pad(x, flat)
kernel_name = 'adaLN_cond__sliding_block_cached__mixer_s_mlp__prompt'

def setup_inputs():

    _w = lambda a: (lambda t: t.to(torch.bfloat16) if t.is_floating_point() else t)(torch.as_tensor(a))

    def _A_setup():
        B, Sq, D = (1, 2048, 512)
        Hq, Hkv, Sk, Dh = (32, 8, 2048, 128)
        assert Hq % Hkv == 0, (Hq, Hkv)
        return {'x': _w((lambda *s: torch.randn(*s, dtype=torch.bfloat16) * 0.05)(B, Sq, D)), 'k_cache': _w((lambda *s: torch.randn(*s, dtype=torch.bfloat16) * 3.2)(B, Hkv, Sk, Dh)), 'v_cache': _w((lambda *s: torch.randn(*s, dtype=torch.bfloat16) * 0.4)(B, Hkv, Sk, Dh)), 'wq': _w((lambda *s: torch.randn(*s, dtype=torch.bfloat16) * 3.2)(D, Hq * Dh) * D ** (-0.5)), 'wo': _w((lambda *s: torch.randn(*s, dtype=torch.bfloat16) * 0.4)(Hq * Dh, D) * (Hq * Dh) ** (-0.5))}
    _A_in = _A_setup()

    def _B_setup():
        B, S, D, F = (1, 2048, 512, 1792)
        return {'x': _w((lambda *s: torch.randn(*s, dtype=torch.bfloat16) * 0.05)(B, S, D)), 'w1': _w((lambda *s: torch.randn(*s, dtype=torch.bfloat16) * 3.2)(D, D) * D ** (-0.5)), 'w2': _w((lambda *s: torch.randn(*s, dtype=torch.bfloat16) * 3.2)(D, D) * D ** (-0.5)), 'w3': _w((lambda *s: torch.randn(*s, dtype=torch.bfloat16) * 3.2)(D, F) * D ** (-0.5)), 'w4': _w((lambda *s: torch.randn(*s, dtype=torch.bfloat16) * 3.2)(F, D) * F ** (-0.5))}
    _B_in = _B_setup()
    return {'A_x': _A_in['x'], 'A_k_cache': _A_in['k_cache'], 'A_v_cache': _A_in['v_cache'], 'A_wq': _A_in['wq'], 'A_wo': _A_in['wo'], 'B_x': _B_in['x'], 'B_w1': _B_in['w1'], 'B_w2': _B_in['w2'], 'B_w3': _B_in['w3'], 'B_w4': _B_in['w4'], 'c': _w((lambda *s: torch.randn(*s, dtype=torch.bfloat16) * 0.1)(1, 512) * 8.0), 'w_mod': _w((lambda *s: torch.randn(*s, dtype=torch.bfloat16) * 0.1)(512, 6 * 512) * 512 ** (-0.5) * 8.0)}

def reference(A_x, A_k_cache, A_v_cache, A_wq, A_wo, B_x, B_w1, B_w2, B_w3, B_w4, c, w_mod):

    def _A_ref(x, k_cache, v_cache, wq, wo):
        B, Sq, D = x.shape
        Hq, Dh = (32, 128)
        Hkv, Sk = (k_cache.shape[1], k_cache.shape[2])
        W = min(4096, max(256, Sk // 4))
        rep = Hq // Hkv
        q = (lambda x, *d: x.permute(*d))((x @ wq).reshape(B, Sq, Hq, Dh), 0, 2, 1, 3)
        k = (lambda x, n, axis: torch.repeat_interleave(x, n, dim=axis))(k_cache[:, :, Sk - W:, :], rep, axis=1)
        v = (lambda x, n, axis: torch.repeat_interleave(x, n, dim=axis))(v_cache[:, :, Sk - W:, :], rep, axis=1)
        scores = torch.einsum('bhqd,bhkd->bhqk', q, k) * Dh ** (-0.5)
        p = _softmax(scores, axis=-1)
        o = torch.einsum('bhqk,bhkd->bhqd', p, v)
        return (lambda x, *d: x.permute(*d))(o, 0, 2, 1, 3).reshape(B, Sq, Hq * Dh) @ wo

    def _B_ref(x, w1, w2, w3, w4):
        B, S, D = x.shape
        h = _gelu(_layernorm(x, axis=-1) @ w1)
        c = D // 4
        g0 = _pad(h[:, :, 0 * c:1 * c], ((0, 0), (1, 0), (0, 0)))[:, :S, :]
        g1 = _pad(h[:, :, 1 * c:2 * c], ((0, 0), (0, 1), (0, 0)))[:, 1:, :]
        g2 = _pad(h[:, :, 2 * c:3 * c], ((0, 0), (2, 0), (0, 0)))[:, :S, :]
        g3 = _pad(h[:, :, 3 * c:], ((0, 0), (0, 2), (0, 0)))[:, 2:, :]
        hs = torch.concatenate([g0, g1, g2, g3], axis=-1) @ w2
        x1 = x + hs
        h2 = _gelu(_layernorm(x1, axis=-1) @ w3) @ w4
        return x1 + h2
    x = A_x
    mod = (_silu(c) @ w_mod).reshape(c.shape[0], 6, 1, -1)
    sa, ca, ga, sb, cb, gb = (mod[:, 0].clone(), mod[:, 1].clone(), mod[:, 2].clone(), mod[:, 3].clone(), mod[:, 4].clone(), mod[:, 5].clone())
    h = _layernorm(x, axis=-1) * (1 + ca) + sa
    x = x + ga * _A_ref(h, A_k_cache, A_v_cache, A_wq, A_wo)
    h = _layernorm(x, axis=-1) * (1 + cb) + sb
    x = x + gb * _B_ref(h, B_w1, B_w2, B_w3, B_w4)
    return x
```

```asm
; @launch kernel=k0_kernel grid=(240,1,1) block=(512,1,1) lds=32768
; @launch kernel=k1_kernel grid=(256,1,1) block=(512,1,1) lds=163840
; @launch kernel=k2_kernel grid=(256,1,1) block=(512,1,1) lds=18432
; @launch kernel=k3_kernel grid=(256,1,1) block=(256,1,1) lds=65536
; @launch kernel=k4_kernel grid=(224,1,1) block=(512,1,1) lds=133632
; @launch kernel=k5_kernel grid=(256,1,1) block=(512,1,1) lds=163840
.amdgcn_target "amdgcn-amd-amdhsa--gfx950"
.text
.p2align 12
TBASE:
.fill (1280 - (. - TBASE))/4, 4, 0xBF810000
.globl k0_kernel
.p2align 8
.type k0_kernel,@function
k0_kernel:
    s_cmp_ge_u32 s2, 240
    s_cbranch_scc1 K0_end
    s_load_dwordx2 s[4:5], s[0:1], 0
    s_load_dwordx4 s[8:11], s[0:1], 80
    s_load_dwordx2 s[12:13], s[0:1], 48
    s_load_dwordx2 s[14:15], s[0:1], 64
    s_load_dwordx2 s[16:17], s[0:1], 112
    s_load_dwordx2 s[58:59], s[0:1], 16
    v_lshrrev_b32 v3, 6, v0
    v_and_b32 v9, 63, v0
    v_readfirstlane_b32 s54, v3
    s_cmp_lt_u32 s2, 32
    s_cbranch_scc1 K0_g
    s_cmp_ge_u32 s2, 160
    s_cbranch_scc1 K0_g
    s_cmp_ge_u32 s54, 4
    s_cbranch_scc1 K0_s
    s_sub_u32 s29, s2, 32
    v_lshrrev_b32 v7, 3, v9
    v_and_b32 v4, 7, v9
    v_lshlrev_b32 v5, 10, v7
    v_lshl_add_u32 v5, v4, 4, v5
    s_lshr_b32 s30, s54, 1
    s_and_b32 s31, s54, 1
    s_lshl_b32 s44, s29, 14
    s_lshl_b32 s45, s30, 13
    s_add_u32 s44, s44, s45
    s_lshl_b32 s45, s31, 9
    s_add_u32 s46, s44, s45
    s_xor_b32 s45, s45, 512
    s_add_u32 s47, s44, s45
    s_waitcnt lgkmcnt(0)
    s_mov_b32 s32, s4
    s_mov_b32 s33, s5
    s_mov_b32 s34, 0x200000
    s_mov_b32 s35, 0x00020000
    buffer_load_dwordx4 v[32:35], v5, s[32:35], s46 offen offset:0
    buffer_load_dwordx4 v[36:39], v5, s[32:35], s46 offen offset:128
    buffer_load_dwordx4 v[40:43], v5, s[32:35], s46 offen offset:256
    buffer_load_dwordx4 v[44:47], v5, s[32:35], s46 offen offset:384
    buffer_load_dwordx4 v[48:51], v5, s[32:35], s47 offen offset:0
    buffer_load_dwordx4 v[52:55], v5, s[32:35], s47 offen offset:128
    buffer_load_dwordx4 v[56:59], v5, s[32:35], s47 offen offset:256
    buffer_load_dwordx4 v[60:63], v5, s[32:35], s47 offen offset:384
    s_mov_b32 s40, s16
    s_mov_b32 s41, s17
    s_mov_b32 s42, 0x10000000
    s_mov_b32 s43, 0x00020000
    v_lshrrev_b32 v10, 1, v4
    v_lshlrev_b32 v10, 10, v10
    v_and_b32 v11, 1, v4
    v_lshl_add_u32 v10, v11, 9, v10
    v_lshl_add_u32 v10, v7, 4, v10
    s_and_b32 s44, s29, 1
    s_lshl_b32 s44, s44, 8
    s_lshl_b32 s45, s30, 7
    s_add_u32 s44, s44, s45
    s_lshr_b32 s45, s29, 1
    s_lshl_b32 s45, s45, 15
    s_add_u32 s44, s44, s45
    s_lshl_b32 s45, s31, 14
    s_add_u32 s44, s44, s45
    s_mov_b32 s47, 0x3f803f80
    s_mov_b32 s46, 0xffff0000
    v_mov_b32 v12, 0x3f80
    v_mov_b32 v13, 0x3f800000
    v_mov_b32 v30, 0
    v_mov_b32 v31, 0
    v_mov_b32 v28, 0
    v_mov_b32 v29, 0
    s_waitcnt vmcnt(7)
    v_dot2_f32_bf16 v30, v32, s47, v30
    v_dot2_f32_bf16 v31, v32, v32, v31
    v_dot2_f32_bf16 v28, v33, s47, v28
    v_dot2_f32_bf16 v29, v33, v33, v29
    v_dot2_f32_bf16 v30, v34, s47, v30
    v_dot2_f32_bf16 v31, v34, v34, v31
    v_dot2_f32_bf16 v28, v35, s47, v28
    v_dot2_f32_bf16 v29, v35, v35, v29
    s_waitcnt vmcnt(6)
    v_dot2_f32_bf16 v30, v36, s47, v30
    v_dot2_f32_bf16 v31, v36, v36, v31
    v_dot2_f32_bf16 v28, v37, s47, v28
    v_dot2_f32_bf16 v29, v37, v37, v29
    v_dot2_f32_bf16 v30, v38, s47, v30
    v_dot2_f32_bf16 v31, v38, v38, v31
    v_dot2_f32_bf16 v28, v39, s47, v28
    v_dot2_f32_bf16 v29, v39, v39, v29
    s_waitcnt vmcnt(5)
    v_dot2_f32_bf16 v30, v40, s47, v30
    v_dot2_f32_bf16 v31, v40, v40, v31
    v_dot2_f32_bf16 v28, v41, s47, v28
    v_dot2_f32_bf16 v29, v41, v41, v29
    v_dot2_f32_bf16 v30, v42, s47, v30
    v_dot2_f32_bf16 v31, v42, v42, v31
    v_dot2_f32_bf16 v28, v43, s47, v28
    v_dot2_f32_bf16 v29, v43, v43, v29
    s_waitcnt vmcnt(4)
    v_dot2_f32_bf16 v30, v44, s47, v30
    v_dot2_f32_bf16 v31, v44, v44, v31
    v_dot2_f32_bf16 v28, v45, s47, v28
    v_dot2_f32_bf16 v29, v45, v45, v29
    v_dot2_f32_bf16 v30, v46, s47, v30
    v_dot2_f32_bf16 v31, v46, v46, v31
    v_dot2_f32_bf16 v28, v47, s47, v28
    v_dot2_f32_bf16 v29, v47, v47, v29
    s_waitcnt vmcnt(3)
    v_dot2_f32_bf16 v30, v48, s47, v30
    v_dot2_f32_bf16 v31, v48, v48, v31
    v_dot2_f32_bf16 v28, v49, s47, v28
    v_dot2_f32_bf16 v29, v49, v49, v29
    v_dot2_f32_bf16 v30, v50, s47, v30
    v_dot2_f32_bf16 v31, v50, v50, v31
    v_dot2_f32_bf16 v28, v51, s47, v28
    v_dot2_f32_bf16 v29, v51, v51, v29
    s_waitcnt vmcnt(2)
    v_dot2_f32_bf16 v30, v52, s47, v30
    v_dot2_f32_bf16 v31, v52, v52, v31
    v_dot2_f32_bf16 v28, v53, s47, v28
    v_dot2_f32_bf16 v29, v53, v53, v29
    v_dot2_f32_bf16 v30, v54, s47, v30
    v_dot2_f32_bf16 v31, v54, v54, v31
    v_dot2_f32_bf16 v28, v55, s47, v28
    v_dot2_f32_bf16 v29, v55, v55, v29
    s_waitcnt vmcnt(1)
    v_dot2_f32_bf16 v30, v56, s47, v30
    v_dot2_f32_bf16 v31, v56, v56, v31
    v_dot2_f32_bf16 v28, v57, s47, v28
    v_dot2_f32_bf16 v29, v57, v57, v29
    v_dot2_f32_bf16 v30, v58, s47, v30
    v_dot2_f32_bf16 v31, v58, v58, v31
    v_dot2_f32_bf16 v28, v59, s47, v28
    v_dot2_f32_bf16 v29, v59, v59, v29
    s_waitcnt vmcnt(0)
    v_dot2_f32_bf16 v30, v60, s47, v30
    v_dot2_f32_bf16 v31, v60, v60, v31
    v_dot2_f32_bf16 v28, v61, s47, v28
    v_dot2_f32_bf16 v29, v61, v61, v29
    v_dot2_f32_bf16 v30, v62, s47, v30
    v_dot2_f32_bf16 v31, v62, v62, v31
    v_dot2_f32_bf16 v28, v63, s47, v28
    v_dot2_f32_bf16 v29, v63, v63, v29
    s_nop 2
    v_add_f32 v30, v30, v28
    v_add_f32 v31, v31, v29
    s_nop 0
    v_add_f32_dpp v28, v30, v30 quad_perm:[1,0,3,2] row_mask:0xf bank_mask:0xf
    v_add_f32_dpp v29, v31, v31 quad_perm:[1,0,3,2] row_mask:0xf bank_mask:0xf
    s_nop 0
    v_add_f32_dpp v30, v28, v28 quad_perm:[2,3,0,1] row_mask:0xf bank_mask:0xf
    v_add_f32_dpp v31, v29, v29 quad_perm:[2,3,0,1] row_mask:0xf bank_mask:0xf
    s_nop 0
    v_add_f32_dpp v28, v30, v30 row_half_mirror row_mask:0xf bank_mask:0xf
    v_add_f32_dpp v29, v31, v31 row_half_mirror row_mask:0xf bank_mask:0xf
    v_mul_f32 v30, 0x3b000000, v28
    v_mul_f32 v31, 0x3b000000, v29
    v_fma_f32 v31, -v30, v30, v31
    v_max_f32 v31, 0, v31
    v_cvt_pk_bf16_f32 v30, 0, v30
    v_cvt_pk_bf16_f32 v31, 0, v31
    v_add_f32 v31, 0x3727c5ac, v31
    v_cvt_pk_bf16_f32 v31, 0, v31
    v_sqrt_f32 v31, v31
    v_sub_f32 v30, 0, v30
    v_cvt_pk_bf16_f32 v31, 0, v31
    v_rcp_f32 v31, v31
    v_dot2_f32_bf16 v64, v32, v12, v30
    v_dot2_f32_bf16 v65, v32, v13, v30
    v_dot2_f32_bf16 v66, v33, v12, v30
    v_dot2_f32_bf16 v67, v33, v13, v30
    v_dot2_f32_bf16 v68, v34, v12, v30
    v_dot2_f32_bf16 v69, v34, v13, v30
    v_dot2_f32_bf16 v70, v35, v12, v30
    v_dot2_f32_bf16 v71, v35, v13, v30
    s_nop 1
    v_cvt_pk_bf16_f32 v64, 0, v64
    v_cvt_pk_bf16_f32 v65, 0, v65
    v_cvt_pk_bf16_f32 v66, 0, v66
    v_cvt_pk_bf16_f32 v67, 0, v67
    v_cvt_pk_bf16_f32 v68, 0, v68
    v_cvt_pk_bf16_f32 v69, 0, v69
    v_cvt_pk_bf16_f32 v70, 0, v70
    v_cvt_pk_bf16_f32 v71, 0, v71
    v_mul_f32 v64, v64, v31
    v_mul_f32 v65, v65, v31
    v_mul_f32 v66, v66, v31
    v_mul_f32 v67, v67, v31
    v_mul_f32 v68, v68, v31
    v_mul_f32 v69, v69, v31
    v_mul_f32 v70, v70, v31
    v_mul_f32 v71, v71, v31
    v_cvt_pk_bf16_f32 v80, v64, v65
    v_cvt_pk_bf16_f32 v81, v66, v67
    v_cvt_pk_bf16_f32 v82, v68, v69
    v_cvt_pk_bf16_f32 v83, v70, v71
    buffer_store_dwordx4 v[80:83], v10, s[40:43], s44 offen sc0 sc1
    s_add_u32 s44, s44, 4096
    v_dot2_f32_bf16 v64, v36, v12, v30
    v_dot2_f32_bf16 v65, v36, v13, v30
    v_dot2_f32_bf16 v66, v37, v12, v30
    v_dot2_f32_bf16 v67, v37, v13, v30
    v_dot2_f32_bf16 v68, v38, v12, v30
    v_dot2_f32_bf16 v69, v38, v13, v30
    v_dot2_f32_bf16 v70, v39, v12, v30
    v_dot2_f32_bf16 v71, v39, v13, v30
    s_nop 1
    v_cvt_pk_bf16_f32 v64, 0, v64
    v_cvt_pk_bf16_f32 v65, 0, v65
    v_cvt_pk_bf16_f32 v66, 0, v66
    v_cvt_pk_bf16_f32 v67, 0, v67
    v_cvt_pk_bf16_f32 v68, 0, v68
    v_cvt_pk_bf16_f32 v69, 0, v69
    v_cvt_pk_bf16_f32 v70, 0, v70
    v_cvt_pk_bf16_f32 v71, 0, v71
    v_mul_f32 v64, v64, v31
    v_mul_f32 v65, v65, v31
    v_mul_f32 v66, v66, v31
    v_mul_f32 v67, v67, v31
    v_mul_f32 v68, v68, v31
    v_mul_f32 v69, v69, v31
    v_mul_f32 v70, v70, v31
    v_mul_f32 v71, v71, v31
    v_cvt_pk_bf16_f32 v84, v64, v65
    v_cvt_pk_bf16_f32 v85, v66, v67
    v_cvt_pk_bf16_f32 v86, v68, v69
    v_cvt_pk_bf16_f32 v87, v70, v71
    buffer_store_dwordx4 v[84:87], v10, s[40:43], s44 offen sc0 sc1
    s_add_u32 s44, s44, 4096
    v_dot2_f32_bf16 v64, v40, v12, v30
    v_dot2_f32_bf16 v65, v40, v13, v30
    v_dot2_f32_bf16 v66, v41, v12, v30
    v_dot2_f32_bf16 v67, v41, v13, v30
    v_dot2_f32_bf16 v68, v42, v12, v30
    v_dot2_f32_bf16 v69, v42, v13, v30
    v_dot2_f32_bf16 v70, v43, v12, v30
    v_dot2_f32_bf16 v71, v43, v13, v30
    s_nop 1
    v_cvt_pk_bf16_f32 v64, 0, v64
    v_cvt_pk_bf16_f32 v65, 0, v65
    v_cvt_pk_bf16_f32 v66, 0, v66
    v_cvt_pk_bf16_f32 v67, 0, v67
    v_cvt_pk_bf16_f32 v68, 0, v68
    v_cvt_pk_bf16_f32 v69, 0, v69
    v_cvt_pk_bf16_f32 v70, 0, v70
    v_cvt_pk_bf16_f32 v71, 0, v71
    v_mul_f32 v64, v64, v31
    v_mul_f32 v65, v65, v31
    v_mul_f32 v66, v66, v31
    v_mul_f32 v67, v67, v31
    v_mul_f32 v68, v68, v31
    v_mul_f32 v69, v69, v31
    v_mul_f32 v70, v70, v31
    v_mul_f32 v71, v71, v31
    v_cvt_pk_bf16_f32 v88, v64, v65
    v_cvt_pk_bf16_f32 v89, v66, v67
    v_cvt_pk_bf16_f32 v90, v68, v69
    v_cvt_pk_bf16_f32 v91, v70, v71
    buffer_store_dwordx4 v[88:91], v10, s[40:43], s44 offen sc0 sc1
    s_add_u32 s44, s44, 4096
    v_dot2_f32_bf16 v64, v44, v12, v30
    v_dot2_f32_bf16 v65, v44, v13, v30
    v_dot2_f32_bf16 v66, v45, v12, v30
    v_dot2_f32_bf16 v67, v45, v13, v30
    v_dot2_f32_bf16 v68, v46, v12, v30
    v_dot2_f32_bf16 v69, v46, v13, v30
    v_dot2_f32_bf16 v70, v47, v12, v30
    v_dot2_f32_bf16 v71, v47, v13, v30
    s_nop 1
    v_cvt_pk_bf16_f32 v64, 0, v64
    v_cvt_pk_bf16_f32 v65, 0, v65
    v_cvt_pk_bf16_f32 v66, 0, v66
    v_cvt_pk_bf16_f32 v67, 0, v67
    v_cvt_pk_bf16_f32 v68, 0, v68
    v_cvt_pk_bf16_f32 v69, 0, v69
    v_cvt_pk_bf16_f32 v70, 0, v70
    v_cvt_pk_bf16_f32 v71, 0, v71
    v_mul_f32 v64, v64, v31
    v_mul_f32 v65, v65, v31
    v_mul_f32 v66, v66, v31
    v_mul_f32 v67, v67, v31
    v_mul_f32 v68, v68, v31
    v_mul_f32 v69, v69, v31
    v_mul_f32 v70, v70, v31
    v_mul_f32 v71, v71, v31
    v_cvt_pk_bf16_f32 v92, v64, v65
    v_cvt_pk_bf16_f32 v93, v66, v67
    v_cvt_pk_bf16_f32 v94, v68, v69
    v_cvt_pk_bf16_f32 v95, v70, v71
    buffer_store_dwordx4 v[92:95], v10, s[40:43], s44 offen sc0 sc1
    s_endpgm
K0_g:
    s_sub_u32 s29, s2, 128
    s_cmp_lt_u32 s2, 32
    s_cselect_b32 s29, s2, s29
    s_and_b32 s31, s29, 3
    s_lshr_b32 s29, s29, 2
    v_and_b32 v1, 15, v0
    v_lshrrev_b32 v2, 4, v0
    v_lshlrev_b32 v6, 3, v2
    s_lshl_b32 s26, s31, 8
    s_mul_i32 s28, s31, 21504
    s_lshl_b32 s30, s29, 9
    s_add_u32 s28, s28, s30
    s_add_u32 s28, s28, 0x240000
    s_waitcnt lgkmcnt(0)
    s_mov_b32 s36, s8
    s_mov_b32 s37, s9
    s_mov_b32 s38, 0x400
    s_mov_b32 s39, 0x00020000
    buffer_load_dwordx2 v[10:11], v6, s[36:39], s26 offen
    s_mov_b32 s20, s10
    s_mov_b32 s21, s11
    s_mov_b32 s22, 3145728
    s_movk_i32 s24, 6144
    s_mov_b32 s25, s29
    s_cmp_ge_u32 s29, 24
    s_cselect_b32 s20, s12, s20
    s_cselect_b32 s21, s13, s21
    s_cselect_b32 s22, 524288, s22
    s_cselect_b32 s24, 1024, s24
    s_cselect_b32 s30, 24, 0
    s_cmp_ge_u32 s29, 28
    s_cselect_b32 s20, s14, s20
    s_cselect_b32 s21, s15, s21
    s_cselect_b32 s22, 1835008, s22
    s_cselect_b32 s24, 3584, s24
    s_cselect_b32 s30, 28, s30
    s_sub_u32 s25, s25, s30
    s_lshl_b32 s25, s25, 8
    s_lshl_b32 s30, s31, 7
    s_mul_i32 s30, s30, s24
    s_add_u32 s25, s25, s30
    s_mov_b32 s23, 0x00020000
    s_lshl_b32 s30, s24, 2
    v_mul_lo_u32 v3, v2, s30
    v_lshl_add_u32 v3, v1, 4, v3
    buffer_load_dwordx4 v[32:35], v3, s[20:23], s25 offen
    s_add_u32 s25, s25, s24
    buffer_load_dwordx4 v[36:39], v3, s[20:23], s25 offen
    s_add_u32 s25, s25, s24
    buffer_load_dwordx4 v[40:43], v3, s[20:23], s25 offen
    s_add_u32 s25, s25, s24
    buffer_load_dwordx4 v[44:47], v3, s[20:23], s25 offen
    s_mov_b32 s40, s16
    s_mov_b32 s41, s17
    s_mov_b32 s42, 0x10000000
    s_mov_b32 s43, 0x00020000
    s_mov_b32 s45, 0x3fb8aa3b
    s_mov_b32 s46, 0xffff0000
    s_mov_b32 s62, 0x05040100
    s_mov_b32 s63, 0x07060302
    s_cmp_ge_u32 s29, 24
    s_cselect_b64 s[52:53], -1, 0
    v_mov_b32 v24, 0x3f803f80
    v_mov_b32 v16, 0
    v_mov_b32 v17, 0
    v_mov_b32 v18, 0
    v_mov_b32 v19, 0
    v_mov_b32 v20, 0
    v_mov_b32 v21, 0
    v_mov_b32 v22, 0
    v_mov_b32 v23, 0
    v_lshrrev_b32 v28, 4, v9
    v_lshlrev_b32 v28, 3, v28
    v_lshl_add_u32 v28, v1, 5, v28
    s_lshl_b32 s30, s54, 9
    v_add_u32 v27, s30, v28
    v_lshlrev_b32 v26, 2, v0
    s_waitcnt vmcnt(4)
    v_lshlrev_b32 v12, 16, v10
    v_and_b32 v13, s46, v10
    v_lshlrev_b32 v14, 16, v11
    v_and_b32 v15, s46, v11
    v_mul_f32 v4, s45, v12
    v_mul_f32 v5, s45, v13
    v_mul_f32 v6, s45, v14
    v_mul_f32 v7, s45, v15
    v_exp_f32 v4, -v4
    v_exp_f32 v5, -v5
    v_exp_f32 v6, -v6
    v_exp_f32 v7, -v7
    v_add_f32 v4, 1.0, v4
    v_add_f32 v5, 1.0, v5
    v_add_f32 v6, 1.0, v6
    v_add_f32 v7, 1.0, v7
    v_rcp_f32 v4, v4
    v_rcp_f32 v5, v5
    v_rcp_f32 v6, v6
    v_rcp_f32 v7, v7
    v_mul_f32 v12, v12, v4
    v_mul_f32 v13, v13, v5
    v_mul_f32 v14, v14, v6
    v_mul_f32 v15, v15, v7
    v_cvt_pk_bf16_f32 v10, v12, v13
    v_cvt_pk_bf16_f32 v11, v14, v15
    v_cndmask_b32 v10, v10, v24, s[52:53]
    v_cndmask_b32 v11, v11, v24, s[52:53]
    s_waitcnt vmcnt(2)
    v_perm_b32 v4, v36, v32, s62
    v_perm_b32 v5, v36, v32, s63
    v_dot2_f32_bf16 v16, v4, v10, v16
    v_dot2_f32_bf16 v17, v5, v10, v17
    v_perm_b32 v6, v37, v33, s62
    v_perm_b32 v7, v37, v33, s63
    v_dot2_f32_bf16 v18, v6, v10, v18
    v_dot2_f32_bf16 v19, v7, v10, v19
    v_perm_b32 v4, v38, v34, s62
    v_perm_b32 v5, v38, v34, s63
    v_dot2_f32_bf16 v20, v4, v10, v20
    v_dot2_f32_bf16 v21, v5, v10, v21
    v_perm_b32 v6, v39, v35, s62
    v_perm_b32 v7, v39, v35, s63
    v_dot2_f32_bf16 v22, v6, v10, v22
    v_dot2_f32_bf16 v23, v7, v10, v23
    s_waitcnt vmcnt(0)
    v_perm_b32 v4, v44, v40, s62
    v_perm_b32 v5, v44, v40, s63
    v_dot2_f32_bf16 v16, v4, v11, v16
    v_dot2_f32_bf16 v17, v5, v11, v17
    v_perm_b32 v6, v45, v41, s62
    v_perm_b32 v7, v45, v41, s63
    v_dot2_f32_bf16 v18, v6, v11, v18
    v_dot2_f32_bf16 v19, v7, v11, v19
    v_perm_b32 v4, v46, v42, s62
    v_perm_b32 v5, v46, v42, s63
    v_dot2_f32_bf16 v20, v4, v11, v20
    v_dot2_f32_bf16 v21, v5, v11, v21
    v_perm_b32 v6, v47, v43, s62
    v_perm_b32 v7, v47, v43, s63
    v_dot2_f32_bf16 v22, v6, v11, v22
    v_dot2_f32_bf16 v23, v7, v11, v23
    v_permlane32_swap_b32 v16, v20
    v_permlane32_swap_b32 v17, v21
    v_permlane32_swap_b32 v18, v22
    v_permlane32_swap_b32 v19, v23
    v_add_f32 v16, v16, v20
    v_add_f32 v17, v17, v21
    v_add_f32 v18, v18, v22
    v_add_f32 v19, v19, v23
    s_nop 0
    v_permlane16_swap_b32 v16, v18
    v_permlane16_swap_b32 v17, v19
    v_add_f32 v16, v16, v18
    v_add_f32 v17, v17, v19
    ds_write_b64 v27, v[16:17]
    s_waitcnt lgkmcnt(0)
    s_barrier
    s_cmp_ge_u32 s54, 2
    s_cbranch_scc1 K0_end
    ds_read_b32 v48, v26 offset:0
    ds_read_b32 v49, v26 offset:512
    ds_read_b32 v50, v26 offset:1024
    ds_read_b32 v51, v26 offset:1536
    ds_read_b32 v52, v26 offset:2048
    ds_read_b32 v53, v26 offset:2560
    ds_read_b32 v54, v26 offset:3072
    ds_read_b32 v55, v26 offset:3584
    s_waitcnt lgkmcnt(3)
    v_add_f32 v48, v48, v52
    s_waitcnt lgkmcnt(2)
    v_add_f32 v49, v49, v53
    s_waitcnt lgkmcnt(1)
    v_add_f32 v50, v50, v54
    s_waitcnt lgkmcnt(0)
    v_add_f32 v51, v51, v55
    v_add_f32 v48, v48, v50
    v_add_f32 v49, v49, v51
    v_add_f32 v48, v48, v49
    buffer_store_dword v48, v26, s[40:43], s28 offen
K0_end:
    s_endpgm
K0_s:
    s_lshl_b32 s66, s54, 12
    s_cmp_ge_u32 s54, 6
    s_cbranch_scc1 K0_s1
    s_sub_u32 s29, s2, 32
    s_and_b32 s64, s29, 7
    s_lshr_b32 s65, s29, 3
    s_lshl_b32 s65, s65, 1
    s_and_b32 s63, s54, 1
    s_add_u32 s65, s65, s63
    v_lshlrev_b32 v10, 4, v9
    v_lshrrev_b32 v11, 4, v9
    v_lshlrev_b32 v11, 6, v11
    v_xor_b32 v10, v10, v11
    s_lshl_b32 s62, s64, 19
    s_lshl_b32 s63, s65, 12
    s_add_u32 s62, s62, s63
    s_add_u32 s62, s62, 393216
    s_mov_b32 m0, s66
    s_mov_b32 s55, s66
    s_waitcnt lgkmcnt(0)
    s_mov_b32 s66, s55
    s_mov_b32 s48, s58
    s_mov_b32 s49, s59
    s_mov_b32 s50, 0x400000
    s_mov_b32 s51, 0x00020000
    buffer_load_dwordx4 v10, s[48:51], s62 offen offset:0 lds
    buffer_load_dwordx4 v10, s[48:51], s62 offen offset:1024 lds
    buffer_load_dwordx4 v10, s[48:51], s62 offen offset:2048 lds
    buffer_load_dwordx4 v10, s[48:51], s62 offen offset:3072 lds
    s_mov_b32 s40, s16
    s_mov_b32 s41, s17
    s_mov_b32 s42, 0x10000000
    s_mov_b32 s43, 0x00020000
    v_lshrrev_b32 v11, 5, v9
    v_bfe_u32 v12, v9, 2, 2
    v_lshl_add_u32 v11, v11, 2, v12
    v_lshlrev_b32 v11, 8, v11
    v_bfe_u32 v13, v9, 4, 1
    v_lshl_add_u32 v11, v13, 5, v11
    v_and_b32 v13, 1, v9
    v_lshl_add_u32 v11, v13, 4, v11
    v_bfe_u32 v13, v9, 1, 1
    v_lshl_add_u32 v11, v13, 3, v11
    v_add_u32 v11, s66, v11
    v_lshlrev_b32 v10, 4, v9
    s_lshl_b32 s62, s64, 17
    s_lshl_b32 s63, s65, 12
    s_add_u32 s62, s62, s63
    s_add_u32 s62, s62, 0x300000
    s_waitcnt vmcnt(0)
    v_xor_b32 v13, 0, v12
    v_lshl_add_u32 v13, v13, 6, v11
    ds_read_b64_tr_b16 v[32:33], v13 offset:0
    ds_read_b64_tr_b16 v[34:35], v13 offset:2048
    v_xor_b32 v13, 1, v12
    v_lshl_add_u32 v13, v13, 6, v11
    ds_read_b64_tr_b16 v[36:37], v13 offset:0
    ds_read_b64_tr_b16 v[38:39], v13 offset:2048
    v_xor_b32 v13, 2, v12
    v_lshl_add_u32 v13, v13, 6, v11
    ds_read_b64_tr_b16 v[40:41], v13 offset:0
    ds_read_b64_tr_b16 v[42:43], v13 offset:2048
    v_xor_b32 v13, 3, v12
    v_lshl_add_u32 v13, v13, 6, v11
    ds_read_b64_tr_b16 v[44:45], v13 offset:0
    ds_read_b64_tr_b16 v[46:47], v13 offset:2048
    s_waitcnt lgkmcnt(6)
    buffer_store_dwordx4 v[32:35], v10, s[40:43], s62 offen offset:0 sc0 sc1
    s_waitcnt lgkmcnt(4)
    buffer_store_dwordx4 v[36:39], v10, s[40:43], s62 offen offset:1024 sc0 sc1
    s_waitcnt lgkmcnt(2)
    buffer_store_dwordx4 v[40:43], v10, s[40:43], s62 offen offset:2048 sc0 sc1
    s_waitcnt lgkmcnt(0)
    buffer_store_dwordx4 v[44:47], v10, s[40:43], s62 offen offset:3072 sc0 sc1
    s_endpgm
K0_s1:
    s_sub_u32 s29, s2, 32
    s_lshl_b32 s29, s29, 1
    s_and_b32 s63, s54, 1
    s_add_u32 s29, s29, s63
    v_lshrrev_b32 v10, 2, v9
    v_lshlrev_b32 v10, 10, v10
    v_and_b32 v11, 3, v9
    v_lshl_add_u32 v10, v11, 4, v10
    s_lshr_b32 s62, s29, 4
    s_lshl_b32 s62, s62, 15
    s_and_b32 s63, s29, 15
    s_lshl_b32 s63, s63, 6
    s_add_u32 s62, s62, s63
    s_mov_b32 m0, s66
    s_mov_b32 s55, s66
    s_waitcnt lgkmcnt(0)
    s_mov_b32 s66, s55
    s_mov_b32 s48, s12
    s_mov_b32 s49, s13
    s_mov_b32 s50, 0x80000
    s_mov_b32 s51, 0x00020000
    buffer_load_dwordx4 v10, s[48:51], s62 offen lds
    s_add_u32 s62, s62, 16384
    s_add_u32 s63, s66, 1024
    s_mov_b32 m0, s63
    s_nop 0
    buffer_load_dwordx4 v10, s[48:51], s62 offen lds
    s_mov_b32 s40, s16
    s_mov_b32 s41, s17
    s_mov_b32 s42, 0x10000000
    s_mov_b32 s43, 0x00020000
    v_bfe_u32 v11, v9, 4, 1
    v_lshlrev_b32 v11, 4, v11
    v_lshrrev_b32 v12, 5, v9
    v_lshl_add_u32 v11, v12, 3, v11
    v_bfe_u32 v12, v9, 2, 2
    v_add_u32 v11, v11, v12
    v_lshlrev_b32 v11, 6, v11
    v_and_b32 v12, 3, v9
    v_lshl_add_u32 v11, v12, 4, v11
    v_add_u32 v11, s66, v11
    v_lshlrev_b32 v10, 4, v9
    s_and_b32 s62, s29, 15
    s_lshl_b32 s62, s62, 15
    s_lshr_b32 s63, s29, 4
    s_lshl_b32 s63, s63, 10
    s_add_u32 s62, s62, s63
    s_add_u32 s62, s62, 0x280000
    s_waitcnt vmcnt(0)
    ds_read_b64_tr_b16 v[32:33], v11 offset:0
    ds_read_b64_tr_b16 v[34:35], v11 offset:256
    ds_read_b64_tr_b16 v[36:37], v11 offset:8
    ds_read_b64_tr_b16 v[38:39], v11 offset:264
    s_waitcnt lgkmcnt(2)
    buffer_store_dwordx4 v[32:35], v10, s[40:43], s62 offen sc0 sc1
    s_add_u32 s62, s62, 16384
    s_waitcnt lgkmcnt(0)
    buffer_store_dwordx4 v[36:39], v10, s[40:43], s62 offen sc0 sc1
    s_endpgm
.fill (5120 - (. - TBASE))/4, 4, 0xBF810000
.globl k1_kernel
.p2align 8
.type k1_kernel,@function
k1_kernel:
    s_cmp_ge_u32 s2, 256
    s_cbranch_scc1 K1_end
    s_load_dwordx2 s[16:17], s[0:1], 112
    s_load_dwordx2 s[8:9], s[0:1], 24
    s_load_dwordx2 s[4:5], s[0:1], 8
    s_load_dwordx2 s[12:13], s[0:1], 32
    v_and_b32 v21, 63, v0
    v_lshrrev_b32 v18, 6, v0
    v_lshlrev_b32 v27, 4, v21
    v_readfirstlane_b32 s24, v18
    s_and_b32 s25, s2, 4
    s_bfe_u32 s34, s2, 0x20003
    s_or_b32 s25, s25, s34
    s_and_b32 s26, s2, 3
    s_lshl_b32 s26, s26, 3
    s_lshr_b32 s34, s2, 5
    s_add_u32 s26, s26, s34
    v_bfe_u32 v22, v21, 3, 2
    v_lshrrev_b32 v23, 5, v21
    v_lshl_add_u32 v22, v23, 3, v22
    v_and_b32 v23, 7, v21
    v_bfe_u32 v24, v21, 4, 2
    v_lshlrev_b32 v24, 1, v24
    v_xor_b32 v23, v23, v24
    v_lshlrev_b32 v23, 4, v23
    v_lshl_add_u32 v1, v22, 13, v23
    v_lshl_add_u32 v2, v22, 10, v23
    v_lshrrev_b32 v18, 5, v21
    v_lshrrev_b32 v19, 4, v21
    v_lshlrev_b32 v20, 9, v19
    v_and_b32 v25, 7, v21
    v_lshl_add_u32 v20, v25, 3, v20
    v_bfe_u32 v25, v21, 3, 1
    v_xor_b32 v26, 1, v25
    v_lshl_add_u32 v20, v26, 11, v20
    s_mov_b32 s18, 0x10000000
    s_mov_b32 s19, 0x00020000
    s_mov_b32 s10, 0x400000
    s_mov_b32 s11, 0x00020000
    s_mov_b32 s6, 0x400000
    s_mov_b32 s7, 0x00020000
    s_mov_b32 s14, 0x400000
    s_mov_b32 s15, 0x00020000
    s_lshr_b32 s27, s24, 1
    s_and_b32 s28, s24, 1
    s_lshl_b32 s29, s24, 12
    s_lshl_b32 s34, s24, 7
    s_lshl_b32 s30, s25, 10
    s_add_u32 s30, s30, s34
    s_lshl_b32 s31, s25, 19
    s_add_u32 s32, s31, s34
    s_add_u32 s31, s31, s29
    s_add_u32 s31, s31, 393216
    s_lshl_b32 s33, s25, 17
    s_add_u32 s33, s33, s29
    s_add_u32 s33, s33, 0x300000
    s_lshr_b32 s34, s34, 1
    s_add_u32 s34, s34, 0x240000
    s_lshl_b32 s35, s26, 16
    s_lshl_b32 s3, s24, 10
    s_add_u32 s35, s35, s3
    s_add_u32 s3, s3, 98304
    v_add_u32 v17, s3, v27
    s_waitcnt lgkmcnt(0)
    s_setprio 3
    buffer_load_dwordx2 v[82:83], v20, s[16:19], s34 offen
    s_add_u32 s34, s34, 21504
    buffer_load_dwordx2 v[84:85], v20, s[16:19], s34 offen
    s_add_u32 s34, s34, 21504
    buffer_load_dwordx2 v[86:87], v20, s[16:19], s34 offen
    s_add_u32 s34, s34, 21504
    buffer_load_dwordx2 v[88:89], v20, s[16:19], s34 offen
    s_add_u32 s3, s35, 0
    buffer_load_dwordx4 v[32:35], v27, s[16:19], s3 offen
    s_add_u32 s3, s35, 32768
    buffer_load_dwordx4 v[36:39], v27, s[16:19], s3 offen
    s_setprio 2
    s_add_u32 s3, s35, 8192
    buffer_load_dwordx4 v[40:43], v27, s[16:19], s3 offen
    s_add_u32 s3, s35, 40960
    buffer_load_dwordx4 v[44:47], v27, s[16:19], s3 offen
    s_add_u32 s3, s35, 16384
    buffer_load_dwordx4 v[48:51], v27, s[16:19], s3 offen
    s_add_u32 s3, s35, 49152
    buffer_load_dwordx4 v[52:55], v27, s[16:19], s3 offen
    s_add_u32 s3, s35, 24576
    buffer_load_dwordx4 v[56:59], v27, s[16:19], s3 offen
    s_add_u32 s3, s35, 57344
    buffer_load_dwordx4 v[60:63], v27, s[16:19], s3 offen
    s_setprio 1
    v_lshrrev_b32 v22, 2, v21
    v_lshlrev_b32 v22, 7, v22
    v_and_b32 v23, 3, v21
    v_lshl_add_u32 v22, v23, 3, v22
    v_add_u32 v22, s29, v22
    v_bfe_u32 v23, v21, 3, 2
    v_xor_b32 v24, 0, v23
    v_lshl_add_u32 v5, v24, 5, v22
    v_xor_b32 v24, 1, v23
    v_lshl_add_u32 v6, v24, 5, v22
    v_xor_b32 v24, 2, v23
    v_lshl_add_u32 v7, v24, 5, v22
    v_xor_b32 v24, 3, v23
    v_lshl_add_u32 v8, v24, 5, v22
    v_and_b32 v24, 31, v21
    v_and_b32 v22, 15, v21
    v_xor_b32 v22, v22, v18
    s_lshl_b32 s3, s28, 3
    v_xor_b32 v22, s3, v22
    v_lshlrev_b32 v24, 8, v24
    v_add_u32 v24, 32768, v24
    v_xor_b32 v23, 0, v22
    v_lshl_add_u32 v9, v23, 4, v24
    v_xor_b32 v23, 2, v22
    v_lshl_add_u32 v10, v23, 4, v24
    v_xor_b32 v23, 4, v22
    v_lshl_add_u32 v11, v23, 4, v24
    v_xor_b32 v23, 6, v22
    v_lshl_add_u32 v12, v23, 4, v24
    v_xor_b32 v23, 8, v22
    v_lshl_add_u32 v13, v23, 4, v24
    v_xor_b32 v23, 10, v22
    v_lshl_add_u32 v14, v23, 4, v24
    v_xor_b32 v23, 12, v22
    v_lshl_add_u32 v15, v23, 4, v24
    v_xor_b32 v23, 14, v22
    v_lshl_add_u32 v16, v23, 4, v24
    v_lshrrev_b32 v24, 4, v21
    v_and_b32 v22, 15, v21
    v_xor_b32 v22, v22, v24
    v_lshlrev_b32 v24, 8, v24
    v_xor_b32 v23, 0, v22
    v_lshl_add_u32 v28, v23, 4, v24
    v_xor_b32 v23, 4, v22
    v_lshl_add_u32 v29, v23, 4, v24
    v_xor_b32 v23, 8, v22
    v_lshl_add_u32 v30, v23, 4, v24
    v_xor_b32 v23, 12, v22
    v_lshl_add_u32 v31, v23, 4, v24
    s_lshl_b32 s3, s28, 14
    s_add_u32 s3, s3, 98304
    v_and_b32 v22, 15, v21
    v_lshlrev_b32 v22, 4, v22
    v_lshrrev_b32 v23, 4, v21
    v_lshl_add_u32 v22, v23, 9, v22
    v_add_u32 v3, s3, v22
    v_xor_b32 v4, 0x4000, v3
    v_mov_b32 v80, 0x3f80
    v_mov_b32 v81, 0x3f800000
    v_and_b32 v94, 0x70, v27
    v_lshlrev_b32 v94, 3, v94
    s_lshl_b32 s44, s26, 16
    s_lshl_b32 s45, s24, 13
    s_add_u32 s44, s44, s45
    s_lshl_b32 s45, s25, 10
    s_add_u32 s44, s44, s45
    buffer_load_dword v94, v94, s[8:11], s44 offen
    v_cvt_f32_u32 v26, v26
    v_cmp_eq_u32 vcc, 0, v21
    v_lshrrev_b32 v25, 3, v21
    v_and_b32 v25, 1, v25
    v_cmp_eq_u32 vcc, 0, v25
    s_nop 1
    v_cndmask_b32 v25, 0, 16, vcc
    s_lshl_b32 s3, s24, 10
    s_add_u32 s3, s3, 122880
    v_lshl_add_u32 v24, v21, 3, s3
    v_lshl_add_u32 v23, v18, 5, s3
    s_waitcnt vmcnt(11)
    v_add_f32 v82, v82, v84
    s_waitcnt vmcnt(9)
    v_add_f32 v86, v86, v88
    v_add_f32 v83, v83, v85
    v_add_f32 v87, v87, v89
    v_add_f32 v82, v82, v86
    v_add_f32 v83, v83, v87
    v_cvt_pk_bf16_f32 v82, 0, v82
    v_cvt_pk_bf16_f32 v83, 0, v83
    v_add_f32 v82, v82, v26
    v_add_f32 v83, v83, v26
    v_cvt_pk_bf16_f32 v82, 0, v82
    v_cvt_pk_bf16_f32 v83, 0, v83
    v_lshrrev_b32 v82, v25, v82
    ds_write_b64 v24, v[82:83]
    ds_read_b128 v[96:99], v23 offset:0
    ds_read_b128 v[100:103], v23 offset:16
    ds_read_b128 v[104:107], v23 offset:64
    ds_read_b128 v[108:111], v23 offset:80
    ds_read_b128 v[112:115], v23 offset:128
    ds_read_b128 v[116:119], v23 offset:144
    ds_read_b128 v[120:123], v23 offset:192
    ds_read_b128 v[124:127], v23 offset:208
    ds_read_b128 v[128:131], v23 offset:256
    ds_read_b128 v[132:135], v23 offset:272
    ds_read_b128 v[136:139], v23 offset:320
    ds_read_b128 v[140:143], v23 offset:336
    ds_read_b128 v[144:147], v23 offset:384
    ds_read_b128 v[148:151], v23 offset:400
    ds_read_b128 v[152:155], v23 offset:448
    ds_read_b128 v[156:159], v23 offset:464
    s_waitcnt vmcnt(8) lgkmcnt(15)
    v_dot2_f32_bf16 v64, v32, v96, 0
    v_dot2_f32_bf16 v65, v32, v97, 0
    v_dot2_f32_bf16 v66, v33, v98, 0
    v_dot2_f32_bf16 v67, v33, v99, 0
    s_waitcnt lgkmcnt(14)
    v_dot2_f32_bf16 v68, v34, v100, 0
    v_dot2_f32_bf16 v69, v34, v101, 0
    v_dot2_f32_bf16 v70, v35, v102, 0
    v_dot2_f32_bf16 v71, v35, v103, 0
    v_cvt_pk_bf16_f32 v32, v64, v65
    v_cvt_pk_bf16_f32 v33, v66, v67
    v_cvt_pk_bf16_f32 v34, v68, v69
    v_cvt_pk_bf16_f32 v35, v70, v71
    s_waitcnt lgkmcnt(13)
    v_dot2_f32_bf16 v72, v32, v80, v104
    v_dot2_f32_bf16 v73, v32, v81, v105
    v_dot2_f32_bf16 v74, v33, v80, v106
    v_dot2_f32_bf16 v75, v33, v81, v107
    s_waitcnt lgkmcnt(12)
    v_dot2_f32_bf16 v76, v34, v80, v108
    v_dot2_f32_bf16 v77, v34, v81, v109
    v_dot2_f32_bf16 v78, v35, v80, v110
    v_dot2_f32_bf16 v79, v35, v81, v111
    v_cvt_pk_bf16_f32 v32, v72, v73
    v_cvt_pk_bf16_f32 v33, v74, v75
    v_cvt_pk_bf16_f32 v34, v76, v77
    v_cvt_pk_bf16_f32 v35, v78, v79
    ds_write_b128 v17, v[32:35] offset:0
    s_waitcnt vmcnt(7)
    v_dot2_f32_bf16 v64, v36, v96, 0
    v_dot2_f32_bf16 v65, v36, v97, 0
    v_dot2_f32_bf16 v66, v37, v98, 0
    v_dot2_f32_bf16 v67, v37, v99, 0
    v_dot2_f32_bf16 v68, v38, v100, 0
    v_dot2_f32_bf16 v69, v38, v101, 0
    v_dot2_f32_bf16 v70, v39, v102, 0
    v_dot2_f32_bf16 v71, v39, v103, 0
    v_cvt_pk_bf16_f32 v36, v64, v65
    v_cvt_pk_bf16_f32 v37, v66, v67
    v_cvt_pk_bf16_f32 v38, v68, v69
    v_cvt_pk_bf16_f32 v39, v70, v71
    v_dot2_f32_bf16 v72, v36, v80, v104
    v_dot2_f32_bf16 v73, v36, v81, v105
    v_dot2_f32_bf16 v74, v37, v80, v106
    v_dot2_f32_bf16 v75, v37, v81, v107
    v_dot2_f32_bf16 v76, v38, v80, v108
    v_dot2_f32_bf16 v77, v38, v81, v109
    v_dot2_f32_bf16 v78, v39, v80, v110
    v_dot2_f32_bf16 v79, v39, v81, v111
    v_cvt_pk_bf16_f32 v36, v72, v73
    v_cvt_pk_bf16_f32 v37, v74, v75
    v_cvt_pk_bf16_f32 v38, v76, v77
    v_cvt_pk_bf16_f32 v39, v78, v79
    ds_write_b128 v17, v[36:39] offset:16384
    s_add_u32 m0, s29, 0
    s_add_u32 s3, s30, 0
    buffer_load_dwordx4 v1, s[8:11], s3 offen lds
    s_add_u32 s3, s30, 130048
    buffer_load_dwordx4 v1, s[8:11], s3 offen offset:1024 lds
    s_add_u32 m0, s29, 2048
    s_add_u32 s3, s30, 32768
    buffer_load_dwordx4 v1, s[8:11], s3 offen lds
    s_add_u32 s3, s30, 162816
    buffer_load_dwordx4 v1, s[8:11], s3 offen offset:1024 lds
    v_and_b32 v95, 0x70, v27
    v_lshlrev_b32 v95, 3, v95
    s_lshl_b32 s44, s26, 16
    s_lshl_b32 s45, s24, 13
    s_add_u32 s44, s44, s45
    s_lshl_b32 s45, s25, 10
    s_add_u32 s44, s44, s45
    s_add_u32 s44, s44, 2097152
    buffer_load_dword v95, v95, s[8:11], s44 offen
    s_waitcnt vmcnt(11) lgkmcnt(13)
    v_dot2_f32_bf16 v160, v40, v112, 0
    v_dot2_f32_bf16 v161, v40, v113, 0
    v_dot2_f32_bf16 v162, v41, v114, 0
    v_dot2_f32_bf16 v163, v41, v115, 0
    s_waitcnt lgkmcnt(12)
    v_dot2_f32_bf16 v164, v42, v116, 0
    v_dot2_f32_bf16 v165, v42, v117, 0
    v_dot2_f32_bf16 v166, v43, v118, 0
    v_dot2_f32_bf16 v167, v43, v119, 0
    s_waitcnt vmcnt(10)
    v_dot2_f32_bf16 v176, v44, v112, 0
    v_dot2_f32_bf16 v177, v44, v113, 0
    v_dot2_f32_bf16 v178, v45, v114, 0
    v_dot2_f32_bf16 v179, v45, v115, 0
    v_dot2_f32_bf16 v180, v46, v116, 0
    v_dot2_f32_bf16 v181, v46, v117, 0
    v_dot2_f32_bf16 v182, v47, v118, 0
    v_dot2_f32_bf16 v183, v47, v119, 0
    v_cvt_pk_bf16_f32 v40, v160, v161
    v_cvt_pk_bf16_f32 v41, v162, v163
    v_cvt_pk_bf16_f32 v42, v164, v165
    v_cvt_pk_bf16_f32 v43, v166, v167
    v_cvt_pk_bf16_f32 v44, v176, v177
    v_cvt_pk_bf16_f32 v45, v178, v179
    v_cvt_pk_bf16_f32 v46, v180, v181
    v_cvt_pk_bf16_f32 v47, v182, v183
    s_waitcnt lgkmcnt(11)
    v_dot2_f32_bf16 v168, v40, v80, v120
    v_dot2_f32_bf16 v169, v40, v81, v121
    v_dot2_f32_bf16 v170, v41, v80, v122
    v_dot2_f32_bf16 v171, v41, v81, v123
    s_waitcnt lgkmcnt(10)
    v_dot2_f32_bf16 v172, v42, v80, v124
    v_dot2_f32_bf16 v173, v42, v81, v125
    v_dot2_f32_bf16 v174, v43, v80, v126
    v_dot2_f32_bf16 v175, v43, v81, v127
    v_dot2_f32_bf16 v184, v44, v80, v120
    v_dot2_f32_bf16 v185, v44, v81, v121
    v_dot2_f32_bf16 v186, v45, v80, v122
    v_dot2_f32_bf16 v187, v45, v81, v123
    v_dot2_f32_bf16 v188, v46, v80, v124
    v_dot2_f32_bf16 v189, v46, v81, v125
    v_dot2_f32_bf16 v190, v47, v80, v126
    v_dot2_f32_bf16 v191, v47, v81, v127
    v_cvt_pk_bf16_f32 v40, v168, v169
    v_cvt_pk_bf16_f32 v41, v170, v171
    v_cvt_pk_bf16_f32 v42, v172, v173
    v_cvt_pk_bf16_f32 v43, v174, v175
    ds_write_b128 v17, v[40:43] offset:8192
    v_cvt_pk_bf16_f32 v44, v184, v185
    v_cvt_pk_bf16_f32 v45, v186, v187
    v_cvt_pk_bf16_f32 v46, v188, v189
    v_cvt_pk_bf16_f32 v47, v190, v191
    ds_write_b128 v17, v[44:47] offset:24576
    s_add_u32 m0, s29, 32768
    s_add_u32 s3, s30, 262144
    buffer_load_dwordx4 v1, s[8:11], s3 offen lds
    s_add_u32 s3, s30, 392192
    buffer_load_dwordx4 v1, s[8:11], s3 offen offset:1024 lds
    s_add_u32 m0, s29, 34816
    s_add_u32 s3, s30, 294912
    buffer_load_dwordx4 v1, s[8:11], s3 offen lds
    s_add_u32 s3, s30, 424960
    buffer_load_dwordx4 v1, s[8:11], s3 offen offset:1024 lds
    s_waitcnt vmcnt(13) lgkmcnt(11)
    v_dot2_f32_bf16 v160, v48, v128, 0
    v_dot2_f32_bf16 v161, v48, v129, 0
    v_dot2_f32_bf16 v162, v49, v130, 0
    v_dot2_f32_bf16 v163, v49, v131, 0
    s_waitcnt lgkmcnt(10)
    v_dot2_f32_bf16 v164, v50, v132, 0
    v_dot2_f32_bf16 v165, v50, v133, 0
    v_dot2_f32_bf16 v166, v51, v134, 0
    v_dot2_f32_bf16 v167, v51, v135, 0
    s_waitcnt vmcnt(12)
    v_dot2_f32_bf16 v176, v52, v128, 0
    v_dot2_f32_bf16 v177, v52, v129, 0
    v_dot2_f32_bf16 v178, v53, v130, 0
    v_dot2_f32_bf16 v179, v53, v131, 0
    v_dot2_f32_bf16 v180, v54, v132, 0
    v_dot2_f32_bf16 v181, v54, v133, 0
    v_dot2_f32_bf16 v182, v55, v134, 0
    v_dot2_f32_bf16 v183, v55, v135, 0
    v_cvt_pk_bf16_f32 v48, v160, v161
    v_cvt_pk_bf16_f32 v49, v162, v163
    v_cvt_pk_bf16_f32 v50, v164, v165
    v_cvt_pk_bf16_f32 v51, v166, v167
    v_cvt_pk_bf16_f32 v52, v176, v177
    v_cvt_pk_bf16_f32 v53, v178, v179
    v_cvt_pk_bf16_f32 v54, v180, v181
    v_cvt_pk_bf16_f32 v55, v182, v183
    s_waitcnt lgkmcnt(9)
    v_dot2_f32_bf16 v168, v48, v80, v136
    v_dot2_f32_bf16 v169, v48, v81, v137
    v_dot2_f32_bf16 v170, v49, v80, v138
    v_dot2_f32_bf16 v171, v49, v81, v139
    s_waitcnt lgkmcnt(8)
    v_dot2_f32_bf16 v172, v50, v80, v140
    v_dot2_f32_bf16 v173, v50, v81, v141
    v_dot2_f32_bf16 v174, v51, v80, v142
    v_dot2_f32_bf16 v175, v51, v81, v143
    v_dot2_f32_bf16 v184, v52, v80, v136
    v_dot2_f32_bf16 v185, v52, v81, v137
    v_dot2_f32_bf16 v186, v53, v80, v138
    v_dot2_f32_bf16 v187, v53, v81, v139
    v_dot2_f32_bf16 v188, v54, v80, v140
    v_dot2_f32_bf16 v189, v54, v81, v141
    v_dot2_f32_bf16 v190, v55, v80, v142
    v_dot2_f32_bf16 v191, v55, v81, v143
    v_cvt_pk_bf16_f32 v48, v168, v169
    v_cvt_pk_bf16_f32 v49, v170, v171
    v_cvt_pk_bf16_f32 v50, v172, v173
    v_cvt_pk_bf16_f32 v51, v174, v175
    ds_write_b128 v17, v[48:51] offset:32768
    v_cvt_pk_bf16_f32 v52, v184, v185
    v_cvt_pk_bf16_f32 v53, v186, v187
    v_cvt_pk_bf16_f32 v54, v188, v189
    v_cvt_pk_bf16_f32 v55, v190, v191
    ds_write_b128 v17, v[52:55] offset:49152
    s_waitcnt vmcnt(11) lgkmcnt(9)
    v_dot2_f32_bf16 v160, v56, v144, 0
    v_dot2_f32_bf16 v161, v56, v145, 0
    v_dot2_f32_bf16 v162, v57, v146, 0
    v_dot2_f32_bf16 v163, v57, v147, 0
    s_waitcnt lgkmcnt(8)
    v_dot2_f32_bf16 v164, v58, v148, 0
    v_dot2_f32_bf16 v165, v58, v149, 0
    v_dot2_f32_bf16 v166, v59, v150, 0
    v_dot2_f32_bf16 v167, v59, v151, 0
    s_waitcnt vmcnt(10)
    v_dot2_f32_bf16 v176, v60, v144, 0
    v_dot2_f32_bf16 v177, v60, v145, 0
    v_dot2_f32_bf16 v178, v61, v146, 0
    v_dot2_f32_bf16 v179, v61, v147, 0
    v_dot2_f32_bf16 v180, v62, v148, 0
    v_dot2_f32_bf16 v181, v62, v149, 0
    v_dot2_f32_bf16 v182, v63, v150, 0
    v_dot2_f32_bf16 v183, v63, v151, 0
    v_cvt_pk_bf16_f32 v56, v160, v161
    v_cvt_pk_bf16_f32 v57, v162, v163
    v_cvt_pk_bf16_f32 v58, v164, v165
    v_cvt_pk_bf16_f32 v59, v166, v167
    v_cvt_pk_bf16_f32 v60, v176, v177
    v_cvt_pk_bf16_f32 v61, v178, v179
    v_cvt_pk_bf16_f32 v62, v180, v181
    v_cvt_pk_bf16_f32 v63, v182, v183
    s_waitcnt lgkmcnt(7)
    v_dot2_f32_bf16 v168, v56, v80, v152
    v_dot2_f32_bf16 v169, v56, v81, v153
    v_dot2_f32_bf16 v170, v57, v80, v154
    v_dot2_f32_bf16 v171, v57, v81, v155
    s_waitcnt lgkmcnt(6)
    v_dot2_f32_bf16 v172, v58, v80, v156
    v_dot2_f32_bf16 v173, v58, v81, v157
    v_dot2_f32_bf16 v174, v59, v80, v158
    v_dot2_f32_bf16 v175, v59, v81, v159
    v_dot2_f32_bf16 v184, v60, v80, v152
    v_dot2_f32_bf16 v185, v60, v81, v153
    v_dot2_f32_bf16 v186, v61, v80, v154
    v_dot2_f32_bf16 v187, v61, v81, v155
    v_dot2_f32_bf16 v188, v62, v80, v156
    v_dot2_f32_bf16 v189, v62, v81, v157
    v_dot2_f32_bf16 v190, v63, v80, v158
    v_dot2_f32_bf16 v191, v63, v81, v159
    v_cvt_pk_bf16_f32 v56, v168, v169
    v_cvt_pk_bf16_f32 v57, v170, v171
    v_cvt_pk_bf16_f32 v58, v172, v173
    v_cvt_pk_bf16_f32 v59, v174, v175
    ds_write_b128 v17, v[56:59] offset:40960
    v_cvt_pk_bf16_f32 v60, v184, v185
    v_cvt_pk_bf16_f32 v61, v186, v187
    v_cvt_pk_bf16_f32 v62, v188, v189
    v_cvt_pk_bf16_f32 v63, v190, v191
    ds_write_b128 v17, v[60:63] offset:57344
    v_add_u32 v21, 65536, v5
    v_add_u32 v22, 65536, v6
    v_add_u32 v25, 65536, v7
    v_add_u32 v26, 65536, v8
    s_waitcnt lgkmcnt(0)
    s_barrier
    ds_read_b128 v[228:231], v3 offset:0
    ds_read_b128 v[244:247], v3 offset:256
    ds_read_b128 v[248:251], v4 offset:0
    s_add_u32 m0, s29, 65536
    s_add_u32 s3, s30, 524288
    buffer_load_dwordx4 v1, s[8:11], s3 offen lds
    s_add_u32 s3, s30, 654336
    buffer_load_dwordx4 v1, s[8:11], s3 offen offset:1024 lds
    s_add_u32 m0, s29, 67584
    s_add_u32 s3, s30, 557056
    buffer_load_dwordx4 v1, s[8:11], s3 offen lds
    s_add_u32 s3, s30, 687104
    buffer_load_dwordx4 v1, s[8:11], s3 offen offset:1024 lds
    s_waitcnt vmcnt(11)
    ds_read_b64_tr_b16 v[224:225], v5 offset:0
    s_waitcnt vmcnt(9)
    ds_read_b64_tr_b16 v[226:227], v5 offset:2048
    ds_read_b64_tr_b16 v[232:233], v6 offset:0
    ds_read_b64_tr_b16 v[234:235], v6 offset:2048
    ds_read_b64_tr_b16 v[236:237], v7 offset:0
    ds_read_b64_tr_b16 v[238:239], v7 offset:2048
    ds_read_b64_tr_b16 v[240:241], v8 offset:0
    ds_read_b64_tr_b16 v[242:243], v8 offset:2048
    s_setprio 3
    s_waitcnt lgkmcnt(6)
    v_mfma_f32_16x16x32_bf16 v[160:163], v[224:227], v[228:231], 0
    s_waitcnt lgkmcnt(4)
    v_mfma_f32_16x16x32_bf16 v[164:167], v[232:235], v[228:231], 0
    s_waitcnt lgkmcnt(2)
    v_mfma_f32_16x16x32_bf16 v[168:171], v[236:239], v[228:231], 0
    ds_read_b128 v[252:255], v4 offset:256
    s_waitcnt lgkmcnt(1)
    v_mfma_f32_16x16x32_bf16 v[172:175], v[240:243], v[228:231], 0
    v_mfma_f32_16x16x32_bf16 v[176:179], v[224:227], v[244:247], 0
    s_add_u32 m0, s29, 0
    s_add_u32 s3, s30, 786432
    buffer_load_dwordx4 v1, s[8:11], s3 offen lds
    v_mfma_f32_16x16x32_bf16 v[180:183], v[232:235], v[244:247], 0
    v_mfma_f32_16x16x32_bf16 v[184:187], v[236:239], v[244:247], 0
    s_waitcnt vmcnt(7)
    ds_read_b64_tr_b16 v[228:229], v5 offset:32768
    s_waitcnt vmcnt(5)
    ds_read_b64_tr_b16 v[230:231], v5 offset:34816
    s_add_u32 s3, s30, 916480
    buffer_load_dwordx4 v1, s[8:11], s3 offen offset:1024 lds
    v_mfma_f32_16x16x32_bf16 v[188:191], v[240:243], v[244:247], 0
    ds_read_b128 v[244:247], v3 offset:2048
    v_mfma_f32_16x16x32_bf16 v[192:195], v[224:227], v[248:251], 0
    v_mfma_f32_16x16x32_bf16 v[196:199], v[232:235], v[248:251], 0
    s_add_u32 m0, s29, 2048
    s_add_u32 s3, s30, 819200
    buffer_load_dwordx4 v1, s[8:11], s3 offen lds
    v_mfma_f32_16x16x32_bf16 v[200:203], v[236:239], v[248:251], 0
    s_add_u32 s3, s30, 949248
    buffer_load_dwordx4 v1, s[8:11], s3 offen offset:1024 lds
    v_mfma_f32_16x16x32_bf16 v[204:207], v[240:243], v[248:251], 0
    ds_read_b64_tr_b16 v[248:249], v6 offset:32768
    ds_read_b64_tr_b16 v[250:251], v6 offset:34816
    s_waitcnt lgkmcnt(5)
    v_mfma_f32_16x16x32_bf16 v[208:211], v[224:227], v[252:255], 0
    ds_read_b64_tr_b16 v[224:225], v7 offset:32768
    ds_read_b64_tr_b16 v[226:227], v7 offset:34816
    v_mfma_f32_16x16x32_bf16 v[212:215], v[232:235], v[252:255], 0
    ds_read_b64_tr_b16 v[232:233], v8 offset:32768
    ds_read_b64_tr_b16 v[234:235], v8 offset:34816
    v_mfma_f32_16x16x32_bf16 v[216:219], v[236:239], v[252:255], 0
    ds_read_b128 v[236:239], v3 offset:2304
    v_mfma_f32_16x16x32_bf16 v[220:223], v[240:243], v[252:255], 0
    ds_read_b128 v[240:243], v4 offset:2048
    s_waitcnt lgkmcnt(8)
    v_mfma_f32_16x16x32_bf16 v[160:163], v[228:231], v[244:247], v[160:163]
    s_waitcnt lgkmcnt(6)
    v_mfma_f32_16x16x32_bf16 v[164:167], v[248:251], v[244:247], v[164:167]
    s_waitcnt lgkmcnt(4)
    v_mfma_f32_16x16x32_bf16 v[168:171], v[224:227], v[244:247], v[168:171]
    ds_read_b128 v[252:255], v4 offset:2304
    s_waitcnt lgkmcnt(3)
    v_mfma_f32_16x16x32_bf16 v[172:175], v[232:235], v[244:247], v[172:175]
    s_waitcnt lgkmcnt(2)
    v_mfma_f32_16x16x32_bf16 v[176:179], v[228:231], v[236:239], v[176:179]
    s_add_u32 m0, s29, 32768
    s_add_u32 s3, s30, 1048576
    buffer_load_dwordx4 v1, s[8:11], s3 offen lds
    v_mfma_f32_16x16x32_bf16 v[180:183], v[248:251], v[236:239], v[180:183]
    v_mfma_f32_16x16x32_bf16 v[184:187], v[224:227], v[236:239], v[184:187]
    s_waitcnt vmcnt(7)
    ds_read_b64_tr_b16 v[244:245], v21 offset:0
    s_waitcnt vmcnt(5)
    ds_read_b64_tr_b16 v[246:247], v21 offset:2048
    s_add_u32 s3, s30, 1178624
    buffer_load_dwordx4 v1, s[8:11], s3 offen offset:1024 lds
    v_mfma_f32_16x16x32_bf16 v[188:191], v[232:235], v[236:239], v[188:191]
    ds_read_b128 v[236:239], v3 offset:4096
    s_waitcnt lgkmcnt(4)
    v_mfma_f32_16x16x32_bf16 v[192:195], v[228:231], v[240:243], v[192:195]
    v_mfma_f32_16x16x32_bf16 v[196:199], v[248:251], v[240:243], v[196:199]
    s_add_u32 m0, s29, 34816
    s_add_u32 s3, s30, 1081344
    buffer_load_dwordx4 v1, s[8:11], s3 offen lds
    v_mfma_f32_16x16x32_bf16 v[200:203], v[224:227], v[240:243], v[200:203]
    s_add_u32 s3, s30, 1211392
    buffer_load_dwordx4 v1, s[8:11], s3 offen offset:1024 lds
    v_mfma_f32_16x16x32_bf16 v[204:207], v[232:235], v[240:243], v[204:207]
    ds_read_b64_tr_b16 v[240:241], v22 offset:0
    ds_read_b64_tr_b16 v[242:243], v22 offset:2048
    s_waitcnt lgkmcnt(5)
    v_mfma_f32_16x16x32_bf16 v[208:211], v[228:231], v[252:255], v[208:211]
    ds_read_b64_tr_b16 v[228:229], v25 offset:0
    ds_read_b64_tr_b16 v[230:231], v25 offset:2048
    v_mfma_f32_16x16x32_bf16 v[212:215], v[248:251], v[252:255], v[212:215]
    ds_read_b64_tr_b16 v[248:249], v26 offset:0
    ds_read_b64_tr_b16 v[250:251], v26 offset:2048
    v_mfma_f32_16x16x32_bf16 v[216:219], v[224:227], v[252:255], v[216:219]
    ds_read_b128 v[224:227], v3 offset:4352
    v_mfma_f32_16x16x32_bf16 v[220:223], v[232:235], v[252:255], v[220:223]
    ds_read_b128 v[232:235], v4 offset:4096
    v_and_b32 v93, 0x30, v27
    v_lshlrev_b32 v93, 3, v93
    s_lshl_b32 s44, s25, 19
    s_lshl_b32 s45, s26, 12
    s_add_u32 s44, s44, s45
    s_lshl_b32 s45, s24, 9
    s_add_u32 s44, s44, s45
    s_add_u32 s44, s44, 393216
    buffer_load_dword v93, v93, s[4:7], s44 offen
    s_waitcnt lgkmcnt(8)
    v_mfma_f32_16x16x32_bf16 v[160:163], v[244:247], v[236:239], v[160:163]
    s_waitcnt lgkmcnt(6)
    v_mfma_f32_16x16x32_bf16 v[164:167], v[240:243], v[236:239], v[164:167]
    s_waitcnt lgkmcnt(4)
    v_mfma_f32_16x16x32_bf16 v[168:171], v[228:231], v[236:239], v[168:171]
    ds_read_b128 v[252:255], v4 offset:4352
    s_waitcnt lgkmcnt(3)
    v_mfma_f32_16x16x32_bf16 v[172:175], v[248:251], v[236:239], v[172:175]
    s_waitcnt lgkmcnt(2)
    v_mfma_f32_16x16x32_bf16 v[176:179], v[244:247], v[224:227], v[176:179]
    s_add_u32 m0, s29, 65536
    s_add_u32 s3, s30, 1310720
    buffer_load_dwordx4 v1, s[8:11], s3 offen lds
    v_mfma_f32_16x16x32_bf16 v[180:183], v[240:243], v[224:227], v[180:183]
    v_mfma_f32_16x16x32_bf16 v[184:187], v[228:231], v[224:227], v[184:187]
    s_waitcnt vmcnt(8)
    ds_read_b64_tr_b16 v[236:237], v5 offset:0
    s_waitcnt vmcnt(6)
    ds_read_b64_tr_b16 v[238:239], v5 offset:2048
    s_add_u32 s3, s30, 1440768
    buffer_load_dwordx4 v1, s[8:11], s3 offen offset:1024 lds
    v_mfma_f32_16x16x32_bf16 v[188:191], v[248:251], v[224:227], v[188:191]
    ds_read_b128 v[224:227], v3 offset:6144
    s_waitcnt lgkmcnt(4)
    v_mfma_f32_16x16x32_bf16 v[192:195], v[244:247], v[232:235], v[192:195]
    v_mfma_f32_16x16x32_bf16 v[196:199], v[240:243], v[232:235], v[196:199]
    s_add_u32 m0, s29, 67584
    s_add_u32 s3, s30, 1343488
    buffer_load_dwordx4 v1, s[8:11], s3 offen lds
    v_mfma_f32_16x16x32_bf16 v[200:203], v[228:231], v[232:235], v[200:203]
    s_add_u32 s3, s30, 1473536
    buffer_load_dwordx4 v1, s[8:11], s3 offen offset:1024 lds
    v_mfma_f32_16x16x32_bf16 v[204:207], v[248:251], v[232:235], v[204:207]
    ds_read_b64_tr_b16 v[232:233], v6 offset:0
    ds_read_b64_tr_b16 v[234:235], v6 offset:2048
    s_waitcnt lgkmcnt(5)
    v_mfma_f32_16x16x32_bf16 v[208:211], v[244:247], v[252:255], v[208:211]
    ds_read_b64_tr_b16 v[244:245], v7 offset:0
    ds_read_b64_tr_b16 v[246:247], v7 offset:2048
    v_mfma_f32_16x16x32_bf16 v[212:215], v[240:243], v[252:255], v[212:215]
    ds_read_b64_tr_b16 v[240:241], v8 offset:0
    ds_read_b64_tr_b16 v[242:243], v8 offset:2048
    v_mfma_f32_16x16x32_bf16 v[216:219], v[228:231], v[252:255], v[216:219]
    ds_read_b128 v[228:231], v3 offset:6400
    v_mfma_f32_16x16x32_bf16 v[220:223], v[248:251], v[252:255], v[220:223]
    ds_read_b128 v[248:251], v4 offset:6144
    s_waitcnt lgkmcnt(8)
    v_mfma_f32_16x16x32_bf16 v[160:163], v[236:239], v[224:227], v[160:163]
    s_waitcnt lgkmcnt(6)
    v_mfma_f32_16x16x32_bf16 v[164:167], v[232:235], v[224:227], v[164:167]
    s_waitcnt lgkmcnt(4)
    v_mfma_f32_16x16x32_bf16 v[168:171], v[244:247], v[224:227], v[168:171]
    ds_read_b128 v[252:255], v4 offset:6400
    s_waitcnt lgkmcnt(3)
    v_mfma_f32_16x16x32_bf16 v[172:175], v[240:243], v[224:227], v[172:175]
    s_waitcnt lgkmcnt(2)
    v_mfma_f32_16x16x32_bf16 v[176:179], v[236:239], v[228:231], v[176:179]
    s_add_u32 m0, s29, 0
    s_add_u32 s3, s30, 1572864
    buffer_load_dwordx4 v1, s[8:11], s3 offen lds
    v_mfma_f32_16x16x32_bf16 v[180:183], v[232:235], v[228:231], v[180:183]
    v_mfma_f32_16x16x32_bf16 v[184:187], v[244:247], v[228:231], v[184:187]
    s_waitcnt vmcnt(8)
    ds_read_b64_tr_b16 v[224:225], v5 offset:32768
    s_waitcnt vmcnt(6)
    ds_read_b64_tr_b16 v[226:227], v5 offset:34816
    s_add_u32 s3, s30, 1702912
    buffer_load_dwordx4 v1, s[8:11], s3 offen offset:1024 lds
    v_mfma_f32_16x16x32_bf16 v[188:191], v[240:243], v[228:231], v[188:191]
    ds_read_b128 v[228:231], v3 offset:8192
    s_waitcnt lgkmcnt(4)
    v_mfma_f32_16x16x32_bf16 v[192:195], v[236:239], v[248:251], v[192:195]
    v_mfma_f32_16x16x32_bf16 v[196:199], v[232:235], v[248:251], v[196:199]
    s_add_u32 m0, s29, 2048
    s_add_u32 s3, s30, 1605632
    buffer_load_dwordx4 v1, s[8:11], s3 offen lds
    v_mfma_f32_16x16x32_bf16 v[200:203], v[244:247], v[248:251], v[200:203]
    s_add_u32 s3, s30, 1735680
    buffer_load_dwordx4 v1, s[8:11], s3 offen offset:1024 lds
    v_mfma_f32_16x16x32_bf16 v[204:207], v[240:243], v[248:251], v[204:207]
    ds_read_b64_tr_b16 v[248:249], v6 offset:32768
    ds_read_b64_tr_b16 v[250:251], v6 offset:34816
    s_waitcnt lgkmcnt(5)
    v_mfma_f32_16x16x32_bf16 v[208:211], v[236:239], v[252:255], v[208:211]
    ds_read_b64_tr_b16 v[236:237], v7 offset:32768
    ds_read_b64_tr_b16 v[238:239], v7 offset:34816
    v_mfma_f32_16x16x32_bf16 v[212:215], v[232:235], v[252:255], v[212:215]
    ds_read_b64_tr_b16 v[232:233], v8 offset:32768
    ds_read_b64_tr_b16 v[234:235], v8 offset:34816
    v_mfma_f32_16x16x32_bf16 v[216:219], v[244:247], v[252:255], v[216:219]
    ds_read_b128 v[244:247], v3 offset:8448
    v_mfma_f32_16x16x32_bf16 v[220:223], v[240:243], v[252:255], v[220:223]
    ds_read_b128 v[240:243], v4 offset:8192
    s_setprio 2
    s_waitcnt lgkmcnt(8)
    v_mfma_f32_16x16x32_bf16 v[160:163], v[224:227], v[228:231], v[160:163]
    s_waitcnt lgkmcnt(6)
    v_mfma_f32_16x16x32_bf16 v[164:167], v[248:251], v[228:231], v[164:167]
    s_waitcnt lgkmcnt(4)
    v_mfma_f32_16x16x32_bf16 v[168:171], v[236:239], v[228:231], v[168:171]
    ds_read_b128 v[252:255], v4 offset:8448
    s_waitcnt lgkmcnt(3)
    v_mfma_f32_16x16x32_bf16 v[172:175], v[232:235], v[228:231], v[172:175]
    s_waitcnt lgkmcnt(2)
    v_mfma_f32_16x16x32_bf16 v[176:179], v[224:227], v[244:247], v[176:179]
    s_add_u32 m0, s29, 32768
    s_add_u32 s3, s30, 1835008
    buffer_load_dwordx4 v1, s[8:11], s3 offen lds
    v_mfma_f32_16x16x32_bf16 v[180:183], v[248:251], v[244:247], v[180:183]
    v_mfma_f32_16x16x32_bf16 v[184:187], v[236:239], v[244:247], v[184:187]
    s_waitcnt vmcnt(7)
    ds_read_b64_tr_b16 v[228:229], v21 offset:0
    s_waitcnt vmcnt(5)
    ds_read_b64_tr_b16 v[230:231], v21 offset:2048
    s_add_u32 s3, s30, 1965056
    buffer_load_dwordx4 v1, s[8:11], s3 offen offset:1024 lds
    v_mfma_f32_16x16x32_bf16 v[188:191], v[232:235], v[244:247], v[188:191]
    ds_read_b128 v[244:247], v3 offset:10240
    s_waitcnt lgkmcnt(4)
    v_mfma_f32_16x16x32_bf16 v[192:195], v[224:227], v[240:243], v[192:195]
    v_mfma_f32_16x16x32_bf16 v[196:199], v[248:251], v[240:243], v[196:199]
    s_add_u32 m0, s29, 34816
    s_add_u32 s3, s30, 1867776
    buffer_load_dwordx4 v1, s[8:11], s3 offen lds
    v_mfma_f32_16x16x32_bf16 v[200:203], v[236:239], v[240:243], v[200:203]
    s_add_u32 s3, s30, 1997824
    buffer_load_dwordx4 v1, s[8:11], s3 offen offset:1024 lds
    v_mfma_f32_16x16x32_bf16 v[204:207], v[232:235], v[240:243], v[204:207]
    ds_read_b64_tr_b16 v[240:241], v22 offset:0
    ds_read_b64_tr_b16 v[242:243], v22 offset:2048
    s_waitcnt lgkmcnt(5)
    v_mfma_f32_16x16x32_bf16 v[208:211], v[224:227], v[252:255], v[208:211]
    ds_read_b64_tr_b16 v[224:225], v25 offset:0
    ds_read_b64_tr_b16 v[226:227], v25 offset:2048
    v_mfma_f32_16x16x32_bf16 v[212:215], v[248:251], v[252:255], v[212:215]
    ds_read_b64_tr_b16 v[248:249], v26 offset:0
    ds_read_b64_tr_b16 v[250:251], v26 offset:2048
    v_mfma_f32_16x16x32_bf16 v[216:219], v[236:239], v[252:255], v[216:219]
    ds_read_b128 v[236:239], v3 offset:10496
    v_mfma_f32_16x16x32_bf16 v[220:223], v[232:235], v[252:255], v[220:223]
    ds_read_b128 v[232:235], v4 offset:10240
    s_waitcnt lgkmcnt(8)
    v_mfma_f32_16x16x32_bf16 v[160:163], v[228:231], v[244:247], v[160:163]
    s_waitcnt lgkmcnt(6)
    v_mfma_f32_16x16x32_bf16 v[164:167], v[240:243], v[244:247], v[164:167]
    s_waitcnt lgkmcnt(4)
    v_mfma_f32_16x16x32_bf16 v[168:171], v[224:227], v[244:247], v[168:171]
    ds_read_b128 v[252:255], v4 offset:10496
    s_waitcnt lgkmcnt(3)
    v_mfma_f32_16x16x32_bf16 v[172:175], v[248:251], v[244:247], v[172:175]
    s_waitcnt lgkmcnt(2)
    v_mfma_f32_16x16x32_bf16 v[176:179], v[228:231], v[236:239], v[176:179]
    s_add_u32 m0, s29, 65536
    s_add_u32 s3, s30, 2097152
    buffer_load_dwordx4 v1, s[8:11], s3 offen lds
    v_mfma_f32_16x16x32_bf16 v[180:183], v[240:243], v[236:239], v[180:183]
    v_mfma_f32_16x16x32_bf16 v[184:187], v[224:227], v[236:239], v[184:187]
    s_waitcnt vmcnt(7)
    ds_read_b64_tr_b16 v[244:245], v5 offset:0
    s_waitcnt vmcnt(5)
    ds_read_b64_tr_b16 v[246:247], v5 offset:2048
    s_add_u32 s3, s30, 2227200
    buffer_load_dwordx4 v1, s[8:11], s3 offen offset:1024 lds
    v_mfma_f32_16x16x32_bf16 v[188:191], v[248:251], v[236:239], v[188:191]
    ds_read_b128 v[236:239], v3 offset:12288
    s_waitcnt lgkmcnt(4)
    v_mfma_f32_16x16x32_bf16 v[192:195], v[228:231], v[232:235], v[192:195]
    v_mfma_f32_16x16x32_bf16 v[196:199], v[240:243], v[232:235], v[196:199]
    s_add_u32 m0, s29, 67584
    s_add_u32 s3, s30, 2129920
    buffer_load_dwordx4 v1, s[8:11], s3 offen lds
    v_mfma_f32_16x16x32_bf16 v[200:203], v[224:227], v[232:235], v[200:203]
    s_add_u32 s3, s30, 2259968
    buffer_load_dwordx4 v1, s[8:11], s3 offen offset:1024 lds
    v_mfma_f32_16x16x32_bf16 v[204:207], v[248:251], v[232:235], v[204:207]
    ds_read_b64_tr_b16 v[232:233], v6 offset:0
    ds_read_b64_tr_b16 v[234:235], v6 offset:2048
    s_waitcnt lgkmcnt(5)
    v_mfma_f32_16x16x32_bf16 v[208:211], v[228:231], v[252:255], v[208:211]
    ds_read_b64_tr_b16 v[228:229], v7 offset:0
    ds_read_b64_tr_b16 v[230:231], v7 offset:2048
    v_mfma_f32_16x16x32_bf16 v[212:215], v[240:243], v[252:255], v[212:215]
    ds_read_b64_tr_b16 v[240:241], v8 offset:0
    ds_read_b64_tr_b16 v[242:243], v8 offset:2048
    v_mfma_f32_16x16x32_bf16 v[216:219], v[224:227], v[252:255], v[216:219]
    ds_read_b128 v[224:227], v3 offset:12544
    v_mfma_f32_16x16x32_bf16 v[220:223], v[248:251], v[252:255], v[220:223]
    ds_read_b128 v[248:251], v4 offset:12288
    s_waitcnt lgkmcnt(8)
    v_mfma_f32_16x16x32_bf16 v[160:163], v[244:247], v[236:239], v[160:163]
    s_lshl_b32 s36, s2, 8
    s_waitcnt lgkmcnt(6)
    v_mfma_f32_16x16x32_bf16 v[164:167], v[232:235], v[236:239], v[164:167]
    s_add_u32 s37, s36, 0x241000
    s_waitcnt lgkmcnt(4)
    v_mfma_f32_16x16x32_bf16 v[168:171], v[228:231], v[236:239], v[168:171]
    s_add_u32 s36, s36, 0x200000
    ds_read_b128 v[252:255], v4 offset:12544
    s_lshl_b32 s38, s24, 8
    s_waitcnt lgkmcnt(3)
    v_mfma_f32_16x16x32_bf16 v[172:175], v[240:243], v[236:239], v[172:175]
    s_add_u32 s38, s38, s2
    s_waitcnt lgkmcnt(2)
    v_mfma_f32_16x16x32_bf16 v[176:179], v[244:247], v[224:227], v[176:179]
    s_cmp_ge_u32 s38, 40
    s_cselect_b32 s38, 0x10000000, 0
    s_add_u32 m0, s29, 0
    s_add_u32 s3, s30, 2359296
    buffer_load_dwordx4 v1, s[8:11], s3 offen lds
    s_add_u32 s36, s36, s38
    s_add_u32 s37, s37, s38
    v_mfma_f32_16x16x32_bf16 v[180:183], v[232:235], v[224:227], v[180:183]
    v_lshrrev_b32 v20, 2, v27
    v_mfma_f32_16x16x32_bf16 v[184:187], v[228:231], v[224:227], v[184:187]
    buffer_load_dword v90, v20, s[16:19], s37 offen
    s_waitcnt vmcnt(8)
    ds_read_b64_tr_b16 v[236:237], v5 offset:32768
    s_add_u32 s37, s37, 21504
    s_waitcnt vmcnt(6)
    ds_read_b64_tr_b16 v[238:239], v5 offset:34816
    buffer_load_dword v91, v20, s[16:19], s37 offen
    s_add_u32 s3, s30, 2489344
    buffer_load_dwordx4 v1, s[8:11], s3 offen offset:1024 lds
    s_add_u32 s37, s37, 21504
    v_mfma_f32_16x16x32_bf16 v[188:191], v[240:243], v[224:227], v[188:191]
    buffer_load_dword v92, v20, s[16:19], s37 offen
    ds_read_b128 v[224:227], v3 offset:14336
    s_add_u32 s37, s37, 21504
    buffer_load_dword v93, v20, s[16:19], s37 offen
    s_waitcnt lgkmcnt(4)
    v_mfma_f32_16x16x32_bf16 v[192:195], v[244:247], v[248:251], v[192:195]
    v_mfma_f32_16x16x32_bf16 v[196:199], v[232:235], v[248:251], v[196:199]
    s_add_u32 m0, s29, 2048
    s_add_u32 s3, s30, 2392064
    buffer_load_dwordx4 v1, s[8:11], s3 offen lds
    v_mfma_f32_16x16x32_bf16 v[200:203], v[228:231], v[248:251], v[200:203]
    s_add_u32 s3, s30, 2522112
    buffer_load_dwordx4 v1, s[8:11], s3 offen offset:1024 lds
    v_mfma_f32_16x16x32_bf16 v[204:207], v[240:243], v[248:251], v[204:207]
    ds_read_b64_tr_b16 v[248:249], v6 offset:32768
    ds_read_b64_tr_b16 v[250:251], v6 offset:34816
    s_waitcnt lgkmcnt(5)
    v_mfma_f32_16x16x32_bf16 v[208:211], v[244:247], v[252:255], v[208:211]
    ds_read_b64_tr_b16 v[244:245], v7 offset:32768
    ds_read_b64_tr_b16 v[246:247], v7 offset:34816
    v_mfma_f32_16x16x32_bf16 v[212:215], v[232:235], v[252:255], v[212:215]
    ds_read_b64_tr_b16 v[232:233], v8 offset:32768
    ds_read_b64_tr_b16 v[234:235], v8 offset:34816
    v_mfma_f32_16x16x32_bf16 v[216:219], v[228:231], v[252:255], v[216:219]
    ds_read_b128 v[228:231], v3 offset:14592
    v_mfma_f32_16x16x32_bf16 v[220:223], v[240:243], v[252:255], v[220:223]
    ds_read_b128 v[240:243], v4 offset:14336
    s_waitcnt lgkmcnt(8)
    v_mfma_f32_16x16x32_bf16 v[160:163], v[236:239], v[224:227], v[160:163]
    s_waitcnt lgkmcnt(6)
    v_mfma_f32_16x16x32_bf16 v[164:167], v[248:251], v[224:227], v[164:167]
    s_waitcnt lgkmcnt(4)
    v_mfma_f32_16x16x32_bf16 v[168:171], v[244:247], v[224:227], v[168:171]
    ds_read_b128 v[252:255], v4 offset:14592
    s_waitcnt lgkmcnt(3)
    v_mfma_f32_16x16x32_bf16 v[172:175], v[232:235], v[224:227], v[172:175]
    s_waitcnt lgkmcnt(2)
    v_mfma_f32_16x16x32_bf16 v[176:179], v[236:239], v[228:231], v[176:179]
    s_add_u32 m0, s29, 32768
    s_add_u32 s3, s30, 2621440
    buffer_load_dwordx4 v1, s[8:11], s3 offen lds
    v_mfma_f32_16x16x32_bf16 v[180:183], v[248:251], v[228:231], v[180:183]
    v_mfma_f32_16x16x32_bf16 v[184:187], v[244:247], v[228:231], v[184:187]
    s_waitcnt vmcnt(11)
    ds_read_b64_tr_b16 v[224:225], v21 offset:0
    s_waitcnt vmcnt(9)
    ds_read_b64_tr_b16 v[226:227], v21 offset:2048
    s_add_u32 s3, s30, 2751488
    buffer_load_dwordx4 v1, s[8:11], s3 offen offset:1024 lds
    v_mfma_f32_16x16x32_bf16 v[188:191], v[232:235], v[228:231], v[188:191]
    ds_read_b128 v[228:231], v3 offset:32768
    s_waitcnt lgkmcnt(4)
    v_mfma_f32_16x16x32_bf16 v[192:195], v[236:239], v[240:243], v[192:195]
    v_mfma_f32_16x16x32_bf16 v[196:199], v[248:251], v[240:243], v[196:199]
    s_add_u32 m0, s29, 34816
    s_add_u32 s3, s30, 2654208
    buffer_load_dwordx4 v1, s[8:11], s3 offen lds
    v_mfma_f32_16x16x32_bf16 v[200:203], v[244:247], v[240:243], v[200:203]
    s_add_u32 s3, s30, 2784256
    buffer_load_dwordx4 v1, s[8:11], s3 offen offset:1024 lds
    v_mfma_f32_16x16x32_bf16 v[204:207], v[232:235], v[240:243], v[204:207]
    ds_read_b64_tr_b16 v[240:241], v22 offset:0
    ds_read_b64_tr_b16 v[242:243], v22 offset:2048
    s_waitcnt lgkmcnt(5)
    v_mfma_f32_16x16x32_bf16 v[208:211], v[236:239], v[252:255], v[208:211]
    ds_read_b64_tr_b16 v[236:237], v25 offset:0
    ds_read_b64_tr_b16 v[238:239], v25 offset:2048
    v_mfma_f32_16x16x32_bf16 v[212:215], v[248:251], v[252:255], v[212:215]
    ds_read_b64_tr_b16 v[248:249], v26 offset:0
    ds_read_b64_tr_b16 v[250:251], v26 offset:2048
    v_mfma_f32_16x16x32_bf16 v[216:219], v[244:247], v[252:255], v[216:219]
    ds_read_b128 v[244:247], v3 offset:33024
    v_mfma_f32_16x16x32_bf16 v[220:223], v[232:235], v[252:255], v[220:223]
    ds_read_b128 v[232:235], v4 offset:32768
    s_setprio 1
    s_waitcnt lgkmcnt(8)
    v_mfma_f32_16x16x32_bf16 v[160:163], v[224:227], v[228:231], v[160:163]
    s_waitcnt lgkmcnt(6)
    v_mfma_f32_16x16x32_bf16 v[164:167], v[240:243], v[228:231], v[164:167]
    s_waitcnt lgkmcnt(4)
    v_mfma_f32_16x16x32_bf16 v[168:171], v[236:239], v[228:231], v[168:171]
    ds_read_b128 v[252:255], v4 offset:33024
    s_waitcnt lgkmcnt(3)
    v_mfma_f32_16x16x32_bf16 v[172:175], v[248:251], v[228:231], v[172:175]
    s_waitcnt lgkmcnt(2)
    v_mfma_f32_16x16x32_bf16 v[176:179], v[224:227], v[244:247], v[176:179]
    s_add_u32 m0, s29, 65536
    s_add_u32 s3, s30, 2883584
    buffer_load_dwordx4 v1, s[8:11], s3 offen lds
    v_mfma_f32_16x16x32_bf16 v[180:183], v[240:243], v[244:247], v[180:183]
    v_mfma_f32_16x16x32_bf16 v[184:187], v[236:239], v[244:247], v[184:187]
    s_waitcnt vmcnt(9)
    ds_read_b64_tr_b16 v[228:229], v5 offset:0
    s_waitcnt vmcnt(5)
    ds_read_b64_tr_b16 v[230:231], v5 offset:2048
    s_add_u32 s3, s30, 3013632
    buffer_load_dwordx4 v1, s[8:11], s3 offen offset:1024 lds
    v_mfma_f32_16x16x32_bf16 v[188:191], v[248:251], v[244:247], v[188:191]
    ds_read_b128 v[244:247], v3 offset:34816
    s_waitcnt lgkmcnt(4)
    v_mfma_f32_16x16x32_bf16 v[192:195], v[224:227], v[232:235], v[192:195]
    v_mfma_f32_16x16x32_bf16 v[196:199], v[240:243], v[232:235], v[196:199]
    s_add_u32 m0, s29, 67584
    s_add_u32 s3, s30, 2916352
    buffer_load_dwordx4 v1, s[8:11], s3 offen lds
    v_mfma_f32_16x16x32_bf16 v[200:203], v[236:239], v[232:235], v[200:203]
    s_add_u32 s3, s30, 3046400
    buffer_load_dwordx4 v1, s[8:11], s3 offen offset:1024 lds
    v_mfma_f32_16x16x32_bf16 v[204:207], v[248:251], v[232:235], v[204:207]
    ds_read_b64_tr_b16 v[232:233], v6 offset:0
    ds_read_b64_tr_b16 v[234:235], v6 offset:2048
    s_waitcnt lgkmcnt(5)
    v_mfma_f32_16x16x32_bf16 v[208:211], v[224:227], v[252:255], v[208:211]
    ds_read_b64_tr_b16 v[224:225], v7 offset:0
    ds_read_b64_tr_b16 v[226:227], v7 offset:2048
    v_mfma_f32_16x16x32_bf16 v[212:215], v[240:243], v[252:255], v[212:215]
    ds_read_b64_tr_b16 v[240:241], v8 offset:0
    ds_read_b64_tr_b16 v[242:243], v8 offset:2048
    v_mfma_f32_16x16x32_bf16 v[216:219], v[236:239], v[252:255], v[216:219]
    ds_read_b128 v[236:239], v3 offset:35072
    v_mfma_f32_16x16x32_bf16 v[220:223], v[248:251], v[252:255], v[220:223]
    ds_read_b128 v[248:251], v4 offset:34816
    s_waitcnt lgkmcnt(8)
    v_mfma_f32_16x16x32_bf16 v[160:163], v[228:231], v[244:247], v[160:163]
    s_waitcnt lgkmcnt(6)
    v_mfma_f32_16x16x32_bf16 v[164:167], v[232:235], v[244:247], v[164:167]
    s_waitcnt lgkmcnt(4)
    v_mfma_f32_16x16x32_bf16 v[168:171], v[224:227], v[244:247], v[168:171]
    ds_read_b128 v[252:255], v4 offset:35072
    s_waitcnt lgkmcnt(3)
    v_mfma_f32_16x16x32_bf16 v[172:175], v[240:243], v[244:247], v[172:175]
    s_waitcnt lgkmcnt(2)
    v_mfma_f32_16x16x32_bf16 v[176:179], v[228:231], v[236:239], v[176:179]
    s_add_u32 m0, s29, 0
    s_add_u32 s3, s30, 3145728
    buffer_load_dwordx4 v1, s[8:11], s3 offen lds
    v_mfma_f32_16x16x32_bf16 v[180:183], v[232:235], v[236:239], v[180:183]
    v_mfma_f32_16x16x32_bf16 v[184:187], v[224:227], v[236:239], v[184:187]
    s_waitcnt vmcnt(7)
    ds_read_b64_tr_b16 v[244:245], v5 offset:32768
    s_waitcnt vmcnt(5)
    ds_read_b64_tr_b16 v[246:247], v5 offset:34816
    s_add_u32 s3, s30, 3275776
    buffer_load_dwordx4 v1, s[8:11], s3 offen offset:1024 lds
    v_mfma_f32_16x16x32_bf16 v[188:191], v[240:243], v[236:239], v[188:191]
    ds_read_b128 v[236:239], v3 offset:36864
    s_waitcnt lgkmcnt(4)
    v_mfma_f32_16x16x32_bf16 v[192:195], v[228:231], v[248:251], v[192:195]
    v_mfma_f32_16x16x32_bf16 v[196:199], v[232:235], v[248:251], v[196:199]
    s_add_u32 m0, s29, 2048
    s_add_u32 s3, s30, 3178496
    buffer_load_dwordx4 v1, s[8:11], s3 offen lds
    v_mfma_f32_16x16x32_bf16 v[200:203], v[224:227], v[248:251], v[200:203]
    s_add_u32 s3, s30, 3308544
    buffer_load_dwordx4 v1, s[8:11], s3 offen offset:1024 lds
    v_mfma_f32_16x16x32_bf16 v[204:207], v[240:243], v[248:251], v[204:207]
    ds_read_b64_tr_b16 v[248:249], v6 offset:32768
    ds_read_b64_tr_b16 v[250:251], v6 offset:34816
    s_waitcnt lgkmcnt(5)
    v_mfma_f32_16x16x32_bf16 v[208:211], v[228:231], v[252:255], v[208:211]
    ds_read_b64_tr_b16 v[228:229], v7 offset:32768
    ds_read_b64_tr_b16 v[230:231], v7 offset:34816
    v_mfma_f32_16x16x32_bf16 v[212:215], v[232:235], v[252:255], v[212:215]
    ds_read_b64_tr_b16 v[232:233], v8 offset:32768
    ds_read_b64_tr_b16 v[234:235], v8 offset:34816
    v_mfma_f32_16x16x32_bf16 v[216:219], v[224:227], v[252:255], v[216:219]
    ds_read_b128 v[224:227], v3 offset:37120
    v_mfma_f32_16x16x32_bf16 v[220:223], v[240:243], v[252:255], v[220:223]
    ds_read_b128 v[240:243], v4 offset:36864
    s_waitcnt lgkmcnt(8)
    v_mfma_f32_16x16x32_bf16 v[160:163], v[244:247], v[236:239], v[160:163]
    s_waitcnt lgkmcnt(6)
    v_mfma_f32_16x16x32_bf16 v[164:167], v[248:251], v[236:239], v[164:167]
    s_waitcnt lgkmcnt(4)
    v_mfma_f32_16x16x32_bf16 v[168:171], v[228:231], v[236:239], v[168:171]
    ds_read_b128 v[252:255], v4 offset:37120
    s_waitcnt lgkmcnt(3)
    v_mfma_f32_16x16x32_bf16 v[172:175], v[232:235], v[236:239], v[172:175]
    s_waitcnt lgkmcnt(2)
    v_mfma_f32_16x16x32_bf16 v[176:179], v[244:247], v[224:227], v[176:179]
    s_add_u32 m0, s29, 32768
    s_add_u32 s3, s30, 3407872
    buffer_load_dwordx4 v1, s[8:11], s3 offen lds
    v_mfma_f32_16x16x32_bf16 v[180:183], v[248:251], v[224:227], v[180:183]
    v_mfma_f32_16x16x32_bf16 v[184:187], v[228:231], v[224:227], v[184:187]
    s_waitcnt vmcnt(7)
    ds_read_b64_tr_b16 v[236:237], v21 offset:0
    s_waitcnt vmcnt(5)
    ds_read_b64_tr_b16 v[238:239], v21 offset:2048
    s_add_u32 s3, s30, 3537920
    buffer_load_dwordx4 v1, s[8:11], s3 offen offset:1024 lds
    v_mfma_f32_16x16x32_bf16 v[188:191], v[232:235], v[224:227], v[188:191]
    ds_read_b128 v[224:227], v3 offset:38912
    s_waitcnt lgkmcnt(4)
    v_mfma_f32_16x16x32_bf16 v[192:195], v[244:247], v[240:243], v[192:195]
    v_mfma_f32_16x16x32_bf16 v[196:199], v[248:251], v[240:243], v[196:199]
    s_add_u32 m0, s29, 34816
    s_add_u32 s3, s30, 3440640
    buffer_load_dwordx4 v1, s[8:11], s3 offen lds
    v_mfma_f32_16x16x32_bf16 v[200:203], v[228:231], v[240:243], v[200:203]
    s_add_u32 s3, s30, 3570688
    buffer_load_dwordx4 v1, s[8:11], s3 offen offset:1024 lds
    v_mfma_f32_16x16x32_bf16 v[204:207], v[232:235], v[240:243], v[204:207]
    ds_read_b64_tr_b16 v[240:241], v22 offset:0
    ds_read_b64_tr_b16 v[242:243], v22 offset:2048
    s_waitcnt lgkmcnt(5)
    v_mfma_f32_16x16x32_bf16 v[208:211], v[244:247], v[252:255], v[208:211]
    ds_read_b64_tr_b16 v[244:245], v25 offset:0
    ds_read_b64_tr_b16 v[246:247], v25 offset:2048
    v_mfma_f32_16x16x32_bf16 v[212:215], v[248:251], v[252:255], v[212:215]
    ds_read_b64_tr_b16 v[248:249], v26 offset:0
    ds_read_b64_tr_b16 v[250:251], v26 offset:2048
    v_mfma_f32_16x16x32_bf16 v[216:219], v[228:231], v[252:255], v[216:219]
    ds_read_b128 v[228:231], v3 offset:39168
    v_mfma_f32_16x16x32_bf16 v[220:223], v[232:235], v[252:255], v[220:223]
    ds_read_b128 v[232:235], v4 offset:38912
    s_waitcnt lgkmcnt(8)
    v_mfma_f32_16x16x32_bf16 v[160:163], v[236:239], v[224:227], v[160:163]
    s_waitcnt lgkmcnt(6)
    v_mfma_f32_16x16x32_bf16 v[164:167], v[240:243], v[224:227], v[164:167]
    s_waitcnt lgkmcnt(4)
    v_mfma_f32_16x16x32_bf16 v[168:171], v[244:247], v[224:227], v[168:171]
    ds_read_b128 v[252:255], v4 offset:39168
    s_waitcnt lgkmcnt(3)
    v_mfma_f32_16x16x32_bf16 v[172:175], v[248:251], v[224:227], v[172:175]
    s_waitcnt lgkmcnt(2)
    v_mfma_f32_16x16x32_bf16 v[176:179], v[236:239], v[228:231], v[176:179]
    s_add_u32 m0, s29, 65536
    s_add_u32 s3, s30, 3670016
    buffer_load_dwordx4 v1, s[8:11], s3 offen lds
    v_mfma_f32_16x16x32_bf16 v[180:183], v[240:243], v[228:231], v[180:183]
    v_mfma_f32_16x16x32_bf16 v[184:187], v[244:247], v[228:231], v[184:187]
    s_waitcnt vmcnt(7)
    ds_read_b64_tr_b16 v[224:225], v5 offset:0
    s_waitcnt vmcnt(5)
    ds_read_b64_tr_b16 v[226:227], v5 offset:2048
    s_add_u32 s3, s30, 3800064
    buffer_load_dwordx4 v1, s[8:11], s3 offen offset:1024 lds
    v_mfma_f32_16x16x32_bf16 v[188:191], v[248:251], v[228:231], v[188:191]
    ds_read_b128 v[228:231], v3 offset:40960
    s_waitcnt lgkmcnt(4)
    v_mfma_f32_16x16x32_bf16 v[192:195], v[236:239], v[232:235], v[192:195]
    v_mfma_f32_16x16x32_bf16 v[196:199], v[240:243], v[232:235], v[196:199]
    s_add_u32 m0, s29, 67584
    s_add_u32 s3, s30, 3702784
    buffer_load_dwordx4 v1, s[8:11], s3 offen lds
    v_mfma_f32_16x16x32_bf16 v[200:203], v[244:247], v[232:235], v[200:203]
    s_add_u32 s3, s30, 3832832
    buffer_load_dwordx4 v1, s[8:11], s3 offen offset:1024 lds
    v_mfma_f32_16x16x32_bf16 v[204:207], v[248:251], v[232:235], v[204:207]
    ds_read_b64_tr_b16 v[232:233], v6 offset:0
    ds_read_b64_tr_b16 v[234:235], v6 offset:2048
    s_waitcnt lgkmcnt(5)
    v_mfma_f32_16x16x32_bf16 v[208:211], v[236:239], v[252:255], v[208:211]
    ds_read_b64_tr_b16 v[236:237], v7 offset:0
    ds_read_b64_tr_b16 v[238:239], v7 offset:2048
    v_mfma_f32_16x16x32_bf16 v[212:215], v[240:243], v[252:255], v[212:215]
    ds_read_b64_tr_b16 v[240:241], v8 offset:0
    ds_read_b64_tr_b16 v[242:243], v8 offset:2048
    v_mfma_f32_16x16x32_bf16 v[216:219], v[244:247], v[252:255], v[216:219]
    ds_read_b128 v[244:247], v3 offset:41216
    v_mfma_f32_16x16x32_bf16 v[220:223], v[248:251], v[252:255], v[220:223]
    ds_read_b128 v[248:251], v4 offset:40960
    s_setprio 0
    s_waitcnt lgkmcnt(8)
    v_mfma_f32_16x16x32_bf16 v[160:163], v[224:227], v[228:231], v[160:163]
    s_waitcnt lgkmcnt(6)
    v_mfma_f32_16x16x32_bf16 v[164:167], v[232:235], v[228:231], v[164:167]
    s_lshr_b32 s38, s2, 3
    s_cmp_eq_u32 s38, 2
    s_cselect_b32 s38, 1.0, 0
    s_waitcnt lgkmcnt(4)
    v_mfma_f32_16x16x32_bf16 v[168:171], v[236:239], v[228:231], v[168:171]
    s_cmp_lt_u32 s2, 32
    s_cselect_b64 s[40:41], -1, 0
    ds_read_b128 v[252:255], v4 offset:41216
    s_waitcnt lgkmcnt(3)
    v_mfma_f32_16x16x32_bf16 v[172:175], v[240:243], v[228:231], v[172:175]
    v_add_f32 v90, v90, v91
    s_waitcnt lgkmcnt(2)
    v_mfma_f32_16x16x32_bf16 v[176:179], v[224:227], v[244:247], v[176:179]
    v_add_f32 v92, v92, v93
    s_add_u32 m0, s29, 0
    s_add_u32 s3, s30, 3932160
    buffer_load_dwordx4 v1, s[8:11], s3 offen lds
    v_add_f32 v90, v90, v92
    v_mfma_f32_16x16x32_bf16 v[180:183], v[232:235], v[244:247], v[180:183]
    v_mfma_f32_16x16x32_bf16 v[184:187], v[236:239], v[244:247], v[184:187]
    v_cvt_pk_bf16_f32 v91, 0, v90
    s_waitcnt vmcnt(7)
    ds_read_b64_tr_b16 v[228:229], v5 offset:32768
    v_add_f32 v91, s38, v91
    s_waitcnt vmcnt(5)
    ds_read_b64_tr_b16 v[230:231], v5 offset:34816
    s_add_u32 s3, s30, 4062208
    buffer_load_dwordx4 v1, s[8:11], s3 offen offset:1024 lds
    v_cvt_pk_bf16_f32 v91, 0, v91
    v_mfma_f32_16x16x32_bf16 v[188:191], v[240:243], v[244:247], v[188:191]
    v_cndmask_b32 v90, v90, v91, s[40:41]
    ds_read_b128 v[244:247], v3 offset:43008
    buffer_store_dword v90, v20, s[16:19], s36 offen
    s_waitcnt lgkmcnt(4)
    v_mfma_f32_16x16x32_bf16 v[192:195], v[224:227], v[248:251], v[192:195]
    v_mfma_f32_16x16x32_bf16 v[196:199], v[232:235], v[248:251], v[196:199]
    s_add_u32 m0, s29, 2048
    s_add_u32 s3, s30, 3964928
    buffer_load_dwordx4 v1, s[8:11], s3 offen lds
    v_mfma_f32_16x16x32_bf16 v[200:203], v[236:239], v[248:251], v[200:203]
    s_add_u32 s3, s30, 4094976
    buffer_load_dwordx4 v1, s[8:11], s3 offen offset:1024 lds
    v_mfma_f32_16x16x32_bf16 v[204:207], v[240:243], v[248:251], v[204:207]
    ds_read_b64_tr_b16 v[248:249], v6 offset:32768
    ds_read_b64_tr_b16 v[250:251], v6 offset:34816
    s_waitcnt lgkmcnt(5)
    v_mfma_f32_16x16x32_bf16 v[208:211], v[224:227], v[252:255], v[208:211]
    ds_read_b64_tr_b16 v[224:225], v7 offset:32768
    ds_read_b64_tr_b16 v[226:227], v7 offset:34816
    v_mfma_f32_16x16x32_bf16 v[212:215], v[232:235], v[252:255], v[212:215]
    ds_read_b64_tr_b16 v[232:233], v8 offset:32768
    ds_read_b64_tr_b16 v[234:235], v8 offset:34816
    v_mfma_f32_16x16x32_bf16 v[216:219], v[236:239], v[252:255], v[216:219]
    ds_read_b128 v[236:239], v3 offset:43264
    v_mfma_f32_16x16x32_bf16 v[220:223], v[240:243], v[252:255], v[220:223]
    ds_read_b128 v[240:243], v4 offset:43008
    s_waitcnt lgkmcnt(8)
    v_mfma_f32_16x16x32_bf16 v[160:163], v[228:231], v[244:247], v[160:163]
    s_waitcnt lgkmcnt(6)
    v_mfma_f32_16x16x32_bf16 v[164:167], v[248:251], v[244:247], v[164:167]
    s_waitcnt lgkmcnt(4)
    v_mfma_f32_16x16x32_bf16 v[168:171], v[224:227], v[244:247], v[168:171]
    ds_read_b128 v[252:255], v4 offset:43264
    s_waitcnt lgkmcnt(3)
    v_mfma_f32_16x16x32_bf16 v[172:175], v[232:235], v[244:247], v[172:175]
    s_waitcnt lgkmcnt(2)
    v_mfma_f32_16x16x32_bf16 v[176:179], v[228:231], v[236:239], v[176:179]
    s_add_u32 m0, s29, 32768
    s_add_u32 s3, s31, 0
    buffer_load_dwordx4 v28, s[4:7], s3 offen offset:0 lds
    v_mfma_f32_16x16x32_bf16 v[180:183], v[248:251], v[236:239], v[180:183]
    v_mfma_f32_16x16x32_bf16 v[184:187], v[224:227], v[236:239], v[184:187]
    s_waitcnt vmcnt(8)
    ds_read_b64_tr_b16 v[244:245], v21 offset:0
    s_waitcnt vmcnt(6)
    ds_read_b64_tr_b16 v[246:247], v21 offset:2048
    buffer_load_dwordx4 v29, s[4:7], s3 offen offset:1024 lds
    v_mfma_f32_16x16x32_bf16 v[188:191], v[232:235], v[236:239], v[188:191]
    ds_read_b128 v[236:239], v3 offset:45056
    s_waitcnt lgkmcnt(4)
    v_mfma_f32_16x16x32_bf16 v[192:195], v[228:231], v[240:243], v[192:195]
    v_mfma_f32_16x16x32_bf16 v[196:199], v[248:251], v[240:243], v[196:199]
    s_add_u32 m0, s29, 32768
    s_add_u32 s3, s31, 0
    buffer_load_dwordx4 v30, s[4:7], s3 offen offset:2048 lds
    v_mfma_f32_16x16x32_bf16 v[200:203], v[224:227], v[240:243], v[200:203]
    buffer_load_dwordx4 v31, s[4:7], s3 offen offset:3072 lds
    v_mfma_f32_16x16x32_bf16 v[204:207], v[232:235], v[240:243], v[204:207]
    ds_read_b64_tr_b16 v[240:241], v22 offset:0
    ds_read_b64_tr_b16 v[242:243], v22 offset:2048
    s_waitcnt lgkmcnt(5)
    v_mfma_f32_16x16x32_bf16 v[208:211], v[228:231], v[252:255], v[208:211]
    ds_read_b64_tr_b16 v[228:229], v25 offset:0
    ds_read_b64_tr_b16 v[230:231], v25 offset:2048
    v_mfma_f32_16x16x32_bf16 v[212:215], v[248:251], v[252:255], v[212:215]
    ds_read_b64_tr_b16 v[248:249], v26 offset:0
    ds_read_b64_tr_b16 v[250:251], v26 offset:2048
    v_mfma_f32_16x16x32_bf16 v[216:219], v[224:227], v[252:255], v[216:219]
    ds_read_b128 v[224:227], v3 offset:45312
    v_mfma_f32_16x16x32_bf16 v[220:223], v[232:235], v[252:255], v[220:223]
    ds_read_b128 v[232:235], v4 offset:45056
    s_waitcnt lgkmcnt(8)
    v_mfma_f32_16x16x32_bf16 v[160:163], v[244:247], v[236:239], v[160:163]
    s_waitcnt lgkmcnt(6)
    v_mfma_f32_16x16x32_bf16 v[164:167], v[240:243], v[236:239], v[164:167]
    s_waitcnt lgkmcnt(4)
    v_mfma_f32_16x16x32_bf16 v[168:171], v[228:231], v[236:239], v[168:171]
    ds_read_b128 v[252:255], v4 offset:45312
    s_waitcnt lgkmcnt(3)
    v_mfma_f32_16x16x32_bf16 v[172:175], v[248:251], v[236:239], v[172:175]
    s_waitcnt lgkmcnt(2)
    v_mfma_f32_16x16x32_bf16 v[176:179], v[244:247], v[224:227], v[176:179]
    s_add_u32 m0, s29, 65536
    s_add_u32 s3, s33, 0
    buffer_load_dwordx4 v27, s[16:19], s3 offen offset:0 lds
    v_mfma_f32_16x16x32_bf16 v[180:183], v[240:243], v[224:227], v[180:183]
    v_mfma_f32_16x16x32_bf16 v[184:187], v[228:231], v[224:227], v[184:187]
    s_waitcnt vmcnt(8)
    ds_read_b64_tr_b16 v[236:237], v5 offset:0
    s_waitcnt vmcnt(5)
    ds_read_b64_tr_b16 v[238:239], v5 offset:2048
    buffer_load_dwordx4 v27, s[16:19], s3 offen offset:1024 lds
    v_mfma_f32_16x16x32_bf16 v[188:191], v[248:251], v[224:227], v[188:191]
    ds_read_b128 v[224:227], v4 offset:47104
    s_waitcnt lgkmcnt(4)
    v_mfma_f32_16x16x32_bf16 v[192:195], v[244:247], v[232:235], v[192:195]
    v_mfma_f32_16x16x32_bf16 v[196:199], v[240:243], v[232:235], v[196:199]
    s_add_u32 m0, s29, 65536
    s_add_u32 s3, s33, 0
    buffer_load_dwordx4 v27, s[16:19], s3 offen offset:2048 lds
    v_mfma_f32_16x16x32_bf16 v[200:203], v[228:231], v[232:235], v[200:203]
    buffer_load_dwordx4 v27, s[16:19], s3 offen offset:3072 lds
    v_mfma_f32_16x16x32_bf16 v[204:207], v[248:251], v[232:235], v[204:207]
    ds_read_b64_tr_b16 v[232:233], v6 offset:0
    ds_read_b64_tr_b16 v[234:235], v6 offset:2048
    s_waitcnt lgkmcnt(5)
    v_mfma_f32_16x16x32_bf16 v[208:211], v[244:247], v[252:255], v[208:211]
    ds_read_b64_tr_b16 v[244:245], v7 offset:0
    ds_read_b64_tr_b16 v[246:247], v7 offset:2048
    v_mfma_f32_16x16x32_bf16 v[212:215], v[240:243], v[252:255], v[212:215]
    ds_read_b64_tr_b16 v[240:241], v8 offset:0
    ds_read_b64_tr_b16 v[242:243], v8 offset:2048
    v_mfma_f32_16x16x32_bf16 v[216:219], v[228:231], v[252:255], v[216:219]
    ds_read_b128 v[228:231], v4 offset:47360
    v_mfma_f32_16x16x32_bf16 v[220:223], v[248:251], v[252:255], v[220:223]
    ds_read_b128 v[248:251], v3 offset:47104
    s_waitcnt lgkmcnt(8)
    v_mfma_f32_16x16x32_bf16 v[192:195], v[236:239], v[224:227], v[192:195]
    s_waitcnt lgkmcnt(6)
    v_mfma_f32_16x16x32_bf16 v[196:199], v[232:235], v[224:227], v[196:199]
    s_waitcnt lgkmcnt(4)
    v_mfma_f32_16x16x32_bf16 v[200:203], v[244:247], v[224:227], v[200:203]
    ds_read_b128 v[252:255], v3 offset:47360
    s_waitcnt lgkmcnt(3)
    v_mfma_f32_16x16x32_bf16 v[204:207], v[240:243], v[224:227], v[204:207]
    s_waitcnt lgkmcnt(2)
    v_mfma_f32_16x16x32_bf16 v[208:211], v[236:239], v[228:231], v[208:211]
    v_mfma_f32_16x16x32_bf16 v[212:215], v[232:235], v[228:231], v[212:215]
    v_mfma_f32_16x16x32_bf16 v[216:219], v[244:247], v[228:231], v[216:219]
    v_mfma_f32_16x16x32_bf16 v[220:223], v[240:243], v[228:231], v[220:223]
    s_waitcnt lgkmcnt(1)
    v_mfma_f32_16x16x32_bf16 v[160:163], v[236:239], v[248:251], v[160:163]
    v_mfma_f32_16x16x32_bf16 v[164:167], v[232:235], v[248:251], v[164:167]
    v_mfma_f32_16x16x32_bf16 v[168:171], v[244:247], v[248:251], v[168:171]
    v_mfma_f32_16x16x32_bf16 v[172:175], v[240:243], v[248:251], v[172:175]
    s_waitcnt lgkmcnt(0)
    v_mfma_f32_16x16x32_bf16 v[176:179], v[236:239], v[252:255], v[176:179]
    v_mfma_f32_16x16x32_bf16 v[180:183], v[232:235], v[252:255], v[180:183]
    v_mfma_f32_16x16x32_bf16 v[184:187], v[244:247], v[252:255], v[184:187]
    v_mfma_f32_16x16x32_bf16 v[188:191], v[240:243], v[252:255], v[188:191]
    s_load_dwordx8 s[56:63], s[0:1], 48
    v_add_u32 v17, s29, v27
    v_xor_b32 v18, 0x1000, v17
    v_cvt_pk_bf16_f32 v64, v192, v193
    v_cvt_pk_bf16_f32 v65, v194, v195
    v_cvt_pk_bf16_f32 v66, v208, v209
    v_cvt_pk_bf16_f32 v67, v210, v211
    v_cvt_pk_bf16_f32 v68, v196, v197
    v_cvt_pk_bf16_f32 v69, v198, v199
    v_cvt_pk_bf16_f32 v70, v212, v213
    v_cvt_pk_bf16_f32 v71, v214, v215
    v_permlane16_swap_b32 v64, v66
    v_permlane16_swap_b32 v65, v67
    ds_write_b128 v17, v[64:67] offset:0
    v_cvt_pk_bf16_f32 v72, v200, v201
    v_cvt_pk_bf16_f32 v73, v202, v203
    v_cvt_pk_bf16_f32 v74, v216, v217
    v_cvt_pk_bf16_f32 v75, v218, v219
    v_permlane16_swap_b32 v68, v70
    v_permlane16_swap_b32 v69, v71
    ds_write_b128 v17, v[68:71] offset:1024
    v_cvt_pk_bf16_f32 v76, v204, v205
    v_cvt_pk_bf16_f32 v77, v206, v207
    v_cvt_pk_bf16_f32 v78, v220, v221
    v_cvt_pk_bf16_f32 v79, v222, v223
    v_permlane16_swap_b32 v72, v74
    v_permlane16_swap_b32 v73, v75
    ds_write_b128 v17, v[72:75] offset:2048
    v_permlane16_swap_b32 v76, v78
    v_permlane16_swap_b32 v77, v79
    ds_write_b128 v17, v[76:79] offset:3072
    v_cvt_pk_bf16_f32 v32, v160, v161
    v_cvt_pk_bf16_f32 v33, v162, v163
    v_cvt_pk_bf16_f32 v34, v176, v177
    v_cvt_pk_bf16_f32 v35, v178, v179
    v_cvt_pk_bf16_f32 v36, v164, v165
    v_cvt_pk_bf16_f32 v37, v166, v167
    v_cvt_pk_bf16_f32 v38, v180, v181
    v_cvt_pk_bf16_f32 v39, v182, v183
    v_cvt_pk_bf16_f32 v40, v168, v169
    v_cvt_pk_bf16_f32 v41, v170, v171
    v_cvt_pk_bf16_f32 v42, v184, v185
    v_cvt_pk_bf16_f32 v43, v186, v187
    v_cvt_pk_bf16_f32 v44, v172, v173
    v_cvt_pk_bf16_f32 v45, v174, v175
    v_cvt_pk_bf16_f32 v46, v188, v189
    v_cvt_pk_bf16_f32 v47, v190, v191
    v_permlane16_swap_b32 v32, v34
    v_permlane16_swap_b32 v33, v35
    v_permlane16_swap_b32 v36, v38
    v_permlane16_swap_b32 v37, v39
    v_permlane16_swap_b32 v40, v42
    v_permlane16_swap_b32 v41, v43
    v_permlane16_swap_b32 v44, v46
    v_permlane16_swap_b32 v45, v47
    s_mov_b32 s51, 0x3e0293ee
    v_mov_b32 v23, 0
    v_mov_b32 v24, 0
    v_mov_b32 v25, 0
    v_mov_b32 v26, 0
    s_waitcnt vmcnt(4) lgkmcnt(0)
    s_barrier
    ds_read_b128 v[224:227], v9 offset:0
    ds_read_b128 v[228:231], v10 offset:0
    ds_read_b128 v[232:235], v11 offset:0
    ds_read_b128 v[236:239], v12 offset:0
    ds_read_b128 v[240:243], v13 offset:0
    ds_read_b128 v[48:51], v18 offset:0
    ds_read_b128 v[244:247], v14 offset:0
    ds_read_b128 v[52:55], v18 offset:1024
    ds_read_b128 v[248:251], v15 offset:0
    ds_read_b128 v[56:59], v18 offset:2048
    ds_read_b128 v[252:255], v16 offset:0
    ds_read_b128 v[60:63], v18 offset:3072
    s_add_u32 m0, s29, 98304
    s_add_u32 s3, s31, 32768
    buffer_load_dwordx4 v28, s[4:7], s3 offen offset:0 lds
    buffer_load_dwordx4 v29, s[4:7], s3 offen offset:1024 lds
    buffer_load_dwordx4 v30, s[4:7], s3 offen offset:2048 lds
    buffer_load_dwordx4 v31, s[4:7], s3 offen offset:3072 lds
    s_add_u32 m0, s29, 131072
    s_waitcnt lgkmcnt(11)
    v_mfma_f32_32x32x16_bf16 v[64:79], v[224:227], v[32:35], 0
    ds_read_b128 v[224:227], v9 offset:8192
    s_add_u32 s3, s33, 32768
    s_waitcnt lgkmcnt(11)
    v_mfma_f32_32x32x16_bf16 v[64:79], v[228:231], v[36:39], v[64:79]
    ds_read_b128 v[228:231], v10 offset:8192
    buffer_load_dwordx4 v27, s[16:19], s3 offen offset:0 lds
    s_waitcnt lgkmcnt(11)
    v_mfma_f32_32x32x16_bf16 v[64:79], v[232:235], v[40:43], v[64:79]
    ds_read_b128 v[232:235], v11 offset:8192
    buffer_load_dwordx4 v27, s[16:19], s3 offen offset:1024 lds
    buffer_load_dwordx4 v27, s[16:19], s3 offen offset:2048 lds
    s_waitcnt lgkmcnt(11)
    v_mfma_f32_32x32x16_bf16 v[64:79], v[236:239], v[44:47], v[64:79]
    ds_read_b128 v[236:239], v12 offset:8192
    buffer_load_dwordx4 v27, s[16:19], s3 offen offset:3072 lds
    s_waitcnt lgkmcnt(10)
    v_mfma_f32_32x32x16_bf16 v[64:79], v[240:243], v[48:51], v[64:79]
    ds_read_b128 v[240:243], v13 offset:8192
    v_lshlrev_b32 v19, 1, v27
    s_waitcnt lgkmcnt(9)
    v_mfma_f32_32x32x16_bf16 v[64:79], v[244:247], v[52:55], v[64:79]
    ds_read_b128 v[244:247], v14 offset:8192
    s_lshl_b32 s34, s25, 19
    s_waitcnt lgkmcnt(8)
    v_mfma_f32_32x32x16_bf16 v[64:79], v[248:251], v[56:59], v[64:79]
    ds_read_b128 v[248:251], v15 offset:8192
    s_lshl_b32 s35, s26, 14
    s_add_u32 s34, s34, s35
    s_waitcnt lgkmcnt(7)
    v_mfma_f32_32x32x16_bf16 v[64:79], v[252:255], v[60:63], v[64:79]
    ds_read_b128 v[252:255], v16 offset:8192
    s_lshl_b32 s35, s24, 11
    s_waitcnt lgkmcnt(7)
    v_mfma_f32_32x32x16_bf16 v[80:95], v[224:227], v[32:35], 0
    ds_read_b128 v[224:227], v9 offset:16384
    s_add_u32 s34, s34, s35
    s_waitcnt lgkmcnt(7)
    v_mfma_f32_32x32x16_bf16 v[80:95], v[228:231], v[36:39], v[80:95]
    ds_read_b128 v[228:231], v10 offset:16384
    buffer_load_dword v19, v19, s[12:15], s34 offen
    s_nop 1
    v_max_f32 v17, v64, v65
    s_waitcnt lgkmcnt(7)
    v_mfma_f32_32x32x16_bf16 v[80:95], v[232:235], v[40:43], v[80:95]
    ds_read_b128 v[232:235], v11 offset:16384
    v_max3_f32 v17, v66, v67, v17
    s_waitcnt lgkmcnt(7)
    v_mfma_f32_32x32x16_bf16 v[80:95], v[236:239], v[44:47], v[80:95]
    ds_read_b128 v[236:239], v12 offset:16384
    v_max3_f32 v17, v68, v69, v17
    s_waitcnt lgkmcnt(7)
    v_mfma_f32_32x32x16_bf16 v[80:95], v[240:243], v[48:51], v[80:95]
    ds_read_b128 v[240:243], v13 offset:16384
    v_max3_f32 v17, v70, v71, v17
    v_max3_f32 v17, v72, v73, v17
    s_waitcnt lgkmcnt(7)
    v_mfma_f32_32x32x16_bf16 v[80:95], v[244:247], v[52:55], v[80:95]
    ds_read_b128 v[244:247], v14 offset:16384
    v_max3_f32 v17, v74, v75, v17
    s_waitcnt lgkmcnt(7)
    v_mfma_f32_32x32x16_bf16 v[80:95], v[248:251], v[56:59], v[80:95]
    ds_read_b128 v[248:251], v15 offset:16384
    v_max3_f32 v17, v76, v77, v17
    s_waitcnt lgkmcnt(7)
    v_mfma_f32_32x32x16_bf16 v[80:95], v[252:255], v[60:63], v[80:95]
    ds_read_b128 v[252:255], v16 offset:16384
    v_max3_f32 v17, v78, v79, v17
    s_nop 9
    v_max3_f32 v17, v80, v81, v17
    v_max3_f32 v17, v82, v83, v17
    v_max3_f32 v17, v84, v85, v17
    v_max3_f32 v17, v86, v87, v17
    v_max3_f32 v17, v88, v89, v17
    v_max3_f32 v17, v90, v91, v17
    v_max3_f32 v17, v92, v93, v17
    v_max3_f32 v17, v94, v95, v17
    v_mov_b32 v18, v17
    s_nop 1
    v_permlane32_swap_b32 v17, v18
    v_max_f32 v17, v17, v18
    v_mul_f32 v22, s51, v17
    v_sub_f32 v22, 0xc2d40000, v22
    v_fma_f32 v64, v64, s51, v22
    v_fma_f32 v65, v65, s51, v22
    s_waitcnt lgkmcnt(7)
    v_mfma_f32_32x32x16_bf16 v[96:111], v[224:227], v[32:35], 0
    ds_read_b128 v[224:227], v9 offset:24576
    v_fma_f32 v66, v66, s51, v22
    v_fma_f32 v67, v67, s51, v22
    v_fma_f32 v68, v68, s51, v22
    v_fma_f32 v69, v69, s51, v22
    v_fma_f32 v70, v70, s51, v22
    s_waitcnt lgkmcnt(7)
    v_mfma_f32_32x32x16_bf16 v[96:111], v[228:231], v[36:39], v[96:111]
    ds_read_b128 v[228:231], v10 offset:24576
    v_fma_f32 v71, v71, s51, v22
    v_exp_f32 v64, v64
    v_exp_f32 v65, v65
    v_exp_f32 v66, v66
    s_waitcnt lgkmcnt(7)
    v_mfma_f32_32x32x16_bf16 v[96:111], v[232:235], v[40:43], v[96:111]
    ds_read_b128 v[232:235], v11 offset:24576
    v_exp_f32 v67, v67
    v_exp_f32 v68, v68
    v_exp_f32 v69, v69
    v_exp_f32 v70, v70
    s_waitcnt lgkmcnt(7)
    v_mfma_f32_32x32x16_bf16 v[96:111], v[236:239], v[44:47], v[96:111]
    ds_read_b128 v[236:239], v12 offset:24576
    v_exp_f32 v71, v71
    v_add_f32 v23, v23, v64
    v_add_f32 v23, v23, v65
    v_cvt_pk_bf16_f32 v64, v64, v65
    v_add_f32 v24, v24, v66
    s_waitcnt lgkmcnt(7)
    v_mfma_f32_32x32x16_bf16 v[96:111], v[240:243], v[48:51], v[96:111]
    ds_read_b128 v[240:243], v13 offset:24576
    v_add_f32 v24, v24, v67
    v_cvt_pk_bf16_f32 v65, v66, v67
    v_add_f32 v25, v25, v68
    v_add_f32 v25, v25, v69
    s_waitcnt lgkmcnt(7)
    v_mfma_f32_32x32x16_bf16 v[96:111], v[244:247], v[52:55], v[96:111]
    ds_read_b128 v[244:247], v14 offset:24576
    v_cvt_pk_bf16_f32 v66, v68, v69
    v_add_f32 v26, v26, v70
    v_add_f32 v26, v26, v71
    v_cvt_pk_bf16_f32 v67, v70, v71
    s_waitcnt lgkmcnt(7)
    v_mfma_f32_32x32x16_bf16 v[96:111], v[248:251], v[56:59], v[96:111]
    ds_read_b128 v[248:251], v15 offset:24576
    v_fma_f32 v72, v72, s51, v22
    v_fma_f32 v73, v73, s51, v22
    v_fma_f32 v74, v74, s51, v22
    v_fma_f32 v75, v75, s51, v22
    v_fma_f32 v76, v76, s51, v22
    s_waitcnt lgkmcnt(7)
    v_mfma_f32_32x32x16_bf16 v[96:111], v[252:255], v[60:63], v[96:111]
    ds_read_b128 v[252:255], v16 offset:24576
    v_fma_f32 v77, v77, s51, v22
    v_fma_f32 v78, v78, s51, v22
    s_waitcnt vmcnt(5)
    s_barrier
    v_fma_f32 v79, v79, s51, v22
    v_exp_f32 v72, v72
    s_add_u32 m0, s29, 0
    s_waitcnt lgkmcnt(7)
    v_mfma_f32_32x32x16_bf16 v[112:127], v[224:227], v[32:35], 0
    v_add_u32 v9, 65536, v9
    ds_read_b128 v[224:227], v9 offset:0
    v_exp_f32 v73, v73
    v_exp_f32 v74, v74
    v_exp_f32 v75, v75
    s_add_u32 s3, s31, 65536
    v_exp_f32 v76, v76
    v_exp_f32 v77, v77
    s_waitcnt lgkmcnt(7)
    v_mfma_f32_32x32x16_bf16 v[112:127], v[228:231], v[36:39], v[112:127]
    v_add_u32 v10, 65536, v10
    ds_read_b128 v[228:231], v10 offset:0
    v_exp_f32 v78, v78
    buffer_load_dwordx4 v28, s[4:7], s3 offen offset:0 lds
    v_exp_f32 v79, v79
    v_add_f32 v23, v23, v72
    v_add_f32 v23, v23, v73
    s_waitcnt lgkmcnt(7)
    v_mfma_f32_32x32x16_bf16 v[112:127], v[232:235], v[40:43], v[112:127]
    v_add_u32 v11, 65536, v11
    ds_read_b128 v[232:235], v11 offset:0
    buffer_load_dwordx4 v29, s[4:7], s3 offen offset:1024 lds
    v_cvt_pk_bf16_f32 v72, v72, v73
    v_add_f32 v24, v24, v74
    v_add_f32 v24, v24, v75
    buffer_load_dwordx4 v30, s[4:7], s3 offen offset:2048 lds
    v_cvt_pk_bf16_f32 v73, v74, v75
    s_waitcnt lgkmcnt(7)
    v_mfma_f32_32x32x16_bf16 v[112:127], v[236:239], v[44:47], v[112:127]
    v_add_u32 v12, 65536, v12
    ds_read_b128 v[236:239], v12 offset:0
    v_add_f32 v25, v25, v76
    v_add_f32 v25, v25, v77
    buffer_load_dwordx4 v31, s[4:7], s3 offen offset:3072 lds
    v_cvt_pk_bf16_f32 v74, v76, v77
    v_add_f32 v26, v26, v78
    v_add_f32 v26, v26, v79
    s_waitcnt lgkmcnt(7)
    v_mfma_f32_32x32x16_bf16 v[112:127], v[240:243], v[48:51], v[112:127]
    v_add_u32 v13, 65536, v13
    ds_read_b128 v[240:243], v13 offset:0
    v_cvt_pk_bf16_f32 v75, v78, v79
    v_add_u32 v20, 65536, v27
    v_fma_f32 v80, v80, s51, v22
    v_fma_f32 v81, v81, s51, v22
    v_fma_f32 v82, v82, s51, v22
    ds_read_b128 v[128:131], v20 offset:0
    s_waitcnt lgkmcnt(8)
    v_mfma_f32_32x32x16_bf16 v[112:127], v[244:247], v[52:55], v[112:127]
    v_add_u32 v14, 65536, v14
    ds_read_b128 v[244:247], v14 offset:0
    v_fma_f32 v83, v83, s51, v22
    v_fma_f32 v84, v84, s51, v22
    v_fma_f32 v85, v85, s51, v22
    ds_read_b128 v[132:135], v20 offset:1024
    v_fma_f32 v86, v86, s51, v22
    s_waitcnt lgkmcnt(9)
    v_mfma_f32_32x32x16_bf16 v[112:127], v[248:251], v[56:59], v[112:127]
    v_add_u32 v15, 65536, v15
    ds_read_b128 v[248:251], v15 offset:0
    v_fma_f32 v87, v87, s51, v22
    v_exp_f32 v80, v80
    ds_read_b128 v[136:139], v20 offset:2048
    v_exp_f32 v81, v81
    v_exp_f32 v82, v82
    v_exp_f32 v83, v83
    s_waitcnt lgkmcnt(10)
    v_mfma_f32_32x32x16_bf16 v[112:127], v[252:255], v[60:63], v[112:127]
    v_add_u32 v16, 65536, v16
    ds_read_b128 v[252:255], v16 offset:0
    ds_read_b128 v[140:143], v20 offset:3072
    v_exp_f32 v84, v84
    v_exp_f32 v85, v85
    v_exp_f32 v86, v86
    v_exp_f32 v87, v87
    s_waitcnt lgkmcnt(6)
    v_mfma_f32_32x32x16_bf16 v[160:175], v[128:131], v[64:67], 0
    ds_read_b128 v[144:147], v20 offset:4096
    v_add_f32 v23, v23, v80
    v_add_f32 v23, v23, v81
    v_cvt_pk_bf16_f32 v80, v80, v81
    v_add_f32 v24, v24, v82
    v_add_f32 v24, v24, v83
    s_waitcnt lgkmcnt(5)
    v_mfma_f32_32x32x16_bf16 v[176:191], v[132:135], v[64:67], 0
    ds_read_b128 v[148:151], v20 offset:5120
    v_cvt_pk_bf16_f32 v81, v82, v83
    v_add_f32 v25, v25, v84
    v_add_f32 v25, v25, v85
    v_cvt_pk_bf16_f32 v82, v84, v85
    s_waitcnt lgkmcnt(4)
    v_mfma_f32_32x32x16_bf16 v[192:207], v[136:139], v[64:67], 0
    ds_read_b128 v[152:155], v20 offset:6144
    v_add_f32 v26, v26, v86
    v_add_f32 v26, v26, v87
    v_cvt_pk_bf16_f32 v83, v86, v87
    v_fma_f32 v88, v88, s51, v22
    v_fma_f32 v89, v89, s51, v22
    s_waitcnt lgkmcnt(3)
    v_mfma_f32_32x32x16_bf16 v[208:223], v[140:143], v[64:67], 0
    ds_read_b128 v[156:159], v20 offset:7168
    v_fma_f32 v90, v90, s51, v22
    v_fma_f32 v91, v91, s51, v22
    v_fma_f32 v92, v92, s51, v22
    v_fma_f32 v93, v93, s51, v22
    s_waitcnt lgkmcnt(3)
    v_mfma_f32_32x32x16_bf16 v[160:175], v[144:147], v[72:75], v[160:175]
    ds_read_b128 v[128:131], v20 offset:8192
    v_fma_f32 v94, v94, s51, v22
    v_fma_f32 v95, v95, s51, v22
    v_exp_f32 v88, v88
    v_exp_f32 v89, v89
    v_exp_f32 v90, v90
    s_waitcnt lgkmcnt(3)
    v_mfma_f32_32x32x16_bf16 v[176:191], v[148:151], v[72:75], v[176:191]
    ds_read_b128 v[132:135], v20 offset:9216
    v_exp_f32 v91, v91
    v_exp_f32 v92, v92
    v_exp_f32 v93, v93
    v_exp_f32 v94, v94
    s_waitcnt lgkmcnt(3)
    v_mfma_f32_32x32x16_bf16 v[192:207], v[152:155], v[72:75], v[192:207]
    ds_read_b128 v[136:139], v20 offset:10240
    v_exp_f32 v95, v95
    v_add_f32 v23, v23, v88
    v_add_f32 v23, v23, v89
    v_cvt_pk_bf16_f32 v88, v88, v89
    v_add_f32 v24, v24, v90
    s_waitcnt lgkmcnt(3)
    v_mfma_f32_32x32x16_bf16 v[208:223], v[156:159], v[72:75], v[208:223]
    ds_read_b128 v[140:143], v20 offset:11264
    v_add_f32 v24, v24, v91
    v_cvt_pk_bf16_f32 v89, v90, v91
    v_add_f32 v25, v25, v92
    v_add_f32 v25, v25, v93
    s_waitcnt lgkmcnt(3)
    v_mfma_f32_32x32x16_bf16 v[160:175], v[128:131], v[80:83], v[160:175]
    ds_read_b128 v[144:147], v20 offset:12288
    v_cvt_pk_bf16_f32 v90, v92, v93
    v_add_f32 v26, v26, v94
    v_add_f32 v26, v26, v95
    v_cvt_pk_bf16_f32 v91, v94, v95
    s_waitcnt lgkmcnt(3)
    v_mfma_f32_32x32x16_bf16 v[176:191], v[132:135], v[80:83], v[176:191]
    ds_read_b128 v[148:151], v20 offset:13312
    v_fma_f32 v96, v96, s51, v22
    v_fma_f32 v97, v97, s51, v22
    v_fma_f32 v98, v98, s51, v22
    v_fma_f32 v99, v99, s51, v22
    s_waitcnt lgkmcnt(3)
    v_mfma_f32_32x32x16_bf16 v[192:207], v[136:139], v[80:83], v[192:207]
    ds_read_b128 v[152:155], v20 offset:14336
    v_fma_f32 v100, v100, s51, v22
    v_fma_f32 v101, v101, s51, v22
    v_fma_f32 v102, v102, s51, v22
    v_fma_f32 v103, v103, s51, v22
    s_waitcnt lgkmcnt(3)
    v_mfma_f32_32x32x16_bf16 v[208:223], v[140:143], v[80:83], v[208:223]
    ds_read_b128 v[156:159], v20 offset:15360
    v_exp_f32 v96, v96
    v_exp_f32 v97, v97
    v_exp_f32 v98, v98
    v_exp_f32 v99, v99
    s_waitcnt lgkmcnt(3)
    v_mfma_f32_32x32x16_bf16 v[160:175], v[144:147], v[88:91], v[160:175]
    ds_read_b128 v[128:131], v20 offset:16384
    v_exp_f32 v100, v100
    v_exp_f32 v101, v101
    v_exp_f32 v102, v102
    v_exp_f32 v103, v103
    v_add_f32 v23, v23, v96
    s_waitcnt lgkmcnt(3)
    v_mfma_f32_32x32x16_bf16 v[176:191], v[148:151], v[88:91], v[176:191]
    ds_read_b128 v[132:135], v20 offset:17408
    v_add_f32 v23, v23, v97
    v_cvt_pk_bf16_f32 v96, v96, v97
    v_add_f32 v24, v24, v98
    v_add_f32 v24, v24, v99
    s_waitcnt lgkmcnt(3)
    v_mfma_f32_32x32x16_bf16 v[192:207], v[152:155], v[88:91], v[192:207]
    ds_read_b128 v[136:139], v20 offset:18432
    v_cvt_pk_bf16_f32 v97, v98, v99
    v_add_f32 v25, v25, v100
    v_add_f32 v25, v25, v101
    v_cvt_pk_bf16_f32 v98, v100, v101
    v_add_f32 v26, v26, v102
    s_waitcnt lgkmcnt(3)
    v_mfma_f32_32x32x16_bf16 v[208:223], v[156:159], v[88:91], v[208:223]
    ds_read_b128 v[140:143], v20 offset:19456
    v_add_f32 v26, v26, v103
    v_cvt_pk_bf16_f32 v99, v102, v103
    s_waitcnt vmcnt(5)
    s_barrier
    v_fma_f32 v104, v104, s51, v22
    v_fma_f32 v105, v105, s51, v22
    v_mfma_f32_32x32x16_bf16 v[64:79], v[224:227], v[32:35], 0
    ds_read_b128 v[224:227], v9 offset:8192
    v_fma_f32 v106, v106, s51, v22
    v_fma_f32 v107, v107, s51, v22
    v_fma_f32 v108, v108, s51, v22
    s_add_u32 m0, s29, 32768
    v_mfma_f32_32x32x16_bf16 v[64:79], v[228:231], v[36:39], v[64:79]
    ds_read_b128 v[228:231], v10 offset:8192
    v_fma_f32 v109, v109, s51, v22
    v_fma_f32 v110, v110, s51, v22
    v_fma_f32 v111, v111, s51, v22
    v_exp_f32 v104, v104
    v_mfma_f32_32x32x16_bf16 v[64:79], v[232:235], v[40:43], v[64:79]
    ds_read_b128 v[232:235], v11 offset:8192
    v_exp_f32 v105, v105
    v_exp_f32 v106, v106
    v_exp_f32 v107, v107
    v_mfma_f32_32x32x16_bf16 v[64:79], v[236:239], v[44:47], v[64:79]
    ds_read_b128 v[236:239], v12 offset:8192
    v_exp_f32 v108, v108
    v_exp_f32 v109, v109
    s_add_u32 s3, s33, 65536
    v_exp_f32 v110, v110
    v_exp_f32 v111, v111
    v_mfma_f32_32x32x16_bf16 v[64:79], v[240:243], v[48:51], v[64:79]
    ds_read_b128 v[240:243], v13 offset:8192
    v_add_f32 v23, v23, v104
    v_add_f32 v23, v23, v105
    v_cvt_pk_bf16_f32 v104, v104, v105
    v_mfma_f32_32x32x16_bf16 v[64:79], v[244:247], v[52:55], v[64:79]
    ds_read_b128 v[244:247], v14 offset:8192
    v_add_f32 v24, v24, v106
    v_add_f32 v24, v24, v107
    v_cvt_pk_bf16_f32 v105, v106, v107
    v_add_f32 v25, v25, v108
    v_mfma_f32_32x32x16_bf16 v[64:79], v[248:251], v[56:59], v[64:79]
    ds_read_b128 v[248:251], v15 offset:8192
    buffer_load_dwordx4 v27, s[16:19], s3 offen offset:0 lds
    v_add_f32 v25, v25, v109
    v_cvt_pk_bf16_f32 v106, v108, v109
    v_add_f32 v26, v26, v110
    v_mfma_f32_32x32x16_bf16 v[64:79], v[252:255], v[60:63], v[64:79]
    ds_read_b128 v[252:255], v16 offset:8192
    v_add_f32 v26, v26, v111
    v_cvt_pk_bf16_f32 v107, v110, v111
    v_fma_f32 v112, v112, s51, v22
    v_fma_f32 v113, v113, s51, v22
    s_waitcnt lgkmcnt(7)
    v_mfma_f32_32x32x16_bf16 v[80:95], v[224:227], v[32:35], 0
    ds_read_b128 v[224:227], v9 offset:16384
    v_fma_f32 v114, v114, s51, v22
    v_fma_f32 v115, v115, s51, v22
    v_fma_f32 v116, v116, s51, v22
    buffer_load_dwordx4 v27, s[16:19], s3 offen offset:1024 lds
    s_waitcnt lgkmcnt(7)
    v_mfma_f32_32x32x16_bf16 v[80:95], v[228:231], v[36:39], v[80:95]
    ds_read_b128 v[228:231], v10 offset:16384
    v_fma_f32 v117, v117, s51, v22
    v_fma_f32 v118, v118, s51, v22
    v_fma_f32 v119, v119, s51, v22
    v_exp_f32 v112, v112
    s_waitcnt lgkmcnt(7)
    v_mfma_f32_32x32x16_bf16 v[80:95], v[232:235], v[40:43], v[80:95]
    ds_read_b128 v[232:235], v11 offset:16384
    v_exp_f32 v113, v113
    v_exp_f32 v114, v114
    v_exp_f32 v115, v115
    s_waitcnt lgkmcnt(7)
    v_mfma_f32_32x32x16_bf16 v[80:95], v[236:239], v[44:47], v[80:95]
    ds_read_b128 v[236:239], v12 offset:16384
    v_exp_f32 v116, v116
    v_exp_f32 v117, v117
    buffer_load_dwordx4 v27, s[16:19], s3 offen offset:2048 lds
    v_exp_f32 v118, v118
    v_exp_f32 v119, v119
    s_waitcnt lgkmcnt(7)
    v_mfma_f32_32x32x16_bf16 v[80:95], v[240:243], v[48:51], v[80:95]
    ds_read_b128 v[240:243], v13 offset:16384
    v_add_f32 v23, v23, v112
    v_add_f32 v23, v23, v113
    v_cvt_pk_bf16_f32 v112, v112, v113
    s_waitcnt lgkmcnt(7)
    v_mfma_f32_32x32x16_bf16 v[80:95], v[244:247], v[52:55], v[80:95]
    ds_read_b128 v[244:247], v14 offset:16384
    v_add_f32 v24, v24, v114
    v_add_f32 v24, v24, v115
    v_cvt_pk_bf16_f32 v113, v114, v115
    v_add_f32 v25, v25, v116
    s_waitcnt lgkmcnt(7)
    v_mfma_f32_32x32x16_bf16 v[80:95], v[248:251], v[56:59], v[80:95]
    ds_read_b128 v[248:251], v15 offset:16384
    buffer_load_dwordx4 v27, s[16:19], s3 offen offset:3072 lds
    v_add_f32 v25, v25, v117
    v_cvt_pk_bf16_f32 v114, v116, v117
    v_add_f32 v26, v26, v118
    s_waitcnt lgkmcnt(7)
    v_mfma_f32_32x32x16_bf16 v[80:95], v[252:255], v[60:63], v[80:95]
    ds_read_b128 v[252:255], v16 offset:16384
    v_add_f32 v26, v26, v119
    v_cvt_pk_bf16_f32 v115, v118, v119
    v_fma_f32 v120, v120, s51, v22
    v_fma_f32 v121, v121, s51, v22
    v_mfma_f32_32x32x16_bf16 v[160:175], v[128:131], v[96:99], v[160:175]
    ds_read_b128 v[144:147], v20 offset:20480
    v_fma_f32 v122, v122, s51, v22
    v_fma_f32 v123, v123, s51, v22
    v_fma_f32 v124, v124, s51, v22
    v_mfma_f32_32x32x16_bf16 v[176:191], v[132:135], v[96:99], v[176:191]
    ds_read_b128 v[148:151], v20 offset:21504
    v_fma_f32 v125, v125, s51, v22
    v_fma_f32 v126, v126, s51, v22
    v_fma_f32 v127, v127, s51, v22
    v_exp_f32 v120, v120
    v_mfma_f32_32x32x16_bf16 v[192:207], v[136:139], v[96:99], v[192:207]
    ds_read_b128 v[152:155], v20 offset:22528
    v_exp_f32 v121, v121
    v_exp_f32 v122, v122
    v_exp_f32 v123, v123
    v_mfma_f32_32x32x16_bf16 v[208:223], v[140:143], v[96:99], v[208:223]
    ds_read_b128 v[156:159], v20 offset:23552
    v_exp_f32 v124, v124
    v_exp_f32 v125, v125
    v_exp_f32 v126, v126
    v_exp_f32 v127, v127
    s_waitcnt lgkmcnt(3)
    v_mfma_f32_32x32x16_bf16 v[160:175], v[144:147], v[104:107], v[160:175]
    ds_read_b128 v[128:131], v20 offset:24576
    v_add_f32 v23, v23, v120
    v_add_f32 v23, v23, v121
    v_cvt_pk_bf16_f32 v120, v120, v121
    s_waitcnt lgkmcnt(3)
    v_mfma_f32_32x32x16_bf16 v[176:191], v[148:151], v[104:107], v[176:191]
    ds_read_b128 v[132:135], v20 offset:25600
    v_add_f32 v24, v24, v122
    v_add_f32 v24, v24, v123
    v_cvt_pk_bf16_f32 v121, v122, v123
    v_add_f32 v25, v25, v124
    s_waitcnt lgkmcnt(3)
    v_mfma_f32_32x32x16_bf16 v[192:207], v[152:155], v[104:107], v[192:207]
    ds_read_b128 v[136:139], v20 offset:26624
    v_add_f32 v25, v25, v125
    v_cvt_pk_bf16_f32 v122, v124, v125
    v_add_f32 v26, v26, v126
    s_waitcnt lgkmcnt(3)
    v_mfma_f32_32x32x16_bf16 v[208:223], v[156:159], v[104:107], v[208:223]
    ds_read_b128 v[140:143], v20 offset:27648
    v_add_f32 v26, v26, v127
    v_cvt_pk_bf16_f32 v123, v126, v127
    v_fma_f32 v64, v64, s51, v22
    v_fma_f32 v65, v65, s51, v22
    s_waitcnt lgkmcnt(3)
    v_mfma_f32_32x32x16_bf16 v[160:175], v[128:131], v[112:115], v[160:175]
    ds_read_b128 v[144:147], v20 offset:28672
    v_fma_f32 v66, v66, s51, v22
    v_fma_f32 v67, v67, s51, v22
    v_fma_f32 v68, v68, s51, v22
    s_waitcnt lgkmcnt(3)
    v_mfma_f32_32x32x16_bf16 v[176:191], v[132:135], v[112:115], v[176:191]
    ds_read_b128 v[148:151], v20 offset:29696
    v_fma_f32 v69, v69, s51, v22
    v_fma_f32 v70, v70, s51, v22
    v_fma_f32 v71, v71, s51, v22
    v_exp_f32 v64, v64
    s_waitcnt lgkmcnt(3)
    v_mfma_f32_32x32x16_bf16 v[192:207], v[136:139], v[112:115], v[192:207]
    ds_read_b128 v[152:155], v20 offset:30720
    v_exp_f32 v65, v65
    v_exp_f32 v66, v66
    v_exp_f32 v67, v67
    s_waitcnt lgkmcnt(3)
    v_mfma_f32_32x32x16_bf16 v[208:223], v[140:143], v[112:115], v[208:223]
    ds_read_b128 v[156:159], v20 offset:31744
    v_exp_f32 v68, v68
    v_exp_f32 v69, v69
    v_exp_f32 v70, v70
    v_add_u32 v20, 131072, v27
    v_exp_f32 v71, v71
    s_waitcnt lgkmcnt(3)
    v_mfma_f32_32x32x16_bf16 v[160:175], v[144:147], v[120:123], v[160:175]
    v_add_f32 v23, v23, v64
    v_add_f32 v23, v23, v65
    ds_read_b128 v[128:131], v20 offset:0
    v_cvt_pk_bf16_f32 v64, v64, v65
    s_waitcnt lgkmcnt(3)
    v_mfma_f32_32x32x16_bf16 v[176:191], v[148:151], v[120:123], v[176:191]
    v_add_f32 v24, v24, v66
    v_add_f32 v24, v24, v67
    ds_read_b128 v[132:135], v20 offset:1024
    v_cvt_pk_bf16_f32 v65, v66, v67
    v_add_f32 v25, v25, v68
    s_waitcnt lgkmcnt(3)
    v_mfma_f32_32x32x16_bf16 v[192:207], v[152:155], v[120:123], v[192:207]
    v_add_f32 v25, v25, v69
    ds_read_b128 v[136:139], v20 offset:2048
    v_cvt_pk_bf16_f32 v66, v68, v69
    v_add_f32 v26, v26, v70
    s_waitcnt lgkmcnt(3)
    v_mfma_f32_32x32x16_bf16 v[208:223], v[156:159], v[120:123], v[208:223]
    v_add_f32 v26, v26, v71
    ds_read_b128 v[140:143], v20 offset:3072
    v_cvt_pk_bf16_f32 v67, v70, v71
    s_waitcnt vmcnt(4)
    s_barrier
    v_fma_f32 v72, v72, s51, v22
    v_fma_f32 v73, v73, s51, v22
    v_mfma_f32_32x32x16_bf16 v[96:111], v[224:227], v[32:35], 0
    ds_read_b128 v[224:227], v9 offset:24576
    s_add_u32 m0, s29, 65536
    v_fma_f32 v74, v74, s51, v22
    v_fma_f32 v75, v75, s51, v22
    v_fma_f32 v76, v76, s51, v22
    v_mfma_f32_32x32x16_bf16 v[96:111], v[228:231], v[36:39], v[96:111]
    ds_read_b128 v[228:231], v10 offset:24576
    v_fma_f32 v77, v77, s51, v22
    s_add_u32 s3, s31, 98304
    v_fma_f32 v78, v78, s51, v22
    v_fma_f32 v79, v79, s51, v22
    v_exp_f32 v72, v72
    v_mfma_f32_32x32x16_bf16 v[96:111], v[232:235], v[40:43], v[96:111]
    ds_read_b128 v[232:235], v11 offset:24576
    v_exp_f32 v73, v73
    buffer_load_dwordx4 v28, s[4:7], s3 offen offset:0 lds
    v_exp_f32 v74, v74
    v_exp_f32 v75, v75
    v_mfma_f32_32x32x16_bf16 v[96:111], v[236:239], v[44:47], v[96:111]
    ds_read_b128 v[236:239], v12 offset:24576
    v_exp_f32 v76, v76
    v_exp_f32 v77, v77
    buffer_load_dwordx4 v29, s[4:7], s3 offen offset:1024 lds
    v_exp_f32 v78, v78
    v_exp_f32 v79, v79
    v_mfma_f32_32x32x16_bf16 v[96:111], v[240:243], v[48:51], v[96:111]
    ds_read_b128 v[240:243], v13 offset:24576
    v_add_f32 v23, v23, v72
    v_add_f32 v23, v23, v73
    buffer_load_dwordx4 v30, s[4:7], s3 offen offset:2048 lds
    v_cvt_pk_bf16_f32 v72, v72, v73
    v_mfma_f32_32x32x16_bf16 v[96:111], v[244:247], v[52:55], v[96:111]
    ds_read_b128 v[244:247], v14 offset:24576
    v_add_f32 v24, v24, v74
    v_add_f32 v24, v24, v75
    v_cvt_pk_bf16_f32 v73, v74, v75
    buffer_load_dwordx4 v31, s[4:7], s3 offen offset:3072 lds
    v_add_f32 v25, v25, v76
    v_mfma_f32_32x32x16_bf16 v[96:111], v[248:251], v[56:59], v[96:111]
    ds_read_b128 v[248:251], v15 offset:24576
    v_add_f32 v25, v25, v77
    v_cvt_pk_bf16_f32 v74, v76, v77
    v_add_f32 v26, v26, v78
    v_lshlrev_b32 v19, 3, v27
    v_mfma_f32_32x32x16_bf16 v[96:111], v[252:255], v[60:63], v[96:111]
    ds_read_b128 v[252:255], v16 offset:24576
    v_add_f32 v26, v26, v79
    v_cvt_pk_bf16_f32 v75, v78, v79
    v_fma_f32 v80, v80, s51, v22
    v_fma_f32 v81, v81, s51, v22
    s_waitcnt lgkmcnt(7)
    v_mfma_f32_32x32x16_bf16 v[112:127], v[224:227], v[32:35], 0
    v_subrev_u32 v9, 98304, v9
    ds_read_b128 v[224:227], v9 offset:0
    s_cmp_eq_u32 s27, 1
    s_cselect_b32 s20, s58, s16
    s_cselect_b32 s21, s59, s17
    s_cselect_b32 s22, 524288, s18
    s_cselect_b32 s35, 0, 0x280000
    v_fma_f32 v82, v82, s51, v22
    v_fma_f32 v83, v83, s51, v22
    v_fma_f32 v84, v84, s51, v22
    s_waitcnt lgkmcnt(7)
    v_mfma_f32_32x32x16_bf16 v[112:127], v[228:231], v[36:39], v[112:127]
    v_subrev_u32 v10, 98304, v10
    ds_read_b128 v[228:231], v10 offset:0
    v_fma_f32 v85, v85, s51, v22
    s_cmp_eq_u32 s27, 2
    s_cselect_b32 s20, s60, s20
    s_cselect_b32 s21, s61, s21
    v_fma_f32 v86, v86, s51, v22
    v_fma_f32 v87, v87, s51, v22
    v_exp_f32 v80, v80
    s_waitcnt lgkmcnt(7)
    v_mfma_f32_32x32x16_bf16 v[112:127], v[232:235], v[40:43], v[112:127]
    v_subrev_u32 v11, 98304, v11
    ds_read_b128 v[232:235], v11 offset:0
    v_exp_f32 v81, v81
    s_cmp_eq_u32 s27, 3
    s_cselect_b32 s20, s62, s20
    s_cselect_b32 s21, s63, s21
    v_exp_f32 v82, v82
    v_exp_f32 v83, v83
    s_waitcnt lgkmcnt(7)
    v_mfma_f32_32x32x16_bf16 v[112:127], v[236:239], v[44:47], v[112:127]
    v_subrev_u32 v12, 98304, v12
    ds_read_b128 v[236:239], v12 offset:0
    v_exp_f32 v84, v84
    v_exp_f32 v85, v85
    s_lshr_b32 s34, s2, 3
    s_lshl_b32 s34, s34, 14
    s_add_u32 s35, s35, s34
    s_lshl_b32 s34, s28, 13
    s_add_u32 s35, s35, s34
    v_exp_f32 v86, v86
    v_exp_f32 v87, v87
    s_waitcnt lgkmcnt(7)
    v_mfma_f32_32x32x16_bf16 v[112:127], v[240:243], v[48:51], v[112:127]
    v_subrev_u32 v13, 98304, v13
    ds_read_b128 v[240:243], v13 offset:0
    v_add_f32 v23, v23, v80
    v_add_f32 v23, v23, v81
    s_mul_i32 s34, s2, 7168
    s_cmp_ge_u32 s27, 2
    s_cselect_b32 s22, 1835008, s22
    s_cselect_b32 s34, s34, s35
    v_cvt_pk_bf16_f32 v80, v80, v81
    s_waitcnt lgkmcnt(7)
    v_mfma_f32_32x32x16_bf16 v[112:127], v[244:247], v[52:55], v[112:127]
    v_subrev_u32 v14, 98304, v14
    ds_read_b128 v[244:247], v14 offset:0
    v_add_f32 v24, v24, v82
    v_add_f32 v24, v24, v83
    v_cvt_pk_bf16_f32 v81, v82, v83
    s_mov_b32 s23, 0x00020000
    v_add_f32 v25, v25, v84
    s_waitcnt lgkmcnt(7)
    v_mfma_f32_32x32x16_bf16 v[112:127], v[248:251], v[56:59], v[112:127]
    v_subrev_u32 v15, 98304, v15
    ds_read_b128 v[248:251], v15 offset:0
    v_add_f32 v25, v25, v85
    v_cvt_pk_bf16_f32 v82, v84, v85
    v_add_f32 v26, v26, v86
    buffer_load_dword v19, v19, s[20:23], s34 offen
    s_waitcnt lgkmcnt(7)
    v_mfma_f32_32x32x16_bf16 v[112:127], v[252:255], v[60:63], v[112:127]
    v_subrev_u32 v16, 98304, v16
    ds_read_b128 v[252:255], v16 offset:0
    v_add_f32 v26, v26, v87
    v_cvt_pk_bf16_f32 v83, v86, v87
    v_fma_f32 v88, v88, s51, v22
    v_fma_f32 v89, v89, s51, v22
    v_mfma_f32_32x32x16_bf16 v[160:175], v[128:131], v[64:67], v[160:175]
    ds_read_b128 v[144:147], v20 offset:4096
    v_fma_f32 v90, v90, s51, v22
    v_fma_f32 v91, v91, s51, v22
    v_fma_f32 v92, v92, s51, v22
    v_mfma_f32_32x32x16_bf16 v[176:191], v[132:135], v[64:67], v[176:191]
    ds_read_b128 v[148:151], v20 offset:5120
    v_fma_f32 v93, v93, s51, v22
    v_fma_f32 v94, v94, s51, v22
    v_fma_f32 v95, v95, s51, v22
    v_exp_f32 v88, v88
    v_mfma_f32_32x32x16_bf16 v[192:207], v[136:139], v[64:67], v[192:207]
    ds_read_b128 v[152:155], v20 offset:6144
    v_exp_f32 v89, v89
    v_exp_f32 v90, v90
    v_exp_f32 v91, v91
    v_mfma_f32_32x32x16_bf16 v[208:223], v[140:143], v[64:67], v[208:223]
    ds_read_b128 v[156:159], v20 offset:7168
    v_exp_f32 v92, v92
    v_exp_f32 v93, v93
    v_exp_f32 v94, v94
    v_exp_f32 v95, v95
    s_waitcnt lgkmcnt(3)
    v_mfma_f32_32x32x16_bf16 v[160:175], v[144:147], v[72:75], v[160:175]
    ds_read_b128 v[128:131], v20 offset:8192
    v_add_f32 v23, v23, v88
    v_add_f32 v23, v23, v89
    v_cvt_pk_bf16_f32 v88, v88, v89
    s_waitcnt lgkmcnt(3)
    v_mfma_f32_32x32x16_bf16 v[176:191], v[148:151], v[72:75], v[176:191]
    ds_read_b128 v[132:135], v20 offset:9216
    v_add_f32 v24, v24, v90
    v_add_f32 v24, v24, v91
    v_cvt_pk_bf16_f32 v89, v90, v91
    v_add_f32 v25, v25, v92
    s_waitcnt lgkmcnt(3)
    v_mfma_f32_32x32x16_bf16 v[192:207], v[152:155], v[72:75], v[192:207]
    ds_read_b128 v[136:139], v20 offset:10240
    v_add_f32 v25, v25, v93
    v_cvt_pk_bf16_f32 v90, v92, v93
    v_add_f32 v26, v26, v94
    s_waitcnt lgkmcnt(3)
    v_mfma_f32_32x32x16_bf16 v[208:223], v[156:159], v[72:75], v[208:223]
    ds_read_b128 v[140:143], v20 offset:11264
    v_add_f32 v26, v26, v95
    v_cvt_pk_bf16_f32 v91, v94, v95
    v_fma_f32 v96, v96, s51, v22
    v_fma_f32 v97, v97, s51, v22
    s_waitcnt lgkmcnt(3)
    v_mfma_f32_32x32x16_bf16 v[160:175], v[128:131], v[80:83], v[160:175]
    ds_read_b128 v[144:147], v20 offset:12288
    v_fma_f32 v98, v98, s51, v22
    v_fma_f32 v99, v99, s51, v22
    v_fma_f32 v100, v100, s51, v22
    s_waitcnt lgkmcnt(3)
    v_mfma_f32_32x32x16_bf16 v[176:191], v[132:135], v[80:83], v[176:191]
    ds_read_b128 v[148:151], v20 offset:13312
    v_fma_f32 v101, v101, s51, v22
    v_fma_f32 v102, v102, s51, v22
    v_fma_f32 v103, v103, s51, v22
    v_exp_f32 v96, v96
    s_waitcnt lgkmcnt(3)
    v_mfma_f32_32x32x16_bf16 v[192:207], v[136:139], v[80:83], v[192:207]
    ds_read_b128 v[152:155], v20 offset:14336
    v_exp_f32 v97, v97
    v_exp_f32 v98, v98
    v_exp_f32 v99, v99
    s_waitcnt lgkmcnt(3)
    v_mfma_f32_32x32x16_bf16 v[208:223], v[140:143], v[80:83], v[208:223]
    ds_read_b128 v[156:159], v20 offset:15360
    v_exp_f32 v100, v100
    v_exp_f32 v101, v101
    v_exp_f32 v102, v102
    v_exp_f32 v103, v103
    s_waitcnt lgkmcnt(3)
    v_mfma_f32_32x32x16_bf16 v[160:175], v[144:147], v[88:91], v[160:175]
    ds_read_b128 v[128:131], v20 offset:16384
    v_add_f32 v23, v23, v96
    v_add_f32 v23, v23, v97
    v_cvt_pk_bf16_f32 v96, v96, v97
    s_waitcnt lgkmcnt(3)
    v_mfma_f32_32x32x16_bf16 v[176:191], v[148:151], v[88:91], v[176:191]
    ds_read_b128 v[132:135], v20 offset:17408
    v_add_f32 v24, v24, v98
    v_add_f32 v24, v24, v99
    v_cvt_pk_bf16_f32 v97, v98, v99
    v_add_f32 v25, v25, v100
    s_waitcnt lgkmcnt(3)
    v_mfma_f32_32x32x16_bf16 v[192:207], v[152:155], v[88:91], v[192:207]
    ds_read_b128 v[136:139], v20 offset:18432
    v_add_f32 v25, v25, v101
    v_cvt_pk_bf16_f32 v98, v100, v101
    v_add_f32 v26, v26, v102
    s_waitcnt lgkmcnt(3)
    v_mfma_f32_32x32x16_bf16 v[208:223], v[156:159], v[88:91], v[208:223]
    ds_read_b128 v[140:143], v20 offset:19456
    v_add_f32 v26, v26, v103
    v_cvt_pk_bf16_f32 v99, v102, v103
    s_waitcnt vmcnt(5)
    s_barrier
    v_fma_f32 v104, v104, s51, v22
    v_fma_f32 v105, v105, s51, v22
    v_mfma_f32_32x32x16_bf16 v[64:79], v[224:227], v[32:35], 0
    ds_read_b128 v[224:227], v9 offset:8192
    s_add_u32 m0, s29, 98304
    v_fma_f32 v106, v106, s51, v22
    v_fma_f32 v107, v107, s51, v22
    v_fma_f32 v108, v108, s51, v22
    v_mfma_f32_32x32x16_bf16 v[64:79], v[228:231], v[36:39], v[64:79]
    ds_read_b128 v[228:231], v10 offset:8192
    v_fma_f32 v109, v109, s51, v22
    s_add_u32 s3, s33, 98304
    v_fma_f32 v110, v110, s51, v22
    v_fma_f32 v111, v111, s51, v22
    v_exp_f32 v104, v104
    v_mfma_f32_32x32x16_bf16 v[64:79], v[232:235], v[40:43], v[64:79]
    ds_read_b128 v[232:235], v11 offset:8192
    v_exp_f32 v105, v105
    v_exp_f32 v106, v106
    buffer_load_dwordx4 v27, s[16:19], s3 offen offset:0 lds
    v_exp_f32 v107, v107
    v_mfma_f32_32x32x16_bf16 v[64:79], v[236:239], v[44:47], v[64:79]
    ds_read_b128 v[236:239], v12 offset:8192
    v_exp_f32 v108, v108
    v_exp_f32 v109, v109
    v_exp_f32 v110, v110
    buffer_load_dwordx4 v27, s[16:19], s3 offen offset:1024 lds
    v_exp_f32 v111, v111
    v_mfma_f32_32x32x16_bf16 v[64:79], v[240:243], v[48:51], v[64:79]
    ds_read_b128 v[240:243], v13 offset:8192
    v_add_f32 v23, v23, v104
    v_add_f32 v23, v23, v105
    v_cvt_pk_bf16_f32 v104, v104, v105
    v_mfma_f32_32x32x16_bf16 v[64:79], v[244:247], v[52:55], v[64:79]
    ds_read_b128 v[244:247], v14 offset:8192
    buffer_load_dwordx4 v27, s[16:19], s3 offen offset:2048 lds
    v_add_f32 v24, v24, v106
    v_add_f32 v24, v24, v107
    v_cvt_pk_bf16_f32 v105, v106, v107
    v_add_f32 v25, v25, v108
    v_mfma_f32_32x32x16_bf16 v[64:79], v[248:251], v[56:59], v[64:79]
    ds_read_b128 v[248:251], v15 offset:8192
    v_add_f32 v25, v25, v109
    buffer_load_dwordx4 v27, s[16:19], s3 offen offset:3072 lds
    v_cvt_pk_bf16_f32 v106, v108, v109
    v_add_f32 v26, v26, v110
    v_mfma_f32_32x32x16_bf16 v[64:79], v[252:255], v[60:63], v[64:79]
    ds_read_b128 v[252:255], v16 offset:8192
    v_add_f32 v26, v26, v111
    v_cvt_pk_bf16_f32 v107, v110, v111
    s_mov_b32 s20, s60
    s_mov_b32 s21, s61
    s_mov_b32 s22, 1835008
    s_mov_b32 s23, 0x00020000
    v_fma_f32 v112, v112, s51, v22
    v_fma_f32 v113, v113, s51, v22
    s_waitcnt lgkmcnt(7)
    v_mfma_f32_32x32x16_bf16 v[80:95], v[224:227], v[32:35], 0
    ds_read_b128 v[224:227], v9 offset:16384
    v_fma_f32 v114, v114, s51, v22
    v_fma_f32 v115, v115, s51, v22
    s_and_b32 s46, s2, 0xc0
    s_and_b32 s47, s2, 7
    s_lshl_b32 s47, s47, 3
    s_add_u32 s46, s46, s47
    s_bfe_u32 s47, s2, 0x30003
    s_add_u32 s46, s46, s47
    v_fma_f32 v116, v116, s51, v22
    s_waitcnt lgkmcnt(7)
    v_mfma_f32_32x32x16_bf16 v[80:95], v[228:231], v[36:39], v[80:95]
    ds_read_b128 v[228:231], v10 offset:16384
    v_fma_f32 v117, v117, s51, v22
    v_fma_f32 v118, v118, s51, v22
    v_fma_f32 v119, v119, s51, v22
    v_exp_f32 v112, v112
    s_cmp_ge_u32 s46, 224
    s_cselect_b32 s48, 0x10000000, 0
    s_lshl_b32 s47, s46, 4
    s_add_u32 s47, s47, s48
    s_waitcnt lgkmcnt(7)
    v_mfma_f32_32x32x16_bf16 v[80:95], v[232:235], v[40:43], v[80:95]
    ds_read_b128 v[232:235], v11 offset:16384
    v_exp_f32 v113, v113
    v_exp_f32 v114, v114
    v_exp_f32 v115, v115
    s_waitcnt lgkmcnt(7)
    v_mfma_f32_32x32x16_bf16 v[80:95], v[236:239], v[44:47], v[80:95]
    ds_read_b128 v[236:239], v12 offset:16384
    v_exp_f32 v116, v116
    s_mul_i32 s49, s24, 229376
    s_add_u32 s47, s47, s49
    v_exp_f32 v117, v117
    v_exp_f32 v118, v118
    v_exp_f32 v119, v119
    s_waitcnt lgkmcnt(7)
    v_mfma_f32_32x32x16_bf16 v[80:95], v[240:243], v[48:51], v[80:95]
    ds_read_b128 v[240:243], v13 offset:16384
    v_add_f32 v23, v23, v112
    v_mul_u32_u24 v28, 224, v27
    v_add_f32 v23, v23, v113
    v_cvt_pk_bf16_f32 v112, v112, v113
    s_waitcnt lgkmcnt(7)
    v_mfma_f32_32x32x16_bf16 v[80:95], v[244:247], v[52:55], v[80:95]
    ds_read_b128 v[244:247], v14 offset:16384
    v_add_f32 v24, v24, v114
    v_add_f32 v24, v24, v115
    v_cvt_pk_bf16_f32 v113, v114, v115
    buffer_load_dwordx4 v[28:31], v28, s[20:23], s47 offen
    v_add_f32 v25, v25, v116
    s_waitcnt lgkmcnt(7)
    v_mfma_f32_32x32x16_bf16 v[80:95], v[248:251], v[56:59], v[80:95]
    ds_read_b128 v[248:251], v15 offset:16384
    v_add_f32 v25, v25, v117
    v_cvt_pk_bf16_f32 v114, v116, v117
    v_add_f32 v26, v26, v118
    s_lshl_b32 s46, s46, 5
    s_add_u32 s46, s46, s48
    s_mul_i32 s49, s24, 7168
    s_add_u32 s46, s46, s49
    s_add_u32 s46, s46, 0x260000
    s_waitcnt lgkmcnt(7)
    v_mfma_f32_32x32x16_bf16 v[80:95], v[252:255], v[60:63], v[80:95]
    ds_read_b128 v[252:255], v16 offset:16384
    v_add_f32 v26, v26, v119
    v_cvt_pk_bf16_f32 v115, v118, v119
    v_fma_f32 v120, v120, s51, v22
    v_fma_f32 v121, v121, s51, v22
    v_mfma_f32_32x32x16_bf16 v[160:175], v[128:131], v[96:99], v[160:175]
    ds_read_b128 v[144:147], v20 offset:20480
    v_fma_f32 v122, v122, s51, v22
    v_fma_f32 v123, v123, s51, v22
    v_fma_f32 v124, v124, s51, v22
    v_mfma_f32_32x32x16_bf16 v[176:191], v[132:135], v[96:99], v[176:191]
    ds_read_b128 v[148:151], v20 offset:21504
    v_fma_f32 v125, v125, s51, v22
    v_fma_f32 v126, v126, s51, v22
    v_fma_f32 v127, v127, s51, v22
    v_exp_f32 v120, v120
    v_mfma_f32_32x32x16_bf16 v[192:207], v[136:139], v[96:99], v[192:207]
    ds_read_b128 v[152:155], v20 offset:22528
    v_exp_f32 v121, v121
    v_exp_f32 v122, v122
    v_exp_f32 v123, v123
    v_mfma_f32_32x32x16_bf16 v[208:223], v[140:143], v[96:99], v[208:223]
    ds_read_b128 v[156:159], v20 offset:23552
    v_exp_f32 v124, v124
    v_exp_f32 v125, v125
    v_exp_f32 v126, v126
    v_exp_f32 v127, v127
    s_waitcnt lgkmcnt(3)
    v_mfma_f32_32x32x16_bf16 v[160:175], v[144:147], v[104:107], v[160:175]
    ds_read_b128 v[128:131], v20 offset:24576
    v_add_f32 v23, v23, v120
    v_add_f32 v23, v23, v121
    v_cvt_pk_bf16_f32 v120, v120, v121
    s_waitcnt lgkmcnt(3)
    v_mfma_f32_32x32x16_bf16 v[176:191], v[148:151], v[104:107], v[176:191]
    ds_read_b128 v[132:135], v20 offset:25600
    v_add_f32 v24, v24, v122
    v_add_f32 v24, v24, v123
    v_cvt_pk_bf16_f32 v121, v122, v123
    v_add_f32 v25, v25, v124
    s_waitcnt lgkmcnt(3)
    v_mfma_f32_32x32x16_bf16 v[192:207], v[152:155], v[104:107], v[192:207]
    ds_read_b128 v[136:139], v20 offset:26624
    v_add_f32 v25, v25, v125
    v_cvt_pk_bf16_f32 v122, v124, v125
    v_add_f32 v26, v26, v126
    s_waitcnt lgkmcnt(3)
    v_mfma_f32_32x32x16_bf16 v[208:223], v[156:159], v[104:107], v[208:223]
    ds_read_b128 v[140:143], v20 offset:27648
    v_add_f32 v26, v26, v127
    v_cvt_pk_bf16_f32 v123, v126, v127
    v_fma_f32 v64, v64, s51, v22
    v_fma_f32 v65, v65, s51, v22
    s_waitcnt lgkmcnt(3)
    v_mfma_f32_32x32x16_bf16 v[160:175], v[128:131], v[112:115], v[160:175]
    ds_read_b128 v[144:147], v20 offset:28672
    v_fma_f32 v66, v66, s51, v22
    v_fma_f32 v67, v67, s51, v22
    v_fma_f32 v68, v68, s51, v22
    s_waitcnt lgkmcnt(3)
    v_mfma_f32_32x32x16_bf16 v[176:191], v[132:135], v[112:115], v[176:191]
    ds_read_b128 v[148:151], v20 offset:29696
    v_fma_f32 v69, v69, s51, v22
    v_fma_f32 v70, v70, s51, v22
    v_fma_f32 v71, v71, s51, v22
    v_exp_f32 v64, v64
    s_waitcnt lgkmcnt(3)
    v_mfma_f32_32x32x16_bf16 v[192:207], v[136:139], v[112:115], v[192:207]
    ds_read_b128 v[152:155], v20 offset:30720
    v_exp_f32 v65, v65
    v_exp_f32 v66, v66
    v_exp_f32 v67, v67
    s_waitcnt lgkmcnt(3)
    v_mfma_f32_32x32x16_bf16 v[208:223], v[140:143], v[112:115], v[208:223]
    ds_read_b128 v[156:159], v20 offset:31744
    v_exp_f32 v68, v68
    v_exp_f32 v69, v69
    v_exp_f32 v70, v70
    v_add_u32 v20, 32768, v27
    v_exp_f32 v71, v71
    s_waitcnt lgkmcnt(3)
    v_mfma_f32_32x32x16_bf16 v[160:175], v[144:147], v[120:123], v[160:175]
    v_add_f32 v23, v23, v64
    v_add_f32 v23, v23, v65
    ds_read_b128 v[128:131], v20 offset:0
    v_cvt_pk_bf16_f32 v64, v64, v65
    s_waitcnt lgkmcnt(3)
    v_mfma_f32_32x32x16_bf16 v[176:191], v[148:151], v[120:123], v[176:191]
    v_add_f32 v24, v24, v66
    v_add_f32 v24, v24, v67
    ds_read_b128 v[132:135], v20 offset:1024
    v_cvt_pk_bf16_f32 v65, v66, v67
    v_add_f32 v25, v25, v68
    s_waitcnt lgkmcnt(3)
    v_mfma_f32_32x32x16_bf16 v[192:207], v[152:155], v[120:123], v[192:207]
    v_add_f32 v25, v25, v69
    ds_read_b128 v[136:139], v20 offset:2048
    v_cvt_pk_bf16_f32 v66, v68, v69
    v_add_f32 v26, v26, v70
    s_waitcnt lgkmcnt(3)
    v_mfma_f32_32x32x16_bf16 v[208:223], v[156:159], v[120:123], v[208:223]
    v_add_f32 v26, v26, v71
    ds_read_b128 v[140:143], v20 offset:3072
    v_cvt_pk_bf16_f32 v67, v70, v71
    s_waitcnt vmcnt(6)
    s_barrier
    v_fma_f32 v72, v72, s51, v22
    v_fma_f32 v73, v73, s51, v22
    v_mfma_f32_32x32x16_bf16 v[96:111], v[224:227], v[32:35], 0
    ds_read_b128 v[224:227], v9 offset:24576
    v_fma_f32 v74, v74, s51, v22
    v_fma_f32 v75, v75, s51, v22
    v_fma_f32 v76, v76, s51, v22
    v_mfma_f32_32x32x16_bf16 v[96:111], v[228:231], v[36:39], v[96:111]
    ds_read_b128 v[228:231], v10 offset:24576
    v_fma_f32 v77, v77, s51, v22
    v_fma_f32 v78, v78, s51, v22
    s_add_u32 m0, s29, 131072
    s_add_u32 s3, s32, 0
    buffer_load_dwordx4 v2, s[12:15], s3 offen lds
    v_fma_f32 v79, v79, s51, v22
    v_exp_f32 v72, v72
    v_mfma_f32_32x32x16_bf16 v[96:111], v[232:235], v[40:43], v[96:111]
    ds_read_b128 v[232:235], v11 offset:24576
    v_exp_f32 v73, v73
    v_exp_f32 v74, v74
    v_exp_f32 v75, v75
    v_mfma_f32_32x32x16_bf16 v[96:111], v[236:239], v[44:47], v[96:111]
    ds_read_b128 v[236:239], v12 offset:24576
    v_exp_f32 v76, v76
    v_exp_f32 v77, v77
    v_exp_f32 v78, v78
    v_exp_f32 v79, v79
    v_mfma_f32_32x32x16_bf16 v[96:111], v[240:243], v[48:51], v[96:111]
    ds_read_b128 v[240:243], v13 offset:24576
    v_add_f32 v23, v23, v72
    v_add_f32 v23, v23, v73
    v_cvt_pk_bf16_f32 v72, v72, v73
    v_mfma_f32_32x32x16_bf16 v[96:111], v[244:247], v[52:55], v[96:111]
    ds_read_b128 v[244:247], v14 offset:24576
    v_add_f32 v24, v24, v74
    v_add_f32 v24, v24, v75
    s_add_u32 s3, s32, 15360
    buffer_load_dwordx4 v2, s[12:15], s3 offen offset:1024 lds
    v_cvt_pk_bf16_f32 v73, v74, v75
    v_add_f32 v25, v25, v76
    v_mfma_f32_32x32x16_bf16 v[96:111], v[248:251], v[56:59], v[96:111]
    ds_read_b128 v[248:251], v15 offset:24576
    v_add_f32 v25, v25, v77
    v_cvt_pk_bf16_f32 v74, v76, v77
    v_add_f32 v26, v26, v78
    v_mfma_f32_32x32x16_bf16 v[96:111], v[252:255], v[60:63], v[96:111]
    ds_read_b128 v[252:255], v16 offset:24576
    v_add_f32 v26, v26, v79
    v_cvt_pk_bf16_f32 v75, v78, v79
    v_fma_f32 v80, v80, s51, v22
    v_fma_f32 v81, v81, s51, v22
    s_waitcnt lgkmcnt(7)
    v_mfma_f32_32x32x16_bf16 v[112:127], v[224:227], v[32:35], 0
    v_add_u32 v9, 65536, v9
    ds_read_b128 v[224:227], v9 offset:0
    v_fma_f32 v82, v82, s51, v22
    v_fma_f32 v83, v83, s51, v22
    v_fma_f32 v84, v84, s51, v22
    s_waitcnt lgkmcnt(7)
    v_mfma_f32_32x32x16_bf16 v[112:127], v[228:231], v[36:39], v[112:127]
    v_add_u32 v10, 65536, v10
    ds_read_b128 v[228:231], v10 offset:0
    v_fma_f32 v85, v85, s51, v22
    v_fma_f32 v86, v86, s51, v22
    s_add_u32 m0, s29, 133120
    s_add_u32 s3, s32, 4096
    buffer_load_dwordx4 v2, s[12:15], s3 offen lds
    v_fma_f32 v87, v87, s51, v22
    v_exp_f32 v80, v80
    s_waitcnt lgkmcnt(7)
    v_mfma_f32_32x32x16_bf16 v[112:127], v[232:235], v[40:43], v[112:127]
    v_add_u32 v11, 65536, v11
    ds_read_b128 v[232:235], v11 offset:0
    v_exp_f32 v81, v81
    v_exp_f32 v82, v82
    v_exp_f32 v83, v83
    s_waitcnt lgkmcnt(7)
    v_mfma_f32_32x32x16_bf16 v[112:127], v[236:239], v[44:47], v[112:127]
    v_add_u32 v12, 65536, v12
    ds_read_b128 v[236:239], v12 offset:0
    v_exp_f32 v84, v84
    v_exp_f32 v85, v85
    v_exp_f32 v86, v86
    v_exp_f32 v87, v87
    s_waitcnt lgkmcnt(7)
    v_mfma_f32_32x32x16_bf16 v[112:127], v[240:243], v[48:51], v[112:127]
    v_add_u32 v13, 65536, v13
    ds_read_b128 v[240:243], v13 offset:0
    v_add_f32 v23, v23, v80
    v_add_f32 v23, v23, v81
    v_cvt_pk_bf16_f32 v80, v80, v81
    s_waitcnt lgkmcnt(7)
    v_mfma_f32_32x32x16_bf16 v[112:127], v[244:247], v[52:55], v[112:127]
    v_add_u32 v14, 65536, v14
    ds_read_b128 v[244:247], v14 offset:0
    v_add_f32 v24, v24, v82
    v_add_f32 v24, v24, v83
    s_add_u32 s3, s32, 19456
    buffer_load_dwordx4 v2, s[12:15], s3 offen offset:1024 lds
    v_cvt_pk_bf16_f32 v81, v82, v83
    v_add_f32 v25, v25, v84
    s_waitcnt lgkmcnt(7)
    v_mfma_f32_32x32x16_bf16 v[112:127], v[248:251], v[56:59], v[112:127]
    v_add_u32 v15, 65536, v15
    ds_read_b128 v[248:251], v15 offset:0
    v_add_f32 v25, v25, v85
    v_cvt_pk_bf16_f32 v82, v84, v85
    v_add_f32 v26, v26, v86
    s_waitcnt lgkmcnt(7)
    v_mfma_f32_32x32x16_bf16 v[112:127], v[252:255], v[60:63], v[112:127]
    v_add_u32 v16, 65536, v16
    ds_read_b128 v[252:255], v16 offset:0
    v_add_f32 v26, v26, v87
    v_cvt_pk_bf16_f32 v83, v86, v87
    v_fma_f32 v88, v88, s51, v22
    v_fma_f32 v89, v89, s51, v22
    v_mfma_f32_32x32x16_bf16 v[160:175], v[128:131], v[64:67], v[160:175]
    ds_read_b128 v[144:147], v20 offset:4096
    v_fma_f32 v90, v90, s51, v22
    v_fma_f32 v91, v91, s51, v22
    v_fma_f32 v92, v92, s51, v22
    v_mfma_f32_32x32x16_bf16 v[176:191], v[132:135], v[64:67], v[176:191]
    ds_read_b128 v[148:151], v20 offset:5120
    v_fma_f32 v93, v93, s51, v22
    v_fma_f32 v94, v94, s51, v22
    v_fma_f32 v95, v95, s51, v22
    v_exp_f32 v88, v88
    v_mfma_f32_32x32x16_bf16 v[192:207], v[136:139], v[64:67], v[192:207]
    ds_read_b128 v[152:155], v20 offset:6144
    v_exp_f32 v89, v89
    v_exp_f32 v90, v90
    v_exp_f32 v91, v91
    v_mfma_f32_32x32x16_bf16 v[208:223], v[140:143], v[64:67], v[208:223]
    ds_read_b128 v[156:159], v20 offset:7168
    v_exp_f32 v92, v92
    v_exp_f32 v93, v93
    v_exp_f32 v94, v94
    v_exp_f32 v95, v95
    s_waitcnt lgkmcnt(3)
    v_mfma_f32_32x32x16_bf16 v[160:175], v[144:147], v[72:75], v[160:175]
    ds_read_b128 v[128:131], v20 offset:8192
    v_add_f32 v23, v23, v88
    v_add_f32 v23, v23, v89
    v_cvt_pk_bf16_f32 v88, v88, v89
    s_waitcnt lgkmcnt(3)
    v_mfma_f32_32x32x16_bf16 v[176:191], v[148:151], v[72:75], v[176:191]
    ds_read_b128 v[132:135], v20 offset:9216
    v_add_f32 v24, v24, v90
    v_add_f32 v24, v24, v91
    v_cvt_pk_bf16_f32 v89, v90, v91
    v_add_f32 v25, v25, v92
    s_waitcnt lgkmcnt(3)
    v_mfma_f32_32x32x16_bf16 v[192:207], v[152:155], v[72:75], v[192:207]
    ds_read_b128 v[136:139], v20 offset:10240
    v_add_f32 v25, v25, v93
    v_cvt_pk_bf16_f32 v90, v92, v93
    v_add_f32 v26, v26, v94
    s_waitcnt lgkmcnt(3)
    v_mfma_f32_32x32x16_bf16 v[208:223], v[156:159], v[72:75], v[208:223]
    ds_read_b128 v[140:143], v20 offset:11264
    v_add_f32 v26, v26, v95
    v_cvt_pk_bf16_f32 v91, v94, v95
    v_fma_f32 v96, v96, s51, v22
    v_fma_f32 v97, v97, s51, v22
    s_waitcnt lgkmcnt(3)
    v_mfma_f32_32x32x16_bf16 v[160:175], v[128:131], v[80:83], v[160:175]
    ds_read_b128 v[144:147], v20 offset:12288
    v_fma_f32 v98, v98, s51, v22
    v_fma_f32 v99, v99, s51, v22
    v_fma_f32 v100, v100, s51, v22
    s_waitcnt lgkmcnt(3)
    v_mfma_f32_32x32x16_bf16 v[176:191], v[132:135], v[80:83], v[176:191]
    ds_read_b128 v[148:151], v20 offset:13312
    v_fma_f32 v101, v101, s51, v22
    v_fma_f32 v102, v102, s51, v22
    v_fma_f32 v103, v103, s51, v22
    v_exp_f32 v96, v96
    s_waitcnt lgkmcnt(3)
    v_mfma_f32_32x32x16_bf16 v[192:207], v[136:139], v[80:83], v[192:207]
    ds_read_b128 v[152:155], v20 offset:14336
    v_exp_f32 v97, v97
    v_exp_f32 v98, v98
    v_exp_f32 v99, v99
    s_waitcnt lgkmcnt(3)
    v_mfma_f32_32x32x16_bf16 v[208:223], v[140:143], v[80:83], v[208:223]
    ds_read_b128 v[156:159], v20 offset:15360
    v_exp_f32 v100, v100
    v_exp_f32 v101, v101
    v_exp_f32 v102, v102
    v_exp_f32 v103, v103
    s_waitcnt lgkmcnt(3)
    v_mfma_f32_32x32x16_bf16 v[160:175], v[144:147], v[88:91], v[160:175]
    ds_read_b128 v[128:131], v20 offset:16384
    v_add_f32 v23, v23, v96
    v_add_f32 v23, v23, v97
    v_cvt_pk_bf16_f32 v96, v96, v97
    s_waitcnt lgkmcnt(3)
    v_mfma_f32_32x32x16_bf16 v[176:191], v[148:151], v[88:91], v[176:191]
    ds_read_b128 v[132:135], v20 offset:17408
    v_add_f32 v24, v24, v98
    v_add_f32 v24, v24, v99
    v_cvt_pk_bf16_f32 v97, v98, v99
    v_add_f32 v25, v25, v100
    s_waitcnt lgkmcnt(3)
    v_mfma_f32_32x32x16_bf16 v[192:207], v[152:155], v[88:91], v[192:207]
    ds_read_b128 v[136:139], v20 offset:18432
    v_add_f32 v25, v25, v101
    v_cvt_pk_bf16_f32 v98, v100, v101
    v_add_f32 v26, v26, v102
    s_waitcnt lgkmcnt(3)
    v_mfma_f32_32x32x16_bf16 v[208:223], v[156:159], v[88:91], v[208:223]
    ds_read_b128 v[140:143], v20 offset:19456
    v_add_f32 v26, v26, v103
    v_cvt_pk_bf16_f32 v99, v102, v103
    s_waitcnt vmcnt(5)
    s_barrier
    v_fma_f32 v104, v104, s51, v22
    v_fma_f32 v105, v105, s51, v22
    v_mfma_f32_32x32x16_bf16 v[64:79], v[224:227], v[32:35], 0
    ds_read_b128 v[224:227], v9 offset:8192
    v_fma_f32 v106, v106, s51, v22
    v_fma_f32 v107, v107, s51, v22
    v_fma_f32 v108, v108, s51, v22
    v_mfma_f32_32x32x16_bf16 v[64:79], v[228:231], v[36:39], v[64:79]
    ds_read_b128 v[228:231], v10 offset:8192
    v_fma_f32 v109, v109, s51, v22
    v_fma_f32 v110, v110, s51, v22
    s_add_u32 m0, s29, 0
    s_add_u32 s3, s32, 32768
    buffer_load_dwordx4 v2, s[12:15], s3 offen lds
    v_fma_f32 v111, v111, s51, v22
    v_exp_f32 v104, v104
    v_mfma_f32_32x32x16_bf16 v[64:79], v[232:235], v[40:43], v[64:79]
    ds_read_b128 v[232:235], v11 offset:8192
    v_exp_f32 v105, v105
    v_exp_f32 v106, v106
    v_exp_f32 v107, v107
    v_mfma_f32_32x32x16_bf16 v[64:79], v[236:239], v[44:47], v[64:79]
    ds_read_b128 v[236:239], v12 offset:8192
    v_exp_f32 v108, v108
    v_exp_f32 v109, v109
    v_exp_f32 v110, v110
    v_exp_f32 v111, v111
    v_mfma_f32_32x32x16_bf16 v[64:79], v[240:243], v[48:51], v[64:79]
    ds_read_b128 v[240:243], v13 offset:8192
    v_add_f32 v23, v23, v104
    v_add_f32 v23, v23, v105
    v_cvt_pk_bf16_f32 v104, v104, v105
    v_mfma_f32_32x32x16_bf16 v[64:79], v[244:247], v[52:55], v[64:79]
    ds_read_b128 v[244:247], v14 offset:8192
    v_add_f32 v24, v24, v106
    v_add_f32 v24, v24, v107
    s_add_u32 s3, s32, 48128
    buffer_load_dwordx4 v2, s[12:15], s3 offen offset:1024 lds
    v_cvt_pk_bf16_f32 v105, v106, v107
    v_add_f32 v25, v25, v108
    v_mfma_f32_32x32x16_bf16 v[64:79], v[248:251], v[56:59], v[64:79]
    ds_read_b128 v[248:251], v15 offset:8192
    v_add_f32 v25, v25, v109
    v_cvt_pk_bf16_f32 v106, v108, v109
    v_add_f32 v26, v26, v110
    v_mfma_f32_32x32x16_bf16 v[64:79], v[252:255], v[60:63], v[64:79]
    ds_read_b128 v[252:255], v16 offset:8192
    v_add_f32 v26, v26, v111
    v_cvt_pk_bf16_f32 v107, v110, v111
    v_fma_f32 v112, v112, s51, v22
    v_fma_f32 v113, v113, s51, v22
    s_waitcnt lgkmcnt(7)
    v_mfma_f32_32x32x16_bf16 v[80:95], v[224:227], v[32:35], 0
    ds_read_b128 v[224:227], v9 offset:16384
    v_fma_f32 v114, v114, s51, v22
    v_fma_f32 v115, v115, s51, v22
    v_fma_f32 v116, v116, s51, v22
    s_waitcnt lgkmcnt(7)
    v_mfma_f32_32x32x16_bf16 v[80:95], v[228:231], v[36:39], v[80:95]
    ds_read_b128 v[228:231], v10 offset:16384
    v_fma_f32 v117, v117, s51, v22
    v_fma_f32 v118, v118, s51, v22
    s_add_u32 m0, s29, 2048
    s_add_u32 s3, s32, 36864
    buffer_load_dwordx4 v2, s[12:15], s3 offen lds
    v_fma_f32 v119, v119, s51, v22
    v_exp_f32 v112, v112
    s_waitcnt lgkmcnt(7)
    v_mfma_f32_32x32x16_bf16 v[80:95], v[232:235], v[40:43], v[80:95]
    ds_read_b128 v[232:235], v11 offset:16384
    v_exp_f32 v113, v113
    v_exp_f32 v114, v114
    v_exp_f32 v115, v115
    s_waitcnt lgkmcnt(7)
    v_mfma_f32_32x32x16_bf16 v[80:95], v[236:239], v[44:47], v[80:95]
    ds_read_b128 v[236:239], v12 offset:16384
    v_exp_f32 v116, v116
    v_exp_f32 v117, v117
    v_exp_f32 v118, v118
    v_exp_f32 v119, v119
    s_waitcnt lgkmcnt(7)
    v_mfma_f32_32x32x16_bf16 v[80:95], v[240:243], v[48:51], v[80:95]
    ds_read_b128 v[240:243], v13 offset:16384
    v_add_f32 v23, v23, v112
    v_add_f32 v23, v23, v113
    v_cvt_pk_bf16_f32 v112, v112, v113
    s_waitcnt lgkmcnt(7)
    v_mfma_f32_32x32x16_bf16 v[80:95], v[244:247], v[52:55], v[80:95]
    ds_read_b128 v[244:247], v14 offset:16384
    v_add_f32 v24, v24, v114
    v_add_f32 v24, v24, v115
    s_add_u32 s3, s32, 52224
    buffer_load_dwordx4 v2, s[12:15], s3 offen offset:1024 lds
    v_cvt_pk_bf16_f32 v113, v114, v115
    v_add_f32 v25, v25, v116
    s_waitcnt lgkmcnt(7)
    v_mfma_f32_32x32x16_bf16 v[80:95], v[248:251], v[56:59], v[80:95]
    ds_read_b128 v[248:251], v15 offset:16384
    v_add_f32 v25, v25, v117
    v_cvt_pk_bf16_f32 v114, v116, v117
    v_add_f32 v26, v26, v118
    s_waitcnt lgkmcnt(7)
    v_mfma_f32_32x32x16_bf16 v[80:95], v[252:255], v[60:63], v[80:95]
    ds_read_b128 v[252:255], v16 offset:16384
    v_add_f32 v26, v26, v119
    v_cvt_pk_bf16_f32 v115, v118, v119
    v_fma_f32 v120, v120, s51, v22
    v_fma_f32 v121, v121, s51, v22
    v_mfma_f32_32x32x16_bf16 v[160:175], v[128:131], v[96:99], v[160:175]
    ds_read_b128 v[144:147], v20 offset:20480
    v_fma_f32 v122, v122, s51, v22
    v_fma_f32 v123, v123, s51, v22
    v_fma_f32 v124, v124, s51, v22
    v_mfma_f32_32x32x16_bf16 v[176:191], v[132:135], v[96:99], v[176:191]
    ds_read_b128 v[148:151], v20 offset:21504
    v_fma_f32 v125, v125, s51, v22
    v_fma_f32 v126, v126, s51, v22
    v_fma_f32 v127, v127, s51, v22
    v_exp_f32 v120, v120
    v_mfma_f32_32x32x16_bf16 v[192:207], v[136:139], v[96:99], v[192:207]
    ds_read_b128 v[152:155], v20 offset:22528
    v_exp_f32 v121, v121
    v_exp_f32 v122, v122
    v_exp_f32 v123, v123
    v_mfma_f32_32x32x16_bf16 v[208:223], v[140:143], v[96:99], v[208:223]
    ds_read_b128 v[156:159], v20 offset:23552
    v_exp_f32 v124, v124
    v_exp_f32 v125, v125
    v_exp_f32 v126, v126
    v_exp_f32 v127, v127
    s_waitcnt lgkmcnt(3)
    v_mfma_f32_32x32x16_bf16 v[160:175], v[144:147], v[104:107], v[160:175]
    ds_read_b128 v[128:131], v20 offset:24576
    v_add_f32 v23, v23, v120
    v_add_f32 v23, v23, v121
    v_cvt_pk_bf16_f32 v120, v120, v121
    s_waitcnt lgkmcnt(3)
    v_mfma_f32_32x32x16_bf16 v[176:191], v[148:151], v[104:107], v[176:191]
    ds_read_b128 v[132:135], v20 offset:25600
    v_add_f32 v24, v24, v122
    v_add_f32 v24, v24, v123
    v_cvt_pk_bf16_f32 v121, v122, v123
    v_add_f32 v25, v25, v124
    s_waitcnt lgkmcnt(3)
    v_mfma_f32_32x32x16_bf16 v[192:207], v[152:155], v[104:107], v[192:207]
    ds_read_b128 v[136:139], v20 offset:26624
    v_add_f32 v25, v25, v125
    v_cvt_pk_bf16_f32 v122, v124, v125
    v_add_f32 v26, v26, v126
    s_waitcnt lgkmcnt(3)
    v_mfma_f32_32x32x16_bf16 v[208:223], v[156:159], v[104:107], v[208:223]
    ds_read_b128 v[140:143], v20 offset:27648
    v_add_f32 v26, v26, v127
    v_cvt_pk_bf16_f32 v123, v126, v127
    v_fma_f32 v64, v64, s51, v22
    v_fma_f32 v65, v65, s51, v22
    s_waitcnt lgkmcnt(3)
    v_mfma_f32_32x32x16_bf16 v[160:175], v[128:131], v[112:115], v[160:175]
    ds_read_b128 v[144:147], v20 offset:28672
    v_fma_f32 v66, v66, s51, v22
    v_fma_f32 v67, v67, s51, v22
    v_fma_f32 v68, v68, s51, v22
    s_waitcnt lgkmcnt(3)
    v_mfma_f32_32x32x16_bf16 v[176:191], v[132:135], v[112:115], v[176:191]
    ds_read_b128 v[148:151], v20 offset:29696
    v_fma_f32 v69, v69, s51, v22
    v_fma_f32 v70, v70, s51, v22
    v_fma_f32 v71, v71, s51, v22
    v_exp_f32 v64, v64
    s_waitcnt lgkmcnt(3)
    v_mfma_f32_32x32x16_bf16 v[192:207], v[136:139], v[112:115], v[192:207]
    ds_read_b128 v[152:155], v20 offset:30720
    v_exp_f32 v65, v65
    v_exp_f32 v66, v66
    v_exp_f32 v67, v67
    s_waitcnt lgkmcnt(3)
    v_mfma_f32_32x32x16_bf16 v[208:223], v[140:143], v[112:115], v[208:223]
    ds_read_b128 v[156:159], v20 offset:31744
    v_exp_f32 v68, v68
    v_exp_f32 v69, v69
    v_exp_f32 v70, v70
    v_add_u32 v20, 98304, v27
    v_exp_f32 v71, v71
    s_waitcnt lgkmcnt(3)
    v_mfma_f32_32x32x16_bf16 v[160:175], v[144:147], v[120:123], v[160:175]
    v_add_f32 v23, v23, v64
    v_add_f32 v23, v23, v65
    ds_read_b128 v[128:131], v20 offset:0
    v_cvt_pk_bf16_f32 v64, v64, v65
    s_waitcnt lgkmcnt(3)
    v_mfma_f32_32x32x16_bf16 v[176:191], v[148:151], v[120:123], v[176:191]
    v_add_f32 v24, v24, v66
    v_add_f32 v24, v24, v67
    ds_read_b128 v[132:135], v20 offset:1024
    v_cvt_pk_bf16_f32 v65, v66, v67
    v_add_f32 v25, v25, v68
    s_waitcnt lgkmcnt(3)
    v_mfma_f32_32x32x16_bf16 v[192:207], v[152:155], v[120:123], v[192:207]
    v_add_f32 v25, v25, v69
    ds_read_b128 v[136:139], v20 offset:2048
    v_cvt_pk_bf16_f32 v66, v68, v69
    v_add_f32 v26, v26, v70
    s_waitcnt lgkmcnt(3)
    v_mfma_f32_32x32x16_bf16 v[208:223], v[156:159], v[120:123], v[208:223]
    v_add_f32 v26, v26, v71
    ds_read_b128 v[140:143], v20 offset:3072
    v_cvt_pk_bf16_f32 v67, v70, v71
    v_fma_f32 v72, v72, s51, v22
    v_fma_f32 v73, v73, s51, v22
    v_mfma_f32_32x32x16_bf16 v[96:111], v[224:227], v[32:35], 0
    ds_read_b128 v[224:227], v9 offset:24576
    v_fma_f32 v74, v74, s51, v22
    v_fma_f32 v75, v75, s51, v22
    v_fma_f32 v76, v76, s51, v22
    v_mfma_f32_32x32x16_bf16 v[96:111], v[228:231], v[36:39], v[96:111]
    ds_read_b128 v[228:231], v10 offset:24576
    v_fma_f32 v77, v77, s51, v22
    v_fma_f32 v78, v78, s51, v22
    v_fma_f32 v79, v79, s51, v22
    v_exp_f32 v72, v72
    v_mfma_f32_32x32x16_bf16 v[96:111], v[232:235], v[40:43], v[96:111]
    ds_read_b128 v[232:235], v11 offset:24576
    v_exp_f32 v73, v73
    v_exp_f32 v74, v74
    v_exp_f32 v75, v75
    v_mfma_f32_32x32x16_bf16 v[96:111], v[236:239], v[44:47], v[96:111]
    ds_read_b128 v[236:239], v12 offset:24576
    v_exp_f32 v76, v76
    v_exp_f32 v77, v77
    v_exp_f32 v78, v78
    v_exp_f32 v79, v79
    v_mfma_f32_32x32x16_bf16 v[96:111], v[240:243], v[48:51], v[96:111]
    ds_read_b128 v[240:243], v13 offset:24576
    v_add_f32 v23, v23, v72
    v_add_f32 v23, v23, v73
    v_cvt_pk_bf16_f32 v72, v72, v73
    v_mfma_f32_32x32x16_bf16 v[96:111], v[244:247], v[52:55], v[96:111]
    ds_read_b128 v[244:247], v14 offset:24576
    v_add_f32 v24, v24, v74
    v_add_f32 v24, v24, v75
    v_cvt_pk_bf16_f32 v73, v74, v75
    v_add_f32 v25, v25, v76
    v_mfma_f32_32x32x16_bf16 v[96:111], v[248:251], v[56:59], v[96:111]
    ds_read_b128 v[248:251], v15 offset:24576
    v_add_f32 v25, v25, v77
    v_cvt_pk_bf16_f32 v74, v76, v77
    v_add_f32 v26, v26, v78
    v_mfma_f32_32x32x16_bf16 v[96:111], v[252:255], v[60:63], v[96:111]
    ds_read_b128 v[252:255], v16 offset:24576
    v_add_f32 v26, v26, v79
    v_cvt_pk_bf16_f32 v75, v78, v79
    v_fma_f32 v80, v80, s51, v22
    v_fma_f32 v81, v81, s51, v22
    s_waitcnt lgkmcnt(7)
    v_mfma_f32_32x32x16_bf16 v[112:127], v[224:227], v[32:35], 0
    v_fma_f32 v82, v82, s51, v22
    v_fma_f32 v83, v83, s51, v22
    v_fma_f32 v84, v84, s51, v22
    s_waitcnt lgkmcnt(6)
    v_mfma_f32_32x32x16_bf16 v[112:127], v[228:231], v[36:39], v[112:127]
    v_fma_f32 v85, v85, s51, v22
    v_fma_f32 v86, v86, s51, v22
    v_fma_f32 v87, v87, s51, v22
    v_exp_f32 v80, v80
    s_waitcnt lgkmcnt(5)
    v_mfma_f32_32x32x16_bf16 v[112:127], v[232:235], v[40:43], v[112:127]
    v_exp_f32 v81, v81
    v_exp_f32 v82, v82
    v_exp_f32 v83, v83
    s_waitcnt lgkmcnt(4)
    v_mfma_f32_32x32x16_bf16 v[112:127], v[236:239], v[44:47], v[112:127]
    v_exp_f32 v84, v84
    v_exp_f32 v85, v85
    v_exp_f32 v86, v86
    v_exp_f32 v87, v87
    s_waitcnt lgkmcnt(3)
    v_mfma_f32_32x32x16_bf16 v[112:127], v[240:243], v[48:51], v[112:127]
    v_add_f32 v23, v23, v80
    v_add_f32 v23, v23, v81
    v_cvt_pk_bf16_f32 v80, v80, v81
    s_waitcnt lgkmcnt(2)
    v_mfma_f32_32x32x16_bf16 v[112:127], v[244:247], v[52:55], v[112:127]
    v_add_f32 v24, v24, v82
    v_add_f32 v24, v24, v83
    v_cvt_pk_bf16_f32 v81, v82, v83
    v_add_f32 v25, v25, v84
    s_waitcnt lgkmcnt(1)
    v_mfma_f32_32x32x16_bf16 v[112:127], v[248:251], v[56:59], v[112:127]
    v_add_f32 v25, v25, v85
    v_cvt_pk_bf16_f32 v82, v84, v85
    v_add_f32 v26, v26, v86
    s_waitcnt lgkmcnt(0)
    v_mfma_f32_32x32x16_bf16 v[112:127], v[252:255], v[60:63], v[112:127]
    v_add_f32 v26, v26, v87
    v_cvt_pk_bf16_f32 v83, v86, v87
    v_fma_f32 v88, v88, s51, v22
    v_fma_f32 v89, v89, s51, v22
    v_mfma_f32_32x32x16_bf16 v[160:175], v[128:131], v[64:67], v[160:175]
    ds_read_b128 v[144:147], v20 offset:4096
    v_fma_f32 v90, v90, s51, v22
    v_fma_f32 v91, v91, s51, v22
    v_fma_f32 v92, v92, s51, v22
    v_mfma_f32_32x32x16_bf16 v[176:191], v[132:135], v[64:67], v[176:191]
    ds_read_b128 v[148:151], v20 offset:5120
    v_fma_f32 v93, v93, s51, v22
    v_fma_f32 v94, v94, s51, v22
    v_fma_f32 v95, v95, s51, v22
    v_exp_f32 v88, v88
    v_mfma_f32_32x32x16_bf16 v[192:207], v[136:139], v[64:67], v[192:207]
    ds_read_b128 v[152:155], v20 offset:6144
    v_exp_f32 v89, v89
    v_exp_f32 v90, v90
    v_exp_f32 v91, v91
    v_mfma_f32_32x32x16_bf16 v[208:223], v[140:143], v[64:67], v[208:223]
    ds_read_b128 v[156:159], v20 offset:7168
    v_exp_f32 v92, v92
    v_exp_f32 v93, v93
    v_exp_f32 v94, v94
    v_exp_f32 v95, v95
    s_waitcnt lgkmcnt(3)
    v_mfma_f32_32x32x16_bf16 v[160:175], v[144:147], v[72:75], v[160:175]
    ds_read_b128 v[128:131], v20 offset:8192
    v_add_f32 v23, v23, v88
    v_add_f32 v23, v23, v89
    v_cvt_pk_bf16_f32 v88, v88, v89
    s_waitcnt lgkmcnt(3)
    v_mfma_f32_32x32x16_bf16 v[176:191], v[148:151], v[72:75], v[176:191]
    ds_read_b128 v[132:135], v20 offset:9216
    v_add_f32 v24, v24, v90
    v_add_f32 v24, v24, v91
    v_cvt_pk_bf16_f32 v89, v90, v91
    v_add_f32 v25, v25, v92
    s_waitcnt lgkmcnt(3)
    v_mfma_f32_32x32x16_bf16 v[192:207], v[152:155], v[72:75], v[192:207]
    ds_read_b128 v[136:139], v20 offset:10240
    v_add_f32 v25, v25, v93
    v_cvt_pk_bf16_f32 v90, v92, v93
    v_add_f32 v26, v26, v94
    s_waitcnt lgkmcnt(3)
    v_mfma_f32_32x32x16_bf16 v[208:223], v[156:159], v[72:75], v[208:223]
    ds_read_b128 v[140:143], v20 offset:11264
    v_add_f32 v26, v26, v95
    v_cvt_pk_bf16_f32 v91, v94, v95
    v_fma_f32 v96, v96, s51, v22
    v_fma_f32 v97, v97, s51, v22
    s_waitcnt lgkmcnt(3)
    v_mfma_f32_32x32x16_bf16 v[160:175], v[128:131], v[80:83], v[160:175]
    ds_read_b128 v[144:147], v20 offset:12288
    v_fma_f32 v98, v98, s51, v22
    v_fma_f32 v99, v99, s51, v22
    v_fma_f32 v100, v100, s51, v22
    s_waitcnt lgkmcnt(3)
    v_mfma_f32_32x32x16_bf16 v[176:191], v[132:135], v[80:83], v[176:191]
    ds_read_b128 v[148:151], v20 offset:13312
    v_fma_f32 v101, v101, s51, v22
    v_fma_f32 v102, v102, s51, v22
    v_fma_f32 v103, v103, s51, v22
    v_exp_f32 v96, v96
    s_waitcnt lgkmcnt(3)
    v_mfma_f32_32x32x16_bf16 v[192:207], v[136:139], v[80:83], v[192:207]
    ds_read_b128 v[152:155], v20 offset:14336
    v_exp_f32 v97, v97
    v_exp_f32 v98, v98
    v_exp_f32 v99, v99
    s_waitcnt lgkmcnt(3)
    v_mfma_f32_32x32x16_bf16 v[208:223], v[140:143], v[80:83], v[208:223]
    ds_read_b128 v[156:159], v20 offset:15360
    v_exp_f32 v100, v100
    v_exp_f32 v101, v101
    v_exp_f32 v102, v102
    v_exp_f32 v103, v103
    s_waitcnt lgkmcnt(3)
    v_mfma_f32_32x32x16_bf16 v[160:175], v[144:147], v[88:91], v[160:175]
    ds_read_b128 v[128:131], v20 offset:16384
    v_add_f32 v23, v23, v96
    v_add_f32 v23, v23, v97
    v_cvt_pk_bf16_f32 v96, v96, v97
    s_waitcnt lgkmcnt(3)
    v_mfma_f32_32x32x16_bf16 v[176:191], v[148:151], v[88:91], v[176:191]
    ds_read_b128 v[132:135], v20 offset:17408
    v_add_f32 v24, v24, v98
    v_add_f32 v24, v24, v99
    v_cvt_pk_bf16_f32 v97, v98, v99
    v_add_f32 v25, v25, v100
    s_waitcnt lgkmcnt(3)
    v_mfma_f32_32x32x16_bf16 v[192:207], v[152:155], v[88:91], v[192:207]
    ds_read_b128 v[136:139], v20 offset:18432
    v_add_f32 v25, v25, v101
    v_cvt_pk_bf16_f32 v98, v100, v101
    v_add_f32 v26, v26, v102
    s_waitcnt lgkmcnt(3)
    v_mfma_f32_32x32x16_bf16 v[208:223], v[156:159], v[88:91], v[208:223]
    ds_read_b128 v[140:143], v20 offset:19456
    v_add_f32 v26, v26, v103
    v_cvt_pk_bf16_f32 v99, v102, v103
    s_barrier
    s_add_u32 m0, s29, 32768
    s_add_u32 s3, s32, 131072
    buffer_load_dwordx4 v2, s[12:15], s3 offen lds
    s_add_u32 s3, s32, 146432
    buffer_load_dwordx4 v2, s[12:15], s3 offen offset:1024 lds
    s_add_u32 m0, s29, 34816
    s_add_u32 s3, s32, 135168
    buffer_load_dwordx4 v2, s[12:15], s3 offen lds
    s_add_u32 s3, s32, 150528
    buffer_load_dwordx4 v2, s[12:15], s3 offen offset:1024 lds
    v_fma_f32 v104, v104, s51, v22
    v_fma_f32 v105, v105, s51, v22
    v_fma_f32 v106, v106, s51, v22
    v_fma_f32 v107, v107, s51, v22
    s_waitcnt lgkmcnt(3)
    v_mfma_f32_32x32x16_bf16 v[160:175], v[128:131], v[96:99], v[160:175]
    ds_read_b128 v[144:147], v20 offset:20480
    v_fma_f32 v108, v108, s51, v22
    v_fma_f32 v109, v109, s51, v22
    v_fma_f32 v110, v110, s51, v22
    v_fma_f32 v111, v111, s51, v22
    v_exp_f32 v104, v104
    v_exp_f32 v105, v105
    v_exp_f32 v106, v106
    v_exp_f32 v107, v107
    s_waitcnt lgkmcnt(3)
    v_mfma_f32_32x32x16_bf16 v[176:191], v[132:135], v[96:99], v[176:191]
    ds_read_b128 v[148:151], v20 offset:21504
    v_exp_f32 v108, v108
    v_exp_f32 v109, v109
    v_exp_f32 v110, v110
    v_exp_f32 v111, v111
    v_add_f32 v23, v23, v104
    v_add_f32 v23, v23, v105
    v_cvt_pk_bf16_f32 v104, v104, v105
    s_waitcnt lgkmcnt(3)
    v_mfma_f32_32x32x16_bf16 v[192:207], v[136:139], v[96:99], v[192:207]
    ds_read_b128 v[152:155], v20 offset:22528
    v_add_f32 v24, v24, v106
    v_add_f32 v24, v24, v107
    v_cvt_pk_bf16_f32 v105, v106, v107
    v_add_f32 v25, v25, v108
    v_add_f32 v25, v25, v109
    v_cvt_pk_bf16_f32 v106, v108, v109
    v_add_f32 v26, v26, v110
    v_add_f32 v26, v26, v111
    s_waitcnt lgkmcnt(3)
    v_mfma_f32_32x32x16_bf16 v[208:223], v[140:143], v[96:99], v[208:223]
    ds_read_b128 v[156:159], v20 offset:23552
    v_cvt_pk_bf16_f32 v107, v110, v111
    v_add_u32 v13, 131072, v5
    v_add_u32 v14, 131072, v6
    v_add_u32 v15, 131072, v7
    v_fma_f32 v112, v112, s51, v22
    v_fma_f32 v113, v113, s51, v22
    v_fma_f32 v114, v114, s51, v22
    v_fma_f32 v115, v115, s51, v22
    s_waitcnt lgkmcnt(3)
    v_mfma_f32_32x32x16_bf16 v[160:175], v[144:147], v[104:107], v[160:175]
    ds_read_b128 v[128:131], v20 offset:24576
    v_fma_f32 v116, v116, s51, v22
    v_fma_f32 v117, v117, s51, v22
    v_fma_f32 v118, v118, s51, v22
    v_fma_f32 v119, v119, s51, v22
    v_exp_f32 v112, v112
    v_exp_f32 v113, v113
    v_exp_f32 v114, v114
    v_exp_f32 v115, v115
    v_exp_f32 v116, v116
    s_waitcnt lgkmcnt(3)
    v_mfma_f32_32x32x16_bf16 v[176:191], v[148:151], v[104:107], v[176:191]
    ds_read_b128 v[132:135], v20 offset:25600
    v_exp_f32 v117, v117
    v_exp_f32 v118, v118
    v_exp_f32 v119, v119
    v_add_f32 v23, v23, v112
    v_add_f32 v23, v23, v113
    v_cvt_pk_bf16_f32 v112, v112, v113
    v_add_f32 v24, v24, v114
    v_add_f32 v24, v24, v115
    s_waitcnt lgkmcnt(3)
    v_mfma_f32_32x32x16_bf16 v[192:207], v[152:155], v[104:107], v[192:207]
    ds_read_b128 v[136:139], v20 offset:26624
    v_cvt_pk_bf16_f32 v113, v114, v115
    v_add_f32 v25, v25, v116
    v_add_f32 v25, v25, v117
    v_cvt_pk_bf16_f32 v114, v116, v117
    v_add_f32 v26, v26, v118
    v_add_f32 v26, v26, v119
    v_cvt_pk_bf16_f32 v115, v118, v119
    v_add_u32 v16, 131072, v8
    v_and_b32 v3, 0x7ff, v3
    s_waitcnt lgkmcnt(3)
    v_mfma_f32_32x32x16_bf16 v[208:223], v[156:159], v[104:107], v[208:223]
    ds_read_b128 v[140:143], v20 offset:27648
    v_add_u32 v4, 81920, v3
    v_add_u32 v3, 65536, v3
    s_lshl_b32 s34, s28, 14
    s_lshl_b32 s35, s27, 12
    s_add_u32 s34, s34, s35
    s_add_u32 s34, s34, 65536
    v_add_u32 v9, s34, v27
    v_fma_f32 v120, v120, s51, v22
    v_fma_f32 v121, v121, s51, v22
    v_fma_f32 v122, v122, s51, v22
    s_waitcnt lgkmcnt(3)
    v_mfma_f32_32x32x16_bf16 v[160:175], v[128:131], v[112:115], v[160:175]
    ds_read_b128 v[144:147], v20 offset:28672
    v_fma_f32 v123, v123, s51, v22
    v_fma_f32 v124, v124, s51, v22
    v_fma_f32 v125, v125, s51, v22
    v_fma_f32 v126, v126, s51, v22
    v_fma_f32 v127, v127, s51, v22
    v_exp_f32 v120, v120
    v_exp_f32 v121, v121
    s_waitcnt lgkmcnt(3)
    v_mfma_f32_32x32x16_bf16 v[176:191], v[132:135], v[112:115], v[176:191]
    ds_read_b128 v[148:151], v20 offset:29696
    v_exp_f32 v122, v122
    v_exp_f32 v123, v123
    v_exp_f32 v124, v124
    v_exp_f32 v125, v125
    v_exp_f32 v126, v126
    v_exp_f32 v127, v127
    v_add_f32 v23, v23, v120
    s_waitcnt lgkmcnt(3)
    v_mfma_f32_32x32x16_bf16 v[192:207], v[136:139], v[112:115], v[192:207]
    ds_read_b128 v[152:155], v20 offset:30720
    v_add_f32 v23, v23, v121
    v_cvt_pk_bf16_f32 v120, v120, v121
    v_add_f32 v24, v24, v122
    v_add_f32 v24, v24, v123
    v_cvt_pk_bf16_f32 v121, v122, v123
    v_add_f32 v25, v25, v124
    v_add_f32 v25, v25, v125
    s_waitcnt lgkmcnt(3)
    v_mfma_f32_32x32x16_bf16 v[208:223], v[140:143], v[112:115], v[208:223]
    ds_read_b128 v[156:159], v20 offset:31744
    v_cvt_pk_bf16_f32 v122, v124, v125
    v_add_f32 v26, v26, v126
    v_add_f32 v26, v26, v127
    v_cvt_pk_bf16_f32 v123, v126, v127
    v_add_f32 v23, v23, v24
    s_waitcnt vmcnt(10)
    ds_read_b64_tr_b16 v[224:225], v13 offset:0
    s_waitcnt lgkmcnt(4)
    v_mfma_f32_32x32x16_bf16 v[160:175], v[144:147], v[120:123], v[160:175]
    v_add_f32 v25, v25, v26
    s_waitcnt vmcnt(8)
    ds_read_b64_tr_b16 v[226:227], v13 offset:2048
    v_add_f32 v23, v23, v25
    ds_read_b64_tr_b16 v[232:233], v14 offset:0
    s_waitcnt lgkmcnt(5)
    v_mfma_f32_32x32x16_bf16 v[176:191], v[148:151], v[120:123], v[176:191]
    v_mov_b32 v24, v23
    ds_read_b64_tr_b16 v[234:235], v14 offset:2048
    s_nop 1
    ds_read_b64_tr_b16 v[236:237], v15 offset:0
    v_permlane32_swap_b32 v23, v24
    s_waitcnt lgkmcnt(6)
    v_mfma_f32_32x32x16_bf16 v[192:207], v[152:155], v[120:123], v[192:207]
    ds_read_b64_tr_b16 v[238:239], v15 offset:2048
    v_add_f32 v24, v23, v24
    ds_read_b64_tr_b16 v[240:241], v16 offset:0
    v_rcp_f32 v23, v24
    s_waitcnt lgkmcnt(7)
    v_mfma_f32_32x32x16_bf16 v[208:223], v[156:159], v[120:123], v[208:223]
    ds_read_b64_tr_b16 v[242:243], v16 offset:2048
    v_cmp_nle_f32 vcc, v24, 1.0
    s_nop 1
    s_cbranch_vccnz K1_fb
K1_fbr:
    v_mul_f32 v160, v160, v23
    v_mul_f32 v161, v161, v23
    v_mul_f32 v162, v162, v23
    v_mul_f32 v163, v163, v23
    v_mul_f32 v164, v164, v23
    v_mul_f32 v165, v165, v23
    v_mul_f32 v166, v166, v23
    v_mul_f32 v167, v167, v23
    v_cvt_pk_bf16_f32 v32, v160, v161
    v_cvt_pk_bf16_f32 v33, v162, v163
    v_cvt_pk_bf16_f32 v34, v164, v165
    v_cvt_pk_bf16_f32 v35, v166, v167
    ds_write_b128 v9, v[32:35] offset:0
    v_mul_f32 v168, v168, v23
    v_mul_f32 v169, v169, v23
    v_mul_f32 v170, v170, v23
    v_mul_f32 v171, v171, v23
    v_mul_f32 v172, v172, v23
    v_mul_f32 v173, v173, v23
    v_mul_f32 v174, v174, v23
    v_mul_f32 v175, v175, v23
    v_cvt_pk_bf16_f32 v36, v168, v169
    v_cvt_pk_bf16_f32 v37, v170, v171
    v_cvt_pk_bf16_f32 v38, v172, v173
    v_cvt_pk_bf16_f32 v39, v174, v175
    ds_write_b128 v9, v[36:39] offset:1024
    v_mul_f32 v176, v176, v23
    v_mul_f32 v177, v177, v23
    v_mul_f32 v178, v178, v23
    v_mul_f32 v179, v179, v23
    v_mul_f32 v180, v180, v23
    v_mul_f32 v181, v181, v23
    v_mul_f32 v182, v182, v23
    v_mul_f32 v183, v183, v23
    v_cvt_pk_bf16_f32 v40, v176, v177
    v_cvt_pk_bf16_f32 v41, v178, v179
    v_cvt_pk_bf16_f32 v42, v180, v181
    v_cvt_pk_bf16_f32 v43, v182, v183
    ds_write_b128 v9, v[40:43] offset:2048
    v_mul_f32 v184, v184, v23
    v_mul_f32 v185, v185, v23
    v_mul_f32 v186, v186, v23
    v_mul_f32 v187, v187, v23
    v_mul_f32 v188, v188, v23
    v_mul_f32 v189, v189, v23
    v_mul_f32 v190, v190, v23
    v_mul_f32 v191, v191, v23
    v_cvt_pk_bf16_f32 v44, v184, v185
    v_cvt_pk_bf16_f32 v45, v186, v187
    v_cvt_pk_bf16_f32 v46, v188, v189
    v_cvt_pk_bf16_f32 v47, v190, v191
    ds_write_b128 v9, v[44:47] offset:3072
    s_waitcnt lgkmcnt(0)
    s_barrier
    ds_read_b128 v[228:231], v3 offset:0
    ds_read_b128 v[244:247], v3 offset:256
    ds_read_b128 v[248:251], v4 offset:0
    v_mul_f32 v192, v192, v23
    v_mul_f32 v193, v193, v23
    v_mul_f32 v194, v194, v23
    v_mul_f32 v195, v195, v23
    v_mul_f32 v196, v196, v23
    v_mul_f32 v197, v197, v23
    v_mul_f32 v198, v198, v23
    v_mul_f32 v199, v199, v23
    v_cvt_pk_bf16_f32 v48, v192, v193
    v_cvt_pk_bf16_f32 v49, v194, v195
    v_cvt_pk_bf16_f32 v50, v196, v197
    v_cvt_pk_bf16_f32 v51, v198, v199
    ds_write_b128 v9, v[48:51] offset:32768
    s_setprio 3
    s_waitcnt lgkmcnt(3)
    v_mfma_f32_16x16x32_bf16 v[64:67], v[224:227], v[228:231], 0
    v_mfma_f32_16x16x32_bf16 v[68:71], v[232:235], v[228:231], 0
    v_mul_f32 v200, v200, v23
    v_mfma_f32_16x16x32_bf16 v[72:75], v[236:239], v[228:231], 0
    v_mul_f32 v201, v201, v23
    ds_read_b128 v[252:255], v4 offset:256
    v_mul_f32 v202, v202, v23
    v_mfma_f32_16x16x32_bf16 v[76:79], v[240:243], v[228:231], 0
    v_mul_f32 v203, v203, v23
    s_waitcnt lgkmcnt(3)
    v_mfma_f32_16x16x32_bf16 v[80:83], v[224:227], v[244:247], 0
    v_mul_f32 v204, v204, v23
    s_add_u32 m0, s29, 131072
    s_add_u32 s3, s32, 163840
    buffer_load_dwordx4 v2, s[12:15], s3 offen lds
    v_mul_f32 v205, v205, v23
    v_mfma_f32_16x16x32_bf16 v[84:87], v[232:235], v[244:247], 0
    v_mul_f32 v206, v206, v23
    v_mfma_f32_16x16x32_bf16 v[88:91], v[236:239], v[244:247], 0
    v_mul_f32 v207, v207, v23
    s_waitcnt vmcnt(7)
    ds_read_b64_tr_b16 v[228:229], v5 offset:0
    v_cvt_pk_bf16_f32 v52, v200, v201
    s_waitcnt vmcnt(5)
    ds_read_b64_tr_b16 v[230:231], v5 offset:2048
    v_cvt_pk_bf16_f32 v53, v202, v203
    s_add_u32 s3, s32, 179200
    buffer_load_dwordx4 v2, s[12:15], s3 offen offset:1024 lds
    v_cvt_pk_bf16_f32 v54, v204, v205
    v_mfma_f32_16x16x32_bf16 v[92:95], v[240:243], v[244:247], 0
    v_cvt_pk_bf16_f32 v55, v206, v207
    ds_read_b128 v[244:247], v3 offset:2048
    ds_write_b128 v9, v[52:55] offset:33792
    s_waitcnt lgkmcnt(6)
    v_mfma_f32_16x16x32_bf16 v[96:99], v[224:227], v[248:251], 0
    v_mfma_f32_16x16x32_bf16 v[100:103], v[232:235], v[248:251], 0
    v_mul_f32 v208, v208, v23
    s_add_u32 m0, s29, 133120
    s_add_u32 s3, s32, 167936
    buffer_load_dwordx4 v2, s[12:15], s3 offen lds
    v_mul_f32 v209, v209, v23
    v_mfma_f32_16x16x32_bf16 v[104:107], v[236:239], v[248:251], 0
    s_add_u32 s3, s32, 183296
    buffer_load_dwordx4 v2, s[12:15], s3 offen offset:1024 lds
    v_mul_f32 v210, v210, v23
    v_mfma_f32_16x16x32_bf16 v[108:111], v[240:243], v[248:251], 0
    v_mul_f32 v211, v211, v23
    ds_read_b64_tr_b16 v[248:249], v6 offset:0
    v_mul_f32 v212, v212, v23
    ds_read_b64_tr_b16 v[250:251], v6 offset:2048
    s_waitcnt lgkmcnt(6)
    v_mfma_f32_16x16x32_bf16 v[112:115], v[224:227], v[252:255], 0
    v_mul_f32 v213, v213, v23
    ds_read_b64_tr_b16 v[224:225], v7 offset:0
    v_mul_f32 v214, v214, v23
    ds_read_b64_tr_b16 v[226:227], v7 offset:2048
    v_mfma_f32_16x16x32_bf16 v[116:119], v[232:235], v[252:255], 0
    v_mul_f32 v215, v215, v23
    ds_read_b64_tr_b16 v[232:233], v8 offset:0
    v_cvt_pk_bf16_f32 v56, v208, v209
    ds_read_b64_tr_b16 v[234:235], v8 offset:2048
    v_cvt_pk_bf16_f32 v57, v210, v211
    v_mfma_f32_16x16x32_bf16 v[120:123], v[236:239], v[252:255], 0
    ds_read_b128 v[236:239], v3 offset:2304
    v_cvt_pk_bf16_f32 v58, v212, v213
    v_mfma_f32_16x16x32_bf16 v[124:127], v[240:243], v[252:255], 0
    v_cvt_pk_bf16_f32 v59, v214, v215
    ds_read_b128 v[240:243], v4 offset:2048
    ds_write_b128 v9, v[56:59] offset:34816
    s_waitcnt lgkmcnt(10)
    v_mfma_f32_16x16x32_bf16 v[64:67], v[228:231], v[244:247], v[64:67]
    s_waitcnt lgkmcnt(7)
    v_mfma_f32_16x16x32_bf16 v[68:71], v[248:251], v[244:247], v[68:71]
    v_mul_f32 v216, v216, v23
    s_waitcnt lgkmcnt(5)
    v_mfma_f32_16x16x32_bf16 v[72:75], v[224:227], v[244:247], v[72:75]
    v_mul_f32 v217, v217, v23
    ds_read_b128 v[252:255], v4 offset:2304
    v_mul_f32 v218, v218, v23
    s_waitcnt lgkmcnt(4)
    v_mfma_f32_16x16x32_bf16 v[76:79], v[232:235], v[244:247], v[76:79]
    v_mul_f32 v219, v219, v23
    s_waitcnt lgkmcnt(3)
    v_mfma_f32_16x16x32_bf16 v[80:83], v[228:231], v[236:239], v[80:83]
    v_mul_f32 v220, v220, v23
    s_add_u32 m0, s29, 0
    s_add_u32 s3, s32, 262144
    buffer_load_dwordx4 v2, s[12:15], s3 offen lds
    v_mul_f32 v221, v221, v23
    v_mfma_f32_16x16x32_bf16 v[84:87], v[248:251], v[236:239], v[84:87]
    v_mul_f32 v222, v222, v23
    v_mfma_f32_16x16x32_bf16 v[88:91], v[224:227], v[236:239], v[88:91]
    v_mul_f32 v223, v223, v23
    s_waitcnt vmcnt(7)
    ds_read_b64_tr_b16 v[244:245], v5 offset:32768
    v_cvt_pk_bf16_f32 v60, v216, v217
    s_waitcnt vmcnt(5)
    ds_read_b64_tr_b16 v[246:247], v5 offset:34816
    v_cvt_pk_bf16_f32 v61, v218, v219
    s_add_u32 s3, s32, 277504
    buffer_load_dwordx4 v2, s[12:15], s3 offen offset:1024 lds
    v_cvt_pk_bf16_f32 v62, v220, v221
    v_mfma_f32_16x16x32_bf16 v[92:95], v[232:235], v[236:239], v[92:95]
    v_cvt_pk_bf16_f32 v63, v222, v223
    ds_read_b128 v[236:239], v3 offset:4096
    ds_write_b128 v9, v[60:63] offset:35840
    s_waitcnt lgkmcnt(6)
    v_mfma_f32_16x16x32_bf16 v[96:99], v[228:231], v[240:243], v[96:99]
    v_mfma_f32_16x16x32_bf16 v[100:103], v[248:251], v[240:243], v[100:103]
    s_add_u32 m0, s29, 2048
    s_add_u32 s3, s32, 266240
    buffer_load_dwordx4 v2, s[12:15], s3 offen lds
    v_mfma_f32_16x16x32_bf16 v[104:107], v[224:227], v[240:243], v[104:107]
    s_add_u32 s3, s32, 281600
    buffer_load_dwordx4 v2, s[12:15], s3 offen offset:1024 lds
    v_mfma_f32_16x16x32_bf16 v[108:111], v[232:235], v[240:243], v[108:111]
    ds_read_b64_tr_b16 v[240:241], v6 offset:32768
    ds_read_b64_tr_b16 v[242:243], v6 offset:34816
    s_waitcnt lgkmcnt(6)
    v_mfma_f32_16x16x32_bf16 v[112:115], v[228:231], v[252:255], v[112:115]
    ds_read_b64_tr_b16 v[228:229], v7 offset:32768
    ds_read_b64_tr_b16 v[230:231], v7 offset:34816
    v_mfma_f32_16x16x32_bf16 v[116:119], v[248:251], v[252:255], v[116:119]
    ds_read_b64_tr_b16 v[248:249], v8 offset:32768
    ds_read_b64_tr_b16 v[250:251], v8 offset:34816
    v_mfma_f32_16x16x32_bf16 v[120:123], v[224:227], v[252:255], v[120:123]
    ds_read_b128 v[224:227], v3 offset:4352
    v_mfma_f32_16x16x32_bf16 v[124:127], v[232:235], v[252:255], v[124:127]
    ds_read_b128 v[232:235], v4 offset:4096
    s_lshl_b32 s34, s25, 21
    s_lshl_b32 s35, s26, 16
    s_add_u32 s34, s34, s35
    s_add_u32 s34, s34, s29
    s_add_u32 s34, s34, 0x400000
    s_add_u32 s35, s34, 32768
    s_waitcnt lgkmcnt(9)
    v_mfma_f32_16x16x32_bf16 v[64:67], v[244:247], v[236:239], v[64:67]
    s_waitcnt lgkmcnt(6)
    v_mfma_f32_16x16x32_bf16 v[68:71], v[240:243], v[236:239], v[68:71]
    s_waitcnt lgkmcnt(4)
    v_mfma_f32_16x16x32_bf16 v[72:75], v[228:231], v[236:239], v[72:75]
    ds_read_b128 v[252:255], v4 offset:4352
    s_waitcnt lgkmcnt(3)
    v_mfma_f32_16x16x32_bf16 v[76:79], v[248:251], v[236:239], v[76:79]
    s_waitcnt lgkmcnt(2)
    v_mfma_f32_16x16x32_bf16 v[80:83], v[244:247], v[224:227], v[80:83]
    s_add_u32 m0, s29, 32768
    s_add_u32 s3, s32, 294912
    buffer_load_dwordx4 v2, s[12:15], s3 offen lds
    v_mfma_f32_16x16x32_bf16 v[84:87], v[240:243], v[224:227], v[84:87]
    v_mfma_f32_16x16x32_bf16 v[88:91], v[228:231], v[224:227], v[88:91]
    s_waitcnt vmcnt(7)
    ds_read_b64_tr_b16 v[236:237], v13 offset:0
    s_waitcnt vmcnt(5)
    ds_read_b64_tr_b16 v[238:239], v13 offset:2048
    s_add_u32 s3, s32, 310272
    buffer_load_dwordx4 v2, s[12:15], s3 offen offset:1024 lds
    v_mfma_f32_16x16x32_bf16 v[92:95], v[248:251], v[224:227], v[92:95]
    ds_read_b128 v[224:227], v3 offset:6144
    s_waitcnt lgkmcnt(0)
    s_barrier
    v_mfma_f32_16x16x32_bf16 v[96:99], v[244:247], v[232:235], v[96:99]
    v_mfma_f32_16x16x32_bf16 v[100:103], v[240:243], v[232:235], v[100:103]
    s_add_u32 m0, s29, 34816
    s_add_u32 s3, s32, 299008
    buffer_load_dwordx4 v2, s[12:15], s3 offen lds
    v_mfma_f32_16x16x32_bf16 v[104:107], v[228:231], v[232:235], v[104:107]
    s_add_u32 s3, s32, 314368
    buffer_load_dwordx4 v2, s[12:15], s3 offen offset:1024 lds
    v_mfma_f32_16x16x32_bf16 v[108:111], v[248:251], v[232:235], v[108:111]
    ds_read_b64_tr_b16 v[232:233], v14 offset:0
    ds_read_b64_tr_b16 v[234:235], v14 offset:2048
    v_mfma_f32_16x16x32_bf16 v[112:115], v[244:247], v[252:255], v[112:115]
    ds_read_b64_tr_b16 v[244:245], v15 offset:0
    ds_read_b64_tr_b16 v[246:247], v15 offset:2048
    v_mfma_f32_16x16x32_bf16 v[116:119], v[240:243], v[252:255], v[116:119]
    ds_read_b64_tr_b16 v[240:241], v16 offset:0
    ds_read_b64_tr_b16 v[242:243], v16 offset:2048
    v_mfma_f32_16x16x32_bf16 v[120:123], v[228:231], v[252:255], v[120:123]
    ds_read_b128 v[228:231], v3 offset:6400
    v_mfma_f32_16x16x32_bf16 v[124:127], v[248:251], v[252:255], v[124:127]
    ds_read_b128 v[248:251], v4 offset:6144
    v_mfma_f32_16x16x32_bf16 v[64:67], v[236:239], v[224:227], v[64:67]
    s_waitcnt lgkmcnt(6)
    v_mfma_f32_16x16x32_bf16 v[68:71], v[232:235], v[224:227], v[68:71]
    v_bfe_u32 v136, v27, 4, 1
    s_waitcnt lgkmcnt(4)
    v_mfma_f32_16x16x32_bf16 v[72:75], v[244:247], v[224:227], v[72:75]
    v_lshlrev_b32 v136, 4, v136
    ds_read_b128 v[252:255], v4 offset:6400
    s_waitcnt lgkmcnt(3)
    v_mfma_f32_16x16x32_bf16 v[76:79], v[240:243], v[224:227], v[76:79]
    v_mov_b32 v137, 0x3f80
    s_waitcnt lgkmcnt(2)
    v_mfma_f32_16x16x32_bf16 v[80:83], v[236:239], v[228:231], v[80:83]
    v_lshlrev_b32 v136, v136, v137
    s_add_u32 m0, s29, 131072
    s_add_u32 s3, s32, 393216
    buffer_load_dwordx4 v2, s[12:15], s3 offen lds
    v_bfe_u32 v137, v27, 5, 3
    v_mfma_f32_16x16x32_bf16 v[84:87], v[232:235], v[228:231], v[84:87]
    v_mfma_f32_16x16x32_bf16 v[88:91], v[244:247], v[228:231], v[88:91]
    v_cmp_eq_u32 vcc, 0, v137
    s_nop 1
    v_cndmask_b32 v128, 0, v136, vcc
    s_waitcnt vmcnt(7)
    ds_read_b64_tr_b16 v[224:225], v5 offset:0
    v_cmp_eq_u32 vcc, 1, v137
    s_nop 1
    v_cndmask_b32 v129, 0, v136, vcc
    s_waitcnt vmcnt(5)
    ds_read_b64_tr_b16 v[226:227], v5 offset:2048
    s_add_u32 s3, s32, 408576
    buffer_load_dwordx4 v2, s[12:15], s3 offen offset:1024 lds
    v_cmp_eq_u32 vcc, 2, v137
    s_nop 1
    v_cndmask_b32 v130, 0, v136, vcc
    v_mfma_f32_16x16x32_bf16 v[92:95], v[240:243], v[228:231], v[92:95]
    v_cmp_eq_u32 vcc, 3, v137
    s_nop 1
    v_cndmask_b32 v131, 0, v136, vcc
    ds_read_b128 v[228:231], v3 offset:8192
    s_nop 0
    v_mfma_f32_16x16x32_bf16 v[132:135], v[28:31], v[128:131], 0
    s_waitcnt lgkmcnt(4)
    v_mfma_f32_16x16x32_bf16 v[96:99], v[236:239], v[248:251], v[96:99]
    v_mfma_f32_16x16x32_bf16 v[100:103], v[232:235], v[248:251], v[100:103]
    s_add_u32 m0, s29, 133120
    s_add_u32 s3, s32, 397312
    buffer_load_dwordx4 v2, s[12:15], s3 offen lds
    v_mfma_f32_16x16x32_bf16 v[104:107], v[244:247], v[248:251], v[104:107]
    s_add_u32 s3, s32, 412672
    buffer_load_dwordx4 v2, s[12:15], s3 offen offset:1024 lds
    v_mfma_f32_16x16x32_bf16 v[108:111], v[240:243], v[248:251], v[108:111]
    ds_read_b64_tr_b16 v[248:249], v6 offset:0
    ds_read_b64_tr_b16 v[250:251], v6 offset:2048
    s_waitcnt lgkmcnt(5)
    v_mfma_f32_16x16x32_bf16 v[112:115], v[236:239], v[252:255], v[112:115]
    ds_read_b64_tr_b16 v[236:237], v7 offset:0
    ds_read_b64_tr_b16 v[238:239], v7 offset:2048
    v_mfma_f32_16x16x32_bf16 v[116:119], v[232:235], v[252:255], v[116:119]
    ds_read_b64_tr_b16 v[232:233], v8 offset:0
    ds_read_b64_tr_b16 v[234:235], v8 offset:2048
    v_mfma_f32_16x16x32_bf16 v[120:123], v[244:247], v[252:255], v[120:123]
    ds_read_b128 v[244:247], v3 offset:8448
    v_mfma_f32_16x16x32_bf16 v[124:127], v[240:243], v[252:255], v[124:127]
    ds_read_b128 v[240:243], v4 offset:8192
    s_setprio 2
    s_waitcnt lgkmcnt(8)
    v_mfma_f32_16x16x32_bf16 v[64:67], v[224:227], v[228:231], v[64:67]
    s_waitcnt lgkmcnt(6)
    v_mfma_f32_16x16x32_bf16 v[68:71], v[248:251], v[228:231], v[68:71]
    v_add_f32 v132, v132, v133
    s_waitcnt lgkmcnt(4)
    v_mfma_f32_16x16x32_bf16 v[72:75], v[236:239], v[228:231], v[72:75]
    v_add_f32 v134, v134, v135
    ds_read_b128 v[252:255], v4 offset:8448
    v_add_f32 v132, v132, v134
    s_waitcnt lgkmcnt(3)
    v_mfma_f32_16x16x32_bf16 v[76:79], v[232:235], v[228:231], v[76:79]
    v_mov_b32 v133, v132
    s_waitcnt lgkmcnt(2)
    v_mfma_f32_16x16x32_bf16 v[80:83], v[224:227], v[244:247], v[80:83]
    v_lshrrev_b32 v136, 2, v27
    s_add_u32 m0, s29, 0
    s_add_u32 s3, s32, 425984
    buffer_load_dwordx4 v2, s[12:15], s3 offen lds
    v_permlane16_swap_b32 v132, v133
    v_mfma_f32_16x16x32_bf16 v[84:87], v[248:251], v[244:247], v[84:87]
    v_mfma_f32_16x16x32_bf16 v[88:91], v[236:239], v[244:247], v[88:91]
    v_add_f32 v132, v132, v133
    s_waitcnt vmcnt(7)
    ds_read_b64_tr_b16 v[228:229], v5 offset:32768
    v_mov_b32 v133, v132
    s_waitcnt vmcnt(5)
    ds_read_b64_tr_b16 v[230:231], v5 offset:34816
    s_nop 0
    s_add_u32 s3, s32, 441344
    buffer_load_dwordx4 v2, s[12:15], s3 offen offset:1024 lds
    v_permlane32_swap_b32 v132, v133
    v_mfma_f32_16x16x32_bf16 v[92:95], v[232:235], v[244:247], v[92:95]
    v_add_f32 v132, v132, v133
    ds_read_b128 v[244:247], v3 offset:10240
    s_mov_b64 exec, 0xff
    buffer_store_dword v132, v136, s[16:19], s46 offen sc0 sc1
    s_mov_b64 exec, -1
    s_waitcnt lgkmcnt(4)
    v_mfma_f32_16x16x32_bf16 v[96:99], v[224:227], v[240:243], v[96:99]
    v_mfma_f32_16x16x32_bf16 v[100:103], v[248:251], v[240:243], v[100:103]
    s_add_u32 m0, s29, 2048
    s_add_u32 s3, s32, 430080
    buffer_load_dwordx4 v2, s[12:15], s3 offen lds
    v_mfma_f32_16x16x32_bf16 v[104:107], v[236:239], v[240:243], v[104:107]
    s_add_u32 s3, s32, 445440
    buffer_load_dwordx4 v2, s[12:15], s3 offen offset:1024 lds
    v_mfma_f32_16x16x32_bf16 v[108:111], v[232:235], v[240:243], v[108:111]
    ds_read_b64_tr_b16 v[240:241], v6 offset:32768
    ds_read_b64_tr_b16 v[242:243], v6 offset:34816
    s_waitcnt lgkmcnt(5)
    v_mfma_f32_16x16x32_bf16 v[112:115], v[224:227], v[252:255], v[112:115]
    ds_read_b64_tr_b16 v[224:225], v7 offset:32768
    ds_read_b64_tr_b16 v[226:227], v7 offset:34816
    v_mfma_f32_16x16x32_bf16 v[116:119], v[248:251], v[252:255], v[116:119]
    ds_read_b64_tr_b16 v[248:249], v8 offset:32768
    ds_read_b64_tr_b16 v[250:251], v8 offset:34816
    v_mfma_f32_16x16x32_bf16 v[120:123], v[236:239], v[252:255], v[120:123]
    ds_read_b128 v[236:239], v3 offset:10496
    v_mfma_f32_16x16x32_bf16 v[124:127], v[232:235], v[252:255], v[124:127]
    ds_read_b128 v[232:235], v4 offset:10240
    s_waitcnt lgkmcnt(8)
    v_mfma_f32_16x16x32_bf16 v[64:67], v[228:231], v[244:247], v[64:67]
    s_waitcnt lgkmcnt(6)
    v_mfma_f32_16x16x32_bf16 v[68:71], v[240:243], v[244:247], v[68:71]
    s_waitcnt lgkmcnt(4)
    v_mfma_f32_16x16x32_bf16 v[72:75], v[224:227], v[244:247], v[72:75]
    ds_read_b128 v[252:255], v4 offset:10496
    s_waitcnt lgkmcnt(3)
    v_mfma_f32_16x16x32_bf16 v[76:79], v[248:251], v[244:247], v[76:79]
    s_waitcnt lgkmcnt(2)
    v_mfma_f32_16x16x32_bf16 v[80:83], v[228:231], v[236:239], v[80:83]
    s_add_u32 m0, s29, 32768
    s_add_u32 s3, s32, 65536
    buffer_load_dwordx4 v2, s[12:15], s3 offen lds
    v_mfma_f32_16x16x32_bf16 v[84:87], v[240:243], v[236:239], v[84:87]
    v_mfma_f32_16x16x32_bf16 v[88:91], v[224:227], v[236:239], v[88:91]
    s_waitcnt vmcnt(8)
    ds_read_b64_tr_b16 v[244:245], v13 offset:0
    s_waitcnt vmcnt(6)
    ds_read_b64_tr_b16 v[246:247], v13 offset:2048
    s_add_u32 s3, s32, 80896
    buffer_load_dwordx4 v2, s[12:15], s3 offen offset:1024 lds
    v_mfma_f32_16x16x32_bf16 v[92:95], v[248:251], v[236:239], v[92:95]
    ds_read_b128 v[236:239], v3 offset:12288
    s_waitcnt lgkmcnt(4)
    v_mfma_f32_16x16x32_bf16 v[96:99], v[228:231], v[232:235], v[96:99]
    v_mfma_f32_16x16x32_bf16 v[100:103], v[240:243], v[232:235], v[100:103]
    s_add_u32 m0, s29, 34816
    s_add_u32 s3, s32, 69632
    buffer_load_dwordx4 v2, s[12:15], s3 offen lds
    v_mfma_f32_16x16x32_bf16 v[104:107], v[224:227], v[232:235], v[104:107]
    s_add_u32 s3, s32, 84992
    buffer_load_dwordx4 v2, s[12:15], s3 offen offset:1024 lds
    v_mfma_f32_16x16x32_bf16 v[108:111], v[248:251], v[232:235], v[108:111]
    ds_read_b64_tr_b16 v[232:233], v14 offset:0
    ds_read_b64_tr_b16 v[234:235], v14 offset:2048
    s_waitcnt lgkmcnt(5)
    v_mfma_f32_16x16x32_bf16 v[112:115], v[228:231], v[252:255], v[112:115]
    ds_read_b64_tr_b16 v[228:229], v15 offset:0
    ds_read_b64_tr_b16 v[230:231], v15 offset:2048
    v_mfma_f32_16x16x32_bf16 v[116:119], v[240:243], v[252:255], v[116:119]
    ds_read_b64_tr_b16 v[240:241], v16 offset:0
    ds_read_b64_tr_b16 v[242:243], v16 offset:2048
    v_mfma_f32_16x16x32_bf16 v[120:123], v[224:227], v[252:255], v[120:123]
    ds_read_b128 v[224:227], v3 offset:12544
    v_mfma_f32_16x16x32_bf16 v[124:127], v[248:251], v[252:255], v[124:127]
    ds_read_b128 v[248:251], v4 offset:12288
    s_waitcnt lgkmcnt(8)
    v_mfma_f32_16x16x32_bf16 v[64:67], v[244:247], v[236:239], v[64:67]
    s_waitcnt lgkmcnt(6)
    v_mfma_f32_16x16x32_bf16 v[68:71], v[232:235], v[236:239], v[68:71]
    s_waitcnt lgkmcnt(4)
    v_mfma_f32_16x16x32_bf16 v[72:75], v[228:231], v[236:239], v[72:75]
    ds_read_b128 v[252:255], v4 offset:12544
    s_waitcnt lgkmcnt(3)
    v_mfma_f32_16x16x32_bf16 v[76:79], v[240:243], v[236:239], v[76:79]
    s_waitcnt lgkmcnt(2)
    v_mfma_f32_16x16x32_bf16 v[80:83], v[244:247], v[224:227], v[80:83]
    s_add_u32 m0, s29, 131072
    s_add_u32 s3, s32, 98304
    buffer_load_dwordx4 v2, s[12:15], s3 offen lds
    v_mfma_f32_16x16x32_bf16 v[84:87], v[232:235], v[224:227], v[84:87]
    v_mfma_f32_16x16x32_bf16 v[88:91], v[228:231], v[224:227], v[88:91]
    s_waitcnt vmcnt(8)
    ds_read_b64_tr_b16 v[236:237], v5 offset:0
    s_waitcnt vmcnt(5)
    ds_read_b64_tr_b16 v[238:239], v5 offset:2048
    s_add_u32 s3, s32, 113664
    buffer_load_dwordx4 v2, s[12:15], s3 offen offset:1024 lds
    v_mfma_f32_16x16x32_bf16 v[92:95], v[240:243], v[224:227], v[92:95]
    ds_read_b128 v[224:227], v3 offset:14336
    s_waitcnt lgkmcnt(4)
    v_mfma_f32_16x16x32_bf16 v[96:99], v[244:247], v[248:251], v[96:99]
    v_mfma_f32_16x16x32_bf16 v[100:103], v[232:235], v[248:251], v[100:103]
    s_add_u32 m0, s29, 133120
    s_add_u32 s3, s32, 102400
    buffer_load_dwordx4 v2, s[12:15], s3 offen lds
    v_mfma_f32_16x16x32_bf16 v[104:107], v[228:231], v[248:251], v[104:107]
    s_add_u32 s3, s32, 117760
    buffer_load_dwordx4 v2, s[12:15], s3 offen offset:1024 lds
    v_mfma_f32_16x16x32_bf16 v[108:111], v[240:243], v[248:251], v[108:111]
    ds_read_b64_tr_b16 v[248:249], v6 offset:0
    ds_read_b64_tr_b16 v[250:251], v6 offset:2048
    s_waitcnt lgkmcnt(5)
    v_mfma_f32_16x16x32_bf16 v[112:115], v[244:247], v[252:255], v[112:115]
    ds_read_b64_tr_b16 v[244:245], v7 offset:0
    ds_read_b64_tr_b16 v[246:247], v7 offset:2048
    v_mfma_f32_16x16x32_bf16 v[116:119], v[232:235], v[252:255], v[116:119]
    ds_read_b64_tr_b16 v[232:233], v8 offset:0
    ds_read_b64_tr_b16 v[234:235], v8 offset:2048
    v_mfma_f32_16x16x32_bf16 v[120:123], v[228:231], v[252:255], v[120:123]
    ds_read_b128 v[228:231], v3 offset:14592
    v_mfma_f32_16x16x32_bf16 v[124:127], v[240:243], v[252:255], v[124:127]
    ds_read_b128 v[240:243], v4 offset:14336
    s_waitcnt lgkmcnt(8)
    v_mfma_f32_16x16x32_bf16 v[64:67], v[236:239], v[224:227], v[64:67]
    s_waitcnt lgkmcnt(6)
    v_mfma_f32_16x16x32_bf16 v[68:71], v[248:251], v[224:227], v[68:71]
    s_waitcnt lgkmcnt(4)
    v_mfma_f32_16x16x32_bf16 v[72:75], v[244:247], v[224:227], v[72:75]
    ds_read_b128 v[252:255], v4 offset:14592
    s_waitcnt lgkmcnt(3)
    v_mfma_f32_16x16x32_bf16 v[76:79], v[232:235], v[224:227], v[76:79]
    s_waitcnt lgkmcnt(2)
    v_mfma_f32_16x16x32_bf16 v[80:83], v[236:239], v[228:231], v[80:83]
    s_add_u32 m0, s29, 0
    s_add_u32 s3, s32, 196608
    buffer_load_dwordx4 v2, s[12:15], s3 offen lds
    v_mfma_f32_16x16x32_bf16 v[84:87], v[248:251], v[228:231], v[84:87]
    v_mfma_f32_16x16x32_bf16 v[88:91], v[244:247], v[228:231], v[88:91]
    s_waitcnt vmcnt(7)
    ds_read_b64_tr_b16 v[224:225], v5 offset:32768
    s_waitcnt vmcnt(5)
    ds_read_b64_tr_b16 v[226:227], v5 offset:34816
    s_add_u32 s3, s32, 211968
    buffer_load_dwordx4 v2, s[12:15], s3 offen offset:1024 lds
    v_mfma_f32_16x16x32_bf16 v[92:95], v[232:235], v[228:231], v[92:95]
    ds_read_b128 v[228:231], v3 offset:32768
    s_waitcnt lgkmcnt(4)
    v_mfma_f32_16x16x32_bf16 v[96:99], v[236:239], v[240:243], v[96:99]
    v_mfma_f32_16x16x32_bf16 v[100:103], v[248:251], v[240:243], v[100:103]
    s_add_u32 m0, s29, 2048
    s_add_u32 s3, s32, 200704
    buffer_load_dwordx4 v2, s[12:15], s3 offen lds
    v_mfma_f32_16x16x32_bf16 v[104:107], v[244:247], v[240:243], v[104:107]
    s_add_u32 s3, s32, 216064
    buffer_load_dwordx4 v2, s[12:15], s3 offen offset:1024 lds
    v_mfma_f32_16x16x32_bf16 v[108:111], v[232:235], v[240:243], v[108:111]
    ds_read_b64_tr_b16 v[240:241], v6 offset:32768
    ds_read_b64_tr_b16 v[242:243], v6 offset:34816
    s_waitcnt lgkmcnt(5)
    v_mfma_f32_16x16x32_bf16 v[112:115], v[236:239], v[252:255], v[112:115]
    ds_read_b64_tr_b16 v[236:237], v7 offset:32768
    ds_read_b64_tr_b16 v[238:239], v7 offset:34816
    v_mfma_f32_16x16x32_bf16 v[116:119], v[248:251], v[252:255], v[116:119]
    ds_read_b64_tr_b16 v[248:249], v8 offset:32768
    ds_read_b64_tr_b16 v[250:251], v8 offset:34816
    v_mfma_f32_16x16x32_bf16 v[120:123], v[244:247], v[252:255], v[120:123]
    ds_read_b128 v[244:247], v3 offset:33024
    v_mfma_f32_16x16x32_bf16 v[124:127], v[232:235], v[252:255], v[124:127]
    ds_read_b128 v[232:235], v4 offset:32768
    s_setprio 1
    s_waitcnt lgkmcnt(8)
    v_mfma_f32_16x16x32_bf16 v[64:67], v[224:227], v[228:231], v[64:67]
    s_waitcnt lgkmcnt(6)
    v_mfma_f32_16x16x32_bf16 v[68:71], v[240:243], v[228:231], v[68:71]
    s_waitcnt lgkmcnt(4)
    v_mfma_f32_16x16x32_bf16 v[72:75], v[236:239], v[228:231], v[72:75]
    ds_read_b128 v[252:255], v4 offset:33024
    s_waitcnt lgkmcnt(3)
    v_mfma_f32_16x16x32_bf16 v[76:79], v[248:251], v[228:231], v[76:79]
    s_waitcnt lgkmcnt(2)
    v_mfma_f32_16x16x32_bf16 v[80:83], v[224:227], v[244:247], v[80:83]
    s_add_u32 m0, s29, 32768
    s_add_u32 s3, s32, 229376
    buffer_load_dwordx4 v2, s[12:15], s3 offen lds
    v_mfma_f32_16x16x32_bf16 v[84:87], v[240:243], v[244:247], v[84:87]
    v_mfma_f32_16x16x32_bf16 v[88:91], v[236:239], v[244:247], v[88:91]
    s_waitcnt vmcnt(7)
    ds_read_b64_tr_b16 v[228:229], v13 offset:0
    s_waitcnt vmcnt(5)
    ds_read_b64_tr_b16 v[230:231], v13 offset:2048
    s_add_u32 s3, s32, 244736
    buffer_load_dwordx4 v2, s[12:15], s3 offen offset:1024 lds
    v_mfma_f32_16x16x32_bf16 v[92:95], v[248:251], v[244:247], v[92:95]
    ds_read_b128 v[244:247], v3 offset:34816
    s_waitcnt lgkmcnt(4)
    v_mfma_f32_16x16x32_bf16 v[96:99], v[224:227], v[232:235], v[96:99]
    v_mfma_f32_16x16x32_bf16 v[100:103], v[240:243], v[232:235], v[100:103]
    s_add_u32 m0, s29, 34816
    s_add_u32 s3, s32, 233472
    buffer_load_dwordx4 v2, s[12:15], s3 offen lds
    v_mfma_f32_16x16x32_bf16 v[104:107], v[236:239], v[232:235], v[104:107]
    s_add_u32 s3, s32, 248832
    buffer_load_dwordx4 v2, s[12:15], s3 offen offset:1024 lds
    v_mfma_f32_16x16x32_bf16 v[108:111], v[248:251], v[232:235], v[108:111]
    ds_read_b64_tr_b16 v[232:233], v14 offset:0
    ds_read_b64_tr_b16 v[234:235], v14 offset:2048
    s_waitcnt lgkmcnt(5)
    v_mfma_f32_16x16x32_bf16 v[112:115], v[224:227], v[252:255], v[112:115]
    ds_read_b64_tr_b16 v[224:225], v15 offset:0
    ds_read_b64_tr_b16 v[226:227], v15 offset:2048
    v_mfma_f32_16x16x32_bf16 v[116:119], v[240:243], v[252:255], v[116:119]
    ds_read_b64_tr_b16 v[240:241], v16 offset:0
    ds_read_b64_tr_b16 v[242:243], v16 offset:2048
    v_mfma_f32_16x16x32_bf16 v[120:123], v[236:239], v[252:255], v[120:123]
    ds_read_b128 v[236:239], v3 offset:35072
    v_mfma_f32_16x16x32_bf16 v[124:127], v[248:251], v[252:255], v[124:127]
    ds_read_b128 v[248:251], v4 offset:34816
    s_waitcnt lgkmcnt(8)
    v_mfma_f32_16x16x32_bf16 v[64:67], v[228:231], v[244:247], v[64:67]
    s_waitcnt lgkmcnt(6)
    v_mfma_f32_16x16x32_bf16 v[68:71], v[232:235], v[244:247], v[68:71]
    s_waitcnt lgkmcnt(4)
    v_mfma_f32_16x16x32_bf16 v[72:75], v[224:227], v[244:247], v[72:75]
    ds_read_b128 v[252:255], v4 offset:35072
    s_waitcnt lgkmcnt(3)
    v_mfma_f32_16x16x32_bf16 v[76:79], v[240:243], v[244:247], v[76:79]
    s_waitcnt lgkmcnt(2)
    v_mfma_f32_16x16x32_bf16 v[80:83], v[228:231], v[236:239], v[80:83]
    s_add_u32 m0, s29, 131072
    s_add_u32 s3, s32, 327680
    buffer_load_dwordx4 v2, s[12:15], s3 offen lds
    v_mfma_f32_16x16x32_bf16 v[84:87], v[232:235], v[236:239], v[84:87]
    v_mfma_f32_16x16x32_bf16 v[88:91], v[224:227], v[236:239], v[88:91]
    s_waitcnt vmcnt(7)
    ds_read_b64_tr_b16 v[244:245], v5 offset:0
    s_waitcnt vmcnt(5)
    ds_read_b64_tr_b16 v[246:247], v5 offset:2048
    s_add_u32 s3, s32, 343040
    buffer_load_dwordx4 v2, s[12:15], s3 offen offset:1024 lds
    v_mfma_f32_16x16x32_bf16 v[92:95], v[240:243], v[236:239], v[92:95]
    ds_read_b128 v[236:239], v3 offset:36864
    s_waitcnt lgkmcnt(4)
    v_mfma_f32_16x16x32_bf16 v[96:99], v[228:231], v[248:251], v[96:99]
    v_mfma_f32_16x16x32_bf16 v[100:103], v[232:235], v[248:251], v[100:103]
    s_add_u32 m0, s29, 133120
    s_add_u32 s3, s32, 331776
    buffer_load_dwordx4 v2, s[12:15], s3 offen lds
    v_mfma_f32_16x16x32_bf16 v[104:107], v[224:227], v[248:251], v[104:107]
    s_add_u32 s3, s32, 347136
    buffer_load_dwordx4 v2, s[12:15], s3 offen offset:1024 lds
    v_mfma_f32_16x16x32_bf16 v[108:111], v[240:243], v[248:251], v[108:111]
    ds_read_b64_tr_b16 v[248:249], v6 offset:0
    ds_read_b64_tr_b16 v[250:251], v6 offset:2048
    s_waitcnt lgkmcnt(5)
    v_mfma_f32_16x16x32_bf16 v[112:115], v[228:231], v[252:255], v[112:115]
    ds_read_b64_tr_b16 v[228:229], v7 offset:0
    ds_read_b64_tr_b16 v[230:231], v7 offset:2048
    v_mfma_f32_16x16x32_bf16 v[116:119], v[232:235], v[252:255], v[116:119]
    ds_read_b64_tr_b16 v[232:233], v8 offset:0
    ds_read_b64_tr_b16 v[234:235], v8 offset:2048
    v_mfma_f32_16x16x32_bf16 v[120:123], v[224:227], v[252:255], v[120:123]
    ds_read_b128 v[224:227], v3 offset:37120
    v_mfma_f32_16x16x32_bf16 v[124:127], v[240:243], v[252:255], v[124:127]
    ds_read_b128 v[240:243], v4 offset:36864
    s_waitcnt lgkmcnt(8)
    v_mfma_f32_16x16x32_bf16 v[64:67], v[244:247], v[236:239], v[64:67]
    s_waitcnt lgkmcnt(6)
    v_mfma_f32_16x16x32_bf16 v[68:71], v[248:251], v[236:239], v[68:71]
    s_waitcnt lgkmcnt(4)
    v_mfma_f32_16x16x32_bf16 v[72:75], v[228:231], v[236:239], v[72:75]
    ds_read_b128 v[252:255], v4 offset:37120
    s_waitcnt lgkmcnt(3)
    v_mfma_f32_16x16x32_bf16 v[76:79], v[232:235], v[236:239], v[76:79]
    s_waitcnt lgkmcnt(2)
    v_mfma_f32_16x16x32_bf16 v[80:83], v[244:247], v[224:227], v[80:83]
    s_add_u32 m0, s29, 0
    s_add_u32 s3, s32, 360448
    buffer_load_dwordx4 v2, s[12:15], s3 offen lds
    v_mfma_f32_16x16x32_bf16 v[84:87], v[248:251], v[224:227], v[84:87]
    v_mfma_f32_16x16x32_bf16 v[88:91], v[228:231], v[224:227], v[88:91]
    s_waitcnt vmcnt(7)
    ds_read_b64_tr_b16 v[236:237], v5 offset:32768
    s_waitcnt vmcnt(5)
    ds_read_b64_tr_b16 v[238:239], v5 offset:34816
    s_add_u32 s3, s32, 375808
    buffer_load_dwordx4 v2, s[12:15], s3 offen offset:1024 lds
    v_mfma_f32_16x16x32_bf16 v[92:95], v[232:235], v[224:227], v[92:95]
    ds_read_b128 v[224:227], v3 offset:38912
    s_waitcnt lgkmcnt(4)
    v_mfma_f32_16x16x32_bf16 v[96:99], v[244:247], v[240:243], v[96:99]
    v_mfma_f32_16x16x32_bf16 v[100:103], v[248:251], v[240:243], v[100:103]
    s_add_u32 m0, s29, 2048
    s_add_u32 s3, s32, 364544
    buffer_load_dwordx4 v2, s[12:15], s3 offen lds
    v_mfma_f32_16x16x32_bf16 v[104:107], v[228:231], v[240:243], v[104:107]
    s_add_u32 s3, s32, 379904
    buffer_load_dwordx4 v2, s[12:15], s3 offen offset:1024 lds
    v_mfma_f32_16x16x32_bf16 v[108:111], v[232:235], v[240:243], v[108:111]
    ds_read_b64_tr_b16 v[240:241], v6 offset:32768
    ds_read_b64_tr_b16 v[242:243], v6 offset:34816
    s_waitcnt lgkmcnt(5)
    v_mfma_f32_16x16x32_bf16 v[112:115], v[244:247], v[252:255], v[112:115]
    ds_read_b64_tr_b16 v[244:245], v7 offset:32768
    ds_read_b64_tr_b16 v[246:247], v7 offset:34816
    v_mfma_f32_16x16x32_bf16 v[116:119], v[248:251], v[252:255], v[116:119]
    ds_read_b64_tr_b16 v[248:249], v8 offset:32768
    ds_read_b64_tr_b16 v[250:251], v8 offset:34816
    v_mfma_f32_16x16x32_bf16 v[120:123], v[228:231], v[252:255], v[120:123]
    ds_read_b128 v[228:231], v3 offset:39168
    v_mfma_f32_16x16x32_bf16 v[124:127], v[232:235], v[252:255], v[124:127]
    ds_read_b128 v[232:235], v4 offset:38912
    s_waitcnt lgkmcnt(8)
    v_mfma_f32_16x16x32_bf16 v[64:67], v[236:239], v[224:227], v[64:67]
    s_waitcnt lgkmcnt(6)
    v_mfma_f32_16x16x32_bf16 v[68:71], v[240:243], v[224:227], v[68:71]
    s_waitcnt lgkmcnt(4)
    v_mfma_f32_16x16x32_bf16 v[72:75], v[244:247], v[224:227], v[72:75]
    ds_read_b128 v[252:255], v4 offset:39168
    s_waitcnt lgkmcnt(3)
    v_mfma_f32_16x16x32_bf16 v[76:79], v[248:251], v[224:227], v[76:79]
    s_waitcnt lgkmcnt(2)
    v_mfma_f32_16x16x32_bf16 v[80:83], v[236:239], v[228:231], v[80:83]
    s_add_u32 m0, s29, 32768
    s_add_u32 s3, s32, 458752
    buffer_load_dwordx4 v2, s[12:15], s3 offen lds
    v_mfma_f32_16x16x32_bf16 v[84:87], v[240:243], v[228:231], v[84:87]
    v_mfma_f32_16x16x32_bf16 v[88:91], v[244:247], v[228:231], v[88:91]
    s_waitcnt vmcnt(7)
    ds_read_b64_tr_b16 v[224:225], v13 offset:0
    s_waitcnt vmcnt(5)
    ds_read_b64_tr_b16 v[226:227], v13 offset:2048
    s_add_u32 s3, s32, 474112
    buffer_load_dwordx4 v2, s[12:15], s3 offen offset:1024 lds
    v_mfma_f32_16x16x32_bf16 v[92:95], v[248:251], v[228:231], v[92:95]
    ds_read_b128 v[228:231], v3 offset:40960
    s_waitcnt lgkmcnt(4)
    v_mfma_f32_16x16x32_bf16 v[96:99], v[236:239], v[232:235], v[96:99]
    v_mfma_f32_16x16x32_bf16 v[100:103], v[240:243], v[232:235], v[100:103]
    s_add_u32 m0, s29, 34816
    s_add_u32 s3, s32, 462848
    buffer_load_dwordx4 v2, s[12:15], s3 offen lds
    v_mfma_f32_16x16x32_bf16 v[104:107], v[244:247], v[232:235], v[104:107]
    s_add_u32 s3, s32, 478208
    buffer_load_dwordx4 v2, s[12:15], s3 offen offset:1024 lds
    v_mfma_f32_16x16x32_bf16 v[108:111], v[248:251], v[232:235], v[108:111]
    ds_read_b64_tr_b16 v[232:233], v14 offset:0
    ds_read_b64_tr_b16 v[234:235], v14 offset:2048
    s_waitcnt lgkmcnt(5)
    v_mfma_f32_16x16x32_bf16 v[112:115], v[236:239], v[252:255], v[112:115]
    ds_read_b64_tr_b16 v[236:237], v15 offset:0
    ds_read_b64_tr_b16 v[238:239], v15 offset:2048
    v_mfma_f32_16x16x32_bf16 v[116:119], v[240:243], v[252:255], v[116:119]
    ds_read_b64_tr_b16 v[240:241], v16 offset:0
    ds_read_b64_tr_b16 v[242:243], v16 offset:2048
    v_mfma_f32_16x16x32_bf16 v[120:123], v[244:247], v[252:255], v[120:123]
    ds_read_b128 v[244:247], v3 offset:41216
    v_mfma_f32_16x16x32_bf16 v[124:127], v[248:251], v[252:255], v[124:127]
    ds_read_b128 v[248:251], v4 offset:40960
    s_setprio 0
    s_waitcnt lgkmcnt(8)
    v_mfma_f32_16x16x32_bf16 v[64:67], v[224:227], v[228:231], v[64:67]
    s_waitcnt lgkmcnt(6)
    v_mfma_f32_16x16x32_bf16 v[68:71], v[232:235], v[228:231], v[68:71]
    s_waitcnt lgkmcnt(4)
    v_mfma_f32_16x16x32_bf16 v[72:75], v[236:239], v[228:231], v[72:75]
    ds_read_b128 v[252:255], v4 offset:41216
    s_waitcnt lgkmcnt(3)
    v_mfma_f32_16x16x32_bf16 v[76:79], v[240:243], v[228:231], v[76:79]
    s_waitcnt lgkmcnt(2)
    v_mfma_f32_16x16x32_bf16 v[80:83], v[224:227], v[244:247], v[80:83]
    s_add_u32 m0, s29, 131072
    s_add_u32 s3, s32, 491520
    buffer_load_dwordx4 v2, s[12:15], s3 offen lds
    v_mfma_f32_16x16x32_bf16 v[84:87], v[232:235], v[244:247], v[84:87]
    v_mfma_f32_16x16x32_bf16 v[88:91], v[236:239], v[244:247], v[88:91]
    s_waitcnt vmcnt(7)
    ds_read_b64_tr_b16 v[228:229], v5 offset:0
    s_waitcnt vmcnt(5)
    ds_read_b64_tr_b16 v[230:231], v5 offset:2048
    s_add_u32 s3, s32, 506880
    buffer_load_dwordx4 v2, s[12:15], s3 offen offset:1024 lds
    v_mfma_f32_16x16x32_bf16 v[92:95], v[240:243], v[244:247], v[92:95]
    ds_read_b128 v[244:247], v3 offset:43008
    s_waitcnt lgkmcnt(4)
    v_mfma_f32_16x16x32_bf16 v[96:99], v[224:227], v[248:251], v[96:99]
    v_mfma_f32_16x16x32_bf16 v[100:103], v[232:235], v[248:251], v[100:103]
    s_add_u32 m0, s29, 133120
    s_add_u32 s3, s32, 495616
    buffer_load_dwordx4 v2, s[12:15], s3 offen lds
    v_mfma_f32_16x16x32_bf16 v[104:107], v[236:239], v[248:251], v[104:107]
    s_add_u32 s3, s32, 510976
    buffer_load_dwordx4 v2, s[12:15], s3 offen offset:1024 lds
    v_mfma_f32_16x16x32_bf16 v[108:111], v[240:243], v[248:251], v[108:111]
    ds_read_b64_tr_b16 v[248:249], v6 offset:0
    ds_read_b64_tr_b16 v[250:251], v6 offset:2048
    s_waitcnt lgkmcnt(5)
    v_mfma_f32_16x16x32_bf16 v[112:115], v[224:227], v[252:255], v[112:115]
    ds_read_b64_tr_b16 v[224:225], v7 offset:0
    ds_read_b64_tr_b16 v[226:227], v7 offset:2048
    v_mfma_f32_16x16x32_bf16 v[116:119], v[232:235], v[252:255], v[116:119]
    ds_read_b64_tr_b16 v[232:233], v8 offset:0
    ds_read_b64_tr_b16 v[234:235], v8 offset:2048
    v_mfma_f32_16x16x32_bf16 v[120:123], v[236:239], v[252:255], v[120:123]
    ds_read_b128 v[236:239], v3 offset:43264
    v_mfma_f32_16x16x32_bf16 v[124:127], v[240:243], v[252:255], v[124:127]
    ds_read_b128 v[240:243], v4 offset:43008
    s_waitcnt lgkmcnt(8)
    v_mfma_f32_16x16x32_bf16 v[64:67], v[228:231], v[244:247], v[64:67]
    s_waitcnt lgkmcnt(6)
    v_mfma_f32_16x16x32_bf16 v[68:71], v[248:251], v[244:247], v[68:71]
    s_waitcnt lgkmcnt(4)
    v_mfma_f32_16x16x32_bf16 v[72:75], v[224:227], v[244:247], v[72:75]
    ds_read_b128 v[252:255], v4 offset:43264
    s_waitcnt lgkmcnt(3)
    v_mfma_f32_16x16x32_bf16 v[76:79], v[232:235], v[244:247], v[76:79]
    s_waitcnt lgkmcnt(2)
    v_mfma_f32_16x16x32_bf16 v[80:83], v[228:231], v[236:239], v[80:83]
    v_mfma_f32_16x16x32_bf16 v[84:87], v[248:251], v[236:239], v[84:87]
    v_mfma_f32_16x16x32_bf16 v[88:91], v[224:227], v[236:239], v[88:91]
    s_waitcnt vmcnt(6)
    ds_read_b64_tr_b16 v[244:245], v5 offset:32768
    s_waitcnt vmcnt(4)
    ds_read_b64_tr_b16 v[246:247], v5 offset:34816
    v_mfma_f32_16x16x32_bf16 v[92:95], v[232:235], v[236:239], v[92:95]
    ds_read_b128 v[236:239], v3 offset:45056
    s_waitcnt lgkmcnt(4)
    v_mfma_f32_16x16x32_bf16 v[96:99], v[228:231], v[240:243], v[96:99]
    v_mfma_f32_16x16x32_bf16 v[100:103], v[248:251], v[240:243], v[100:103]
    v_mfma_f32_16x16x32_bf16 v[104:107], v[224:227], v[240:243], v[104:107]
    v_mfma_f32_16x16x32_bf16 v[108:111], v[232:235], v[240:243], v[108:111]
    ds_read_b64_tr_b16 v[240:241], v6 offset:32768
    ds_read_b64_tr_b16 v[242:243], v6 offset:34816
    s_waitcnt lgkmcnt(5)
    v_mfma_f32_16x16x32_bf16 v[112:115], v[228:231], v[252:255], v[112:115]
    ds_read_b64_tr_b16 v[228:229], v7 offset:32768
    ds_read_b64_tr_b16 v[230:231], v7 offset:34816
    v_mfma_f32_16x16x32_bf16 v[116:119], v[248:251], v[252:255], v[116:119]
    ds_read_b64_tr_b16 v[248:249], v8 offset:32768
    ds_read_b64_tr_b16 v[250:251], v8 offset:34816
    v_mfma_f32_16x16x32_bf16 v[120:123], v[224:227], v[252:255], v[120:123]
    ds_read_b128 v[224:227], v3 offset:45312
    v_mfma_f32_16x16x32_bf16 v[124:127], v[232:235], v[252:255], v[124:127]
    ds_read_b128 v[232:235], v4 offset:45056
    s_waitcnt lgkmcnt(8)
    v_mfma_f32_16x16x32_bf16 v[64:67], v[244:247], v[236:239], v[64:67]
    s_waitcnt lgkmcnt(6)
    v_mfma_f32_16x16x32_bf16 v[68:71], v[240:243], v[236:239], v[68:71]
    s_waitcnt lgkmcnt(4)
    v_mfma_f32_16x16x32_bf16 v[72:75], v[228:231], v[236:239], v[72:75]
    ds_read_b128 v[252:255], v4 offset:45312
    s_waitcnt lgkmcnt(3)
    v_mfma_f32_16x16x32_bf16 v[76:79], v[248:251], v[236:239], v[76:79]
    s_waitcnt lgkmcnt(2)
    v_mfma_f32_16x16x32_bf16 v[80:83], v[244:247], v[224:227], v[80:83]
    v_mfma_f32_16x16x32_bf16 v[84:87], v[240:243], v[224:227], v[84:87]
    v_mfma_f32_16x16x32_bf16 v[88:91], v[228:231], v[224:227], v[88:91]
    s_waitcnt vmcnt(2)
    ds_read_b64_tr_b16 v[236:237], v13 offset:0
    s_waitcnt vmcnt(0)
    ds_read_b64_tr_b16 v[238:239], v13 offset:2048
    v_mfma_f32_16x16x32_bf16 v[92:95], v[248:251], v[224:227], v[92:95]
    ds_read_b128 v[224:227], v3 offset:47104
    s_waitcnt lgkmcnt(4)
    v_mfma_f32_16x16x32_bf16 v[96:99], v[244:247], v[232:235], v[96:99]
    v_mfma_f32_16x16x32_bf16 v[100:103], v[240:243], v[232:235], v[100:103]
    v_mfma_f32_16x16x32_bf16 v[104:107], v[228:231], v[232:235], v[104:107]
    v_mfma_f32_16x16x32_bf16 v[108:111], v[248:251], v[232:235], v[108:111]
    ds_read_b64_tr_b16 v[232:233], v14 offset:0
    ds_read_b64_tr_b16 v[234:235], v14 offset:2048
    s_waitcnt lgkmcnt(5)
    v_mfma_f32_16x16x32_bf16 v[112:115], v[244:247], v[252:255], v[112:115]
    ds_read_b64_tr_b16 v[244:245], v15 offset:0
    ds_read_b64_tr_b16 v[246:247], v15 offset:2048
    v_mfma_f32_16x16x32_bf16 v[116:119], v[240:243], v[252:255], v[116:119]
    ds_read_b64_tr_b16 v[240:241], v16 offset:0
    ds_read_b64_tr_b16 v[242:243], v16 offset:2048
    v_mfma_f32_16x16x32_bf16 v[120:123], v[228:231], v[252:255], v[120:123]
    ds_read_b128 v[228:231], v3 offset:47360
    v_mfma_f32_16x16x32_bf16 v[124:127], v[248:251], v[252:255], v[124:127]
    ds_read_b128 v[248:251], v4 offset:47104
    s_waitcnt lgkmcnt(8)
    v_mfma_f32_16x16x32_bf16 v[64:67], v[236:239], v[224:227], v[64:67]
    s_waitcnt lgkmcnt(6)
    v_mfma_f32_16x16x32_bf16 v[68:71], v[232:235], v[224:227], v[68:71]
    s_waitcnt lgkmcnt(4)
    v_mfma_f32_16x16x32_bf16 v[72:75], v[244:247], v[224:227], v[72:75]
    ds_read_b128 v[252:255], v4 offset:47360
    s_waitcnt lgkmcnt(3)
    v_mfma_f32_16x16x32_bf16 v[76:79], v[240:243], v[224:227], v[76:79]
    s_waitcnt lgkmcnt(2)
    v_mfma_f32_16x16x32_bf16 v[80:83], v[236:239], v[228:231], v[80:83]
    v_mfma_f32_16x16x32_bf16 v[84:87], v[232:235], v[228:231], v[84:87]
    v_mfma_f32_16x16x32_bf16 v[88:91], v[244:247], v[228:231], v[88:91]
    v_mfma_f32_16x16x32_bf16 v[92:95], v[240:243], v[228:231], v[92:95]
    s_waitcnt lgkmcnt(1)
    v_mfma_f32_16x16x32_bf16 v[96:99], v[236:239], v[248:251], v[96:99]
    v_mfma_f32_16x16x32_bf16 v[100:103], v[232:235], v[248:251], v[100:103]
    v_mfma_f32_16x16x32_bf16 v[104:107], v[244:247], v[248:251], v[104:107]
    v_mfma_f32_16x16x32_bf16 v[108:111], v[240:243], v[248:251], v[108:111]
    s_waitcnt lgkmcnt(0)
    v_mfma_f32_16x16x32_bf16 v[112:115], v[236:239], v[252:255], v[112:115]
    v_mfma_f32_16x16x32_bf16 v[116:119], v[232:235], v[252:255], v[116:119]
    v_mfma_f32_16x16x32_bf16 v[120:123], v[244:247], v[252:255], v[120:123]
    v_mfma_f32_16x16x32_bf16 v[124:127], v[240:243], v[252:255], v[124:127]
    v_cvt_pk_bf16_f32 v32, v64, v65
    v_cvt_pk_bf16_f32 v33, v66, v67
    v_cvt_pk_bf16_f32 v34, v80, v81
    v_cvt_pk_bf16_f32 v35, v82, v83
    v_cvt_pk_bf16_f32 v36, v68, v69
    v_cvt_pk_bf16_f32 v37, v70, v71
    v_cvt_pk_bf16_f32 v38, v84, v85
    v_cvt_pk_bf16_f32 v39, v86, v87
    v_permlane16_swap_b32 v32, v34
    v_permlane16_swap_b32 v33, v35
    buffer_store_dwordx4 v[32:35], v27, s[16:19], s34 offen offset:0 sc0 sc1
    v_cvt_pk_bf16_f32 v40, v72, v73
    v_cvt_pk_bf16_f32 v41, v74, v75
    v_cvt_pk_bf16_f32 v42, v88, v89
    v_cvt_pk_bf16_f32 v43, v90, v91
    v_permlane16_swap_b32 v36, v38
    v_permlane16_swap_b32 v37, v39
    buffer_store_dwordx4 v[36:39], v27, s[16:19], s34 offen offset:1024 sc0 sc1
    v_cvt_pk_bf16_f32 v44, v76, v77
    v_cvt_pk_bf16_f32 v45, v78, v79
    v_cvt_pk_bf16_f32 v46, v92, v93
    v_cvt_pk_bf16_f32 v47, v94, v95
    v_permlane16_swap_b32 v40, v42
    v_permlane16_swap_b32 v41, v43
    buffer_store_dwordx4 v[40:43], v27, s[16:19], s34 offen offset:2048 sc0 sc1
    v_cvt_pk_bf16_f32 v48, v96, v97
    v_cvt_pk_bf16_f32 v49, v98, v99
    v_cvt_pk_bf16_f32 v50, v112, v113
    v_cvt_pk_bf16_f32 v51, v114, v115
    v_permlane16_swap_b32 v44, v46
    v_permlane16_swap_b32 v45, v47
    buffer_store_dwordx4 v[44:47], v27, s[16:19], s34 offen offset:3072 sc0 sc1
    v_cvt_pk_bf16_f32 v52, v100, v101
    v_cvt_pk_bf16_f32 v53, v102, v103
    v_cvt_pk_bf16_f32 v54, v116, v117
    v_cvt_pk_bf16_f32 v55, v118, v119
    v_permlane16_swap_b32 v48, v50
    v_permlane16_swap_b32 v49, v51
    buffer_store_dwordx4 v[48:51], v27, s[16:19], s35 offen offset:0 sc0 sc1
    v_cvt_pk_bf16_f32 v56, v104, v105
    v_cvt_pk_bf16_f32 v57, v106, v107
    v_cvt_pk_bf16_f32 v58, v120, v121
    v_cvt_pk_bf16_f32 v59, v122, v123
    v_permlane16_swap_b32 v52, v54
    v_permlane16_swap_b32 v53, v55
    buffer_store_dwordx4 v[52:55], v27, s[16:19], s35 offen offset:1024 sc0 sc1
    v_cvt_pk_bf16_f32 v60, v108, v109
    v_cvt_pk_bf16_f32 v61, v110, v111
    v_cvt_pk_bf16_f32 v62, v124, v125
    v_cvt_pk_bf16_f32 v63, v126, v127
    v_permlane16_swap_b32 v56, v58
    v_permlane16_swap_b32 v57, v59
    buffer_store_dwordx4 v[56:59], v27, s[16:19], s35 offen offset:2048 sc0 sc1
    v_permlane16_swap_b32 v60, v62
    v_permlane16_swap_b32 v61, v63
    buffer_store_dwordx4 v[60:63], v27, s[16:19], s35 offen offset:3072 sc0 sc1
    s_mov_b64 exec, 0
    s_cmp_eq_u32 s24, 0
    s_cbranch_scc1 TP0
    s_cmp_eq_u32 s24, 1
    s_cbranch_scc1 TP1
    s_cmp_eq_u32 s24, 2
    s_cbranch_scc1 TP2
    s_cmp_eq_u32 s24, 3
    s_cbranch_scc1 TP3
K1_end:
    s_endpgm
.fill (37376 - (. - TBASE))/4, 4, 0xBF810000
.globl k2_kernel
.p2align 8
.type k2_kernel,@function
k2_kernel:
    s_cmp_ge_u32 s2, 256
    s_cbranch_scc1 K2_end
TP0:
    s_cbranch_execz TP4
    s_load_dwordx2 s[24:25], s[0:1], 112
    s_load_dwordx2 s[8:9], s[0:1], 0
    v_and_b32 v1, 63, v0
    v_lshrrev_b32 v3, 6, v0
    s_nop 0
    v_readfirstlane_b32 s34, v3
    s_and_b32 s35, s2, 7
    s_lshr_b32 s36, s2, 3
    s_lshl_b32 s35, s35, 4
    s_lshr_b32 s37, s36, 1
    s_add_u32 s35, s35, s37
    s_and_b32 s36, s36, 1
    v_lshlrev_b32 v2, 4, v1
    v_and_b32 v12, 15, v1
    v_bfe_u32 v13, v1, 4, 1
    v_lshrrev_b32 v14, 5, v1
    v_lshl_add_u32 v3, v14, 5, v12
    s_and_b32 s37, s35, 1
    s_lshl_b32 s37, s37, 4
    v_add_u32 v3, s37, v3
    v_lshlrev_b32 v3, 4, v3
    v_lshl_add_u32 v3, v13, 10, v3
    s_mov_b32 s10, 0x200000
    s_mov_b32 s11, 0x00020000
    s_mov_b32 s26, 0x10000000
    s_mov_b32 s27, 0x00020000
    s_lshr_b32 s40, s35, 1
    s_lshl_b32 s40, s40, 15
    s_lshl_b32 s41, s34, 12
    s_add_u32 s41, s40, s41
    s_add_u32 s42, s41, 0x400000
    s_waitcnt lgkmcnt(0)
    s_setprio 3
    s_cmp_ge_u32 s34, 4
    s_cbranch_scc1 K2_B
    s_add_u32 s43, s42, 0x0
    buffer_load_dwordx4 v[64:67], v3, s[24:27], s43 offen offset:0
    s_add_u32 s43, s42, 0x0
    buffer_load_dwordx4 v[68:71], v3, s[24:27], s43 offen offset:2048
    v_lshlrev_b32 v15, 10, v12
    v_lshl_add_u32 v15, v13, 5, v15
    v_lshl_add_u32 v15, v14, 4, v15
    s_lshl_b32 s43, s35, 14
    s_lshl_b32 s44, s34, 7
    s_add_u32 s43, s43, s44
    buffer_load_dwordx4 v[20:23], v15, s[8:11], s43 offen offset:0
    buffer_load_dwordx4 v[24:27], v15, s[8:11], s43 offen offset:64
    v_lshlrev_b32 v16, 6, v13
    v_lshl_add_u32 v16, v14, 5, v16
    s_lshl_b32 s44, s34, 8
    s_add_u32 s44, s44, 0x200000
    v_lshrrev_b32 v28, 4, v1
    v_lshlrev_b32 v28, 11, v28
    v_lshl_add_u32 v28, v12, 4, v28
    s_lshl_b32 s48, s34, 8
    v_add_u32 v28, s48, v28
    s_lshl_b32 s45, s36, 3
    s_add_u32 s45, s45, s34
    s_lshl_b32 s48, s45, 7
    s_add_u32 s48, s48, 0x2000
    v_and_b32 v29, 7, v1
    v_lshl_add_u32 v29, v29, 4, s48
    v_cmp_gt_u32 vcc, 48, v1
    s_nop 1
    v_cndmask_b32 v28, v29, v28, vcc
    s_lshl_b32 s48, s34, 11
    s_mov_b32 m0, s48
    s_mov_b32 s43, 0x200000
    buffer_load_dwordx4 v28, s[24:27], s43 offen lds
    v_add_u32 v16, s48, v16
    s_lshl_b32 s45, s36, 3
    s_add_u32 s45, s45, s34
    s_lshl_b32 s46, s45, 15
    s_add_u32 s46, s46, 0x280000
    s_add_u32 s56, s46, 0
    s_add_u32 s57, s46, 4096
    s_add_u32 s58, s46, 8192
    s_add_u32 s59, s46, 12288
    s_add_u32 s60, s46, 16384
    s_add_u32 s61, s46, 20480
    s_add_u32 s62, s46, 24576
    s_add_u32 s63, s46, 28672
    s_add_u32 s43, s42, 0x200000
    buffer_load_dwordx4 v[72:75], v3, s[24:27], s43 offen offset:0
    s_add_u32 s43, s42, 0x200000
    buffer_load_dwordx4 v[76:79], v3, s[24:27], s43 offen offset:2048
    s_add_u32 s43, s42, 0x400000
    buffer_load_dwordx4 v[80:83], v3, s[24:27], s43 offen offset:0
    s_add_u32 s43, s42, 0x400000
    buffer_load_dwordx4 v[84:87], v3, s[24:27], s43 offen offset:2048
    s_add_u32 s43, s42, 0x600000
    buffer_load_dwordx4 v[88:91], v3, s[24:27], s43 offen offset:0
    s_add_u32 s43, s42, 0x600000
    buffer_load_dwordx4 v[92:95], v3, s[24:27], s43 offen offset:2048
    s_add_u32 s43, s42, 0x800000
    buffer_load_dwordx4 v[96:99], v3, s[24:27], s43 offen offset:0
    s_add_u32 s43, s42, 0x800000
    buffer_load_dwordx4 v[100:103], v3, s[24:27], s43 offen offset:2048
    s_add_u32 s43, s42, 0xa00000
    buffer_load_dwordx4 v[104:107], v3, s[24:27], s43 offen offset:0
    s_add_u32 s43, s42, 0xa00000
    buffer_load_dwordx4 v[108:111], v3, s[24:27], s43 offen offset:2048
    s_add_u32 s43, s42, 0xc00000
    buffer_load_dwordx4 v[112:115], v3, s[24:27], s43 offen offset:0
    s_add_u32 s43, s42, 0xc00000
    buffer_load_dwordx4 v[116:119], v3, s[24:27], s43 offen offset:2048
    s_add_u32 s43, s42, 0xe00000
    buffer_load_dwordx4 v[120:123], v3, s[24:27], s43 offen offset:0
    s_add_u32 s43, s42, 0xe00000
    buffer_load_dwordx4 v[124:127], v3, s[24:27], s43 offen offset:2048
    v_and_b32 v17, 31, v1
    v_and_b32 v18, 0x13, v17
    v_bfe_u32 v19, v17, 2, 1
    v_lshl_or_b32 v18, v19, 3, v18
    v_bfe_u32 v19, v17, 3, 1
    v_lshl_or_b32 v18, v19, 2, v18
    v_lshrrev_b32 v17, 5, v1
    v_lshlrev_b32 v17, 3, v17
    v_sub_u32 v18, v18, v17
    v_mov_b32 v4, 0
    v_cmp_eq_u32 vcc, 0, v18
    v_mov_b32 v19, 0x3f80
    s_nop 0
    v_cndmask_b32 v4, v4, v19, vcc
    v_cmp_eq_u32 vcc, 1, v18
    v_mov_b32 v19, 0x3f800000
    s_nop 0
    v_cndmask_b32 v4, v4, v19, vcc
    v_mov_b32 v5, 0
    v_cmp_eq_u32 vcc, 2, v18
    v_mov_b32 v19, 0x3f80
    s_nop 0
    v_cndmask_b32 v5, v5, v19, vcc
    v_cmp_eq_u32 vcc, 3, v18
    v_mov_b32 v19, 0x3f800000
    s_nop 0
    v_cndmask_b32 v5, v5, v19, vcc
    v_mov_b32 v6, 0
    v_cmp_eq_u32 vcc, 4, v18
    v_mov_b32 v19, 0x3f80
    s_nop 0
    v_cndmask_b32 v6, v6, v19, vcc
    v_cmp_eq_u32 vcc, 5, v18
    v_mov_b32 v19, 0x3f800000
    s_nop 0
    v_cndmask_b32 v6, v6, v19, vcc
    v_mov_b32 v7, 0
    v_cmp_eq_u32 vcc, 6, v18
    v_mov_b32 v19, 0x3f80
    s_nop 0
    v_cndmask_b32 v7, v7, v19, vcc
    v_cmp_eq_u32 vcc, 7, v18
    v_mov_b32 v19, 0x3f800000
    s_nop 0
    v_cndmask_b32 v7, v7, v19, vcc
    v_mov_b32 v8, 0
    v_cmp_eq_u32 vcc, 16, v18
    v_mov_b32 v19, 0x3f80
    s_nop 0
    v_cndmask_b32 v8, v8, v19, vcc
    v_cmp_eq_u32 vcc, 17, v18
    v_mov_b32 v19, 0x3f800000
    s_nop 0
    v_cndmask_b32 v8, v8, v19, vcc
    v_mov_b32 v9, 0
    v_cmp_eq_u32 vcc, 18, v18
    v_mov_b32 v19, 0x3f80
    s_nop 0
    v_cndmask_b32 v9, v9, v19, vcc
    v_cmp_eq_u32 vcc, 19, v18
    v_mov_b32 v19, 0x3f800000
    s_nop 0
    v_cndmask_b32 v9, v9, v19, vcc
    v_mov_b32 v10, 0
    v_cmp_eq_u32 vcc, 20, v18
    v_mov_b32 v19, 0x3f80
    s_nop 0
    v_cndmask_b32 v10, v10, v19, vcc
    v_cmp_eq_u32 vcc, 21, v18
    v_mov_b32 v19, 0x3f800000
    s_nop 0
    v_cndmask_b32 v10, v10, v19, vcc
    v_mov_b32 v11, 0
    v_cmp_eq_u32 vcc, 22, v18
    v_mov_b32 v19, 0x3f80
    s_nop 0
    v_cndmask_b32 v11, v11, v19, vcc
    v_cmp_eq_u32 vcc, 23, v18
    v_mov_b32 v19, 0x3f800000
    s_nop 0
    v_cndmask_b32 v11, v11, v19, vcc
    s_waitcnt vmcnt(14)
    ds_read_b128 v[32:35], v16 offset:0
    ds_read_b128 v[36:39], v16 offset:16
    ds_read_b128 v[40:43], v16 offset:128
    ds_read_b128 v[44:47], v16 offset:144
    s_mov_b32 s52, 0xffff0000
    s_mov_b32 s53, 0x3f803f80
    v_mfma_f32_32x32x16_bf16 v[48:63], v[4:7], v[64:67], 0
    v_mfma_f32_32x32x16_bf16 v[48:63], v[8:11], v[68:71], v[48:63]
    s_waitcnt vmcnt(13)
    v_mfma_f32_32x32x16_bf16 v[48:63], v[4:7], v[72:75], v[48:63]
    s_waitcnt vmcnt(12)
    v_mfma_f32_32x32x16_bf16 v[48:63], v[8:11], v[76:79], v[48:63]
    s_waitcnt vmcnt(11)
    v_mfma_f32_32x32x16_bf16 v[48:63], v[4:7], v[80:83], v[48:63]
    s_waitcnt vmcnt(10)
    v_mfma_f32_32x32x16_bf16 v[48:63], v[8:11], v[84:87], v[48:63]
    s_waitcnt vmcnt(9)
    v_mfma_f32_32x32x16_bf16 v[48:63], v[4:7], v[88:91], v[48:63]
    s_waitcnt vmcnt(8)
    v_mfma_f32_32x32x16_bf16 v[48:63], v[8:11], v[92:95], v[48:63]
    s_waitcnt vmcnt(7)
    v_mfma_f32_32x32x16_bf16 v[48:63], v[4:7], v[96:99], v[48:63]
    s_waitcnt vmcnt(6)
    v_mfma_f32_32x32x16_bf16 v[48:63], v[8:11], v[100:103], v[48:63]
    s_waitcnt vmcnt(5)
    v_mfma_f32_32x32x16_bf16 v[48:63], v[4:7], v[104:107], v[48:63]
    s_waitcnt vmcnt(4)
    v_mfma_f32_32x32x16_bf16 v[48:63], v[8:11], v[108:111], v[48:63]
    s_waitcnt vmcnt(3)
    v_mfma_f32_32x32x16_bf16 v[48:63], v[4:7], v[112:115], v[48:63]
    s_waitcnt vmcnt(2)
    v_mfma_f32_32x32x16_bf16 v[48:63], v[8:11], v[116:119], v[48:63]
    s_waitcnt vmcnt(1)
    v_mfma_f32_32x32x16_bf16 v[48:63], v[4:7], v[120:123], v[48:63]
    s_waitcnt vmcnt(0)
    v_mfma_f32_32x32x16_bf16 v[48:63], v[8:11], v[124:127], v[48:63]
    s_nop 7
    ds_read_b128 v[64:67], v16 offset:512
    v_lshlrev_b32 v28, 16, v20
    ds_read_b128 v[68:71], v16 offset:528
    ds_read_b128 v[72:75], v16 offset:640
    ds_read_b128 v[76:79], v16 offset:656
    v_and_b32 v29, s52, v20
    ds_read_b128 v[80:83], v16 offset:256
    ds_read_b128 v[84:87], v16 offset:272
    ds_read_b128 v[88:91], v16 offset:384
    s_waitcnt lgkmcnt(10)
    v_pk_fma_f32 v[48:49], v[48:49], v[32:33], v[28:29]
    ds_read_b128 v[92:95], v16 offset:400
    v_lshrrev_b32 v13, 4, v1
    s_lshl_b32 s48, s34, 11
    v_lshl_add_u32 v13, v13, 5, s48
    ds_read_b128 v[4:7], v13 offset:768
    v_cvt_pk_bf16_f32 v20, v48, v49
    ds_read_b128 v[8:11], v13 offset:784
    v_lshlrev_b32 v48, 16, v20
    v_and_b32 v49, s52, v20
    v_lshlrev_b32 v30, 16, v21
    v_and_b32 v31, s52, v21
    v_pk_fma_f32 v[50:51], v[50:51], v[34:35], v[30:31]
    v_cvt_pk_bf16_f32 v21, v50, v51
    v_lshlrev_b32 v50, 16, v21
    v_and_b32 v51, s52, v21
    v_lshlrev_b32 v28, 16, v22
    v_and_b32 v29, s52, v22
    s_waitcnt lgkmcnt(12)
    v_pk_fma_f32 v[52:53], v[52:53], v[36:37], v[28:29]
    v_cvt_pk_bf16_f32 v22, v52, v53
    v_lshlrev_b32 v52, 16, v22
    v_and_b32 v53, s52, v22
    v_lshlrev_b32 v30, 16, v23
    v_and_b32 v31, s52, v23
    v_pk_fma_f32 v[54:55], v[54:55], v[38:39], v[30:31]
    v_cvt_pk_bf16_f32 v23, v54, v55
    v_lshlrev_b32 v54, 16, v23
    v_and_b32 v55, s52, v23
    v_lshlrev_b32 v28, 16, v24
    v_and_b32 v29, s52, v24
    s_waitcnt lgkmcnt(11)
    v_pk_fma_f32 v[56:57], v[56:57], v[40:41], v[28:29]
    v_cvt_pk_bf16_f32 v24, v56, v57
    v_lshlrev_b32 v56, 16, v24
    v_and_b32 v57, s52, v24
    v_lshlrev_b32 v30, 16, v25
    v_and_b32 v31, s52, v25
    v_pk_fma_f32 v[58:59], v[58:59], v[42:43], v[30:31]
    v_cvt_pk_bf16_f32 v25, v58, v59
    v_lshlrev_b32 v58, 16, v25
    v_and_b32 v59, s52, v25
    v_lshlrev_b32 v28, 16, v26
    v_and_b32 v29, s52, v26
    s_waitcnt lgkmcnt(10)
    v_pk_fma_f32 v[60:61], v[60:61], v[44:45], v[28:29]
    v_cvt_pk_bf16_f32 v26, v60, v61
    v_lshlrev_b32 v60, 16, v26
    v_and_b32 v61, s52, v26
    v_lshlrev_b32 v30, 16, v27
    v_and_b32 v31, s52, v27
    v_pk_fma_f32 v[62:63], v[62:63], v[46:47], v[30:31]
    v_cvt_pk_bf16_f32 v27, v62, v63
    v_lshlrev_b32 v62, 16, v27
    v_and_b32 v63, s52, v27
    v_mov_b32 v14, 0
    v_mov_b32 v15, 0
    v_mov_b32 v18, 0
    v_mov_b32 v19, 0
    v_dot2_f32_bf16 v14, v20, s53, v14
    v_dot2_f32_bf16 v15, v20, v20, v15
    v_dot2_f32_bf16 v18, v21, s53, v18
    v_dot2_f32_bf16 v19, v21, v21, v19
    v_dot2_f32_bf16 v14, v22, s53, v14
    v_dot2_f32_bf16 v15, v22, v22, v15
    v_dot2_f32_bf16 v18, v23, s53, v18
    v_dot2_f32_bf16 v19, v23, v23, v19
    v_dot2_f32_bf16 v14, v24, s53, v14
    v_dot2_f32_bf16 v15, v24, v24, v15
    v_dot2_f32_bf16 v18, v25, s53, v18
    v_dot2_f32_bf16 v19, v25, v25, v19
    v_dot2_f32_bf16 v14, v26, s53, v14
    v_dot2_f32_bf16 v15, v26, v26, v15
    v_dot2_f32_bf16 v18, v27, s53, v18
    v_dot2_f32_bf16 v19, v27, v27, v19
    s_nop 2
    v_add_f32 v14, v14, v18
    v_add_f32 v15, v15, v19
    v_mov_b32 v18, v14
    v_mov_b32 v19, v15
    s_nop 0
    v_permlane16_swap_b32 v14, v18
    v_permlane16_swap_b32 v15, v19
    v_add_f32 v14, v14, v18
    v_add_f32 v15, v15, v19
    v_mov_b32 v18, v14
    v_mov_b32 v19, v15
    s_nop 0
    v_permlane32_swap_b32 v14, v18
    v_permlane32_swap_b32 v15, v19
    v_add_f32 v14, v14, v18
    v_add_f32 v15, v15, v19
    v_lshlrev_b32 v17, 3, v12
    s_lshl_b32 s48, s34, 7
    s_add_u32 s48, s48, 16384
    v_add_u32 v18, s48, v17
    ds_write_b64 v18, v[14:15]
    s_lshr_b32 s47, s34, 2
    s_cmp_eq_u32 s47, s36
    s_cselect_b32 s54, 0, 0x10000000
    s_add_u32 s43, s41, 0x1400000
    s_add_u32 s43, s43, s54
    buffer_store_dwordx4 v[20:23], v3, s[24:27], s43 offen offset:0 sc0 sc1
    buffer_store_dwordx4 v[24:27], v3, s[24:27], s43 offen offset:2048 sc0 sc1
    s_setprio 0
    buffer_load_dwordx4 a[0:3], v2, s[24:27], s56 offen offset:0
    buffer_load_dwordx4 a[4:7], v2, s[24:27], s60 offen offset:0
    buffer_load_dwordx4 a[8:11], v2, s[24:27], s56 offen offset:1024
    buffer_load_dwordx4 a[12:15], v2, s[24:27], s60 offen offset:1024
    buffer_load_dwordx4 a[16:19], v2, s[24:27], s56 offen offset:2048
    buffer_load_dwordx4 a[20:23], v2, s[24:27], s60 offen offset:2048
    buffer_load_dwordx4 a[24:27], v2, s[24:27], s56 offen offset:3072
    buffer_load_dwordx4 a[28:31], v2, s[24:27], s60 offen offset:3072
    buffer_load_dwordx4 a[32:35], v2, s[24:27], s57 offen offset:0
    buffer_load_dwordx4 a[36:39], v2, s[24:27], s61 offen offset:0
    buffer_load_dwordx4 a[40:43], v2, s[24:27], s57 offen offset:1024
    buffer_load_dwordx4 a[44:47], v2, s[24:27], s61 offen offset:1024
    buffer_load_dwordx4 a[48:51], v2, s[24:27], s57 offen offset:2048
    buffer_load_dwordx4 a[52:55], v2, s[24:27], s61 offen offset:2048
    buffer_load_dwordx4 a[56:59], v2, s[24:27], s57 offen offset:3072
    buffer_load_dwordx4 a[60:63], v2, s[24:27], s61 offen offset:3072
    buffer_load_dwordx4 a[64:67], v2, s[24:27], s58 offen offset:0
    buffer_load_dwordx4 a[68:71], v2, s[24:27], s62 offen offset:0
    buffer_load_dwordx4 a[72:75], v2, s[24:27], s58 offen offset:1024
    buffer_load_dwordx4 a[76:79], v2, s[24:27], s62 offen offset:1024
    buffer_load_dwordx4 a[80:83], v2, s[24:27], s58 offen offset:2048
    buffer_load_dwordx4 a[84:87], v2, s[24:27], s62 offen offset:2048
    buffer_load_dwordx4 a[88:91], v2, s[24:27], s58 offen offset:3072
    buffer_load_dwordx4 a[92:95], v2, s[24:27], s62 offen offset:3072
    s_setprio 3
    s_waitcnt lgkmcnt(0)
    s_barrier
    ds_read_b64 v[32:33], v17 offset:16384
    ds_read_b64 v[34:35], v17 offset:16512
    ds_read_b64 v[36:37], v17 offset:16640
    ds_read_b64 v[38:39], v17 offset:16768
    ds_read_b64 v[40:41], v17 offset:16896
    buffer_load_dwordx4 a[96:99], v2, s[24:27], s59 offen offset:0
    ds_read_b64 v[42:43], v17 offset:17024
    ds_read_b64 v[44:45], v17 offset:17152
    ds_read_b64 v[46:47], v17 offset:17280
    s_waitcnt lgkmcnt(3)
    v_pk_add_f32 v[32:33], v[32:33], v[40:41]
    s_waitcnt lgkmcnt(2)
    v_pk_add_f32 v[34:35], v[34:35], v[42:43]
    s_waitcnt lgkmcnt(1)
    v_pk_add_f32 v[36:37], v[36:37], v[44:45]
    s_waitcnt lgkmcnt(0)
    v_pk_add_f32 v[38:39], v[38:39], v[46:47]
    v_pk_add_f32 v[32:33], v[32:33], v[36:37]
    buffer_load_dwordx4 a[100:103], v2, s[24:27], s63 offen offset:0
    v_pk_add_f32 v[34:35], v[34:35], v[38:39]
    v_pk_add_f32 v[32:33], v[32:33], v[34:35]
    v_mul_f32 v14, 0x3b000000, v32
    v_mul_f32 v15, 0x3b000000, v33
    v_fma_f32 v15, -v14, v14, v15
    v_max_f32 v15, 0, v15
    v_cvt_pk_bf16_f32 v14, 0, v14
    v_cvt_pk_bf16_f32 v15, 0, v15
    buffer_load_dwordx4 a[104:107], v2, s[24:27], s59 offen offset:1024
    v_add_f32 v15, 0x3727c5ac, v15
    v_cvt_pk_bf16_f32 v15, 0, v15
    v_sqrt_f32 v15, v15
    s_nop 0
    v_cvt_pk_bf16_f32 v15, 0, v15
    v_rcp_f32 v15, v15
    v_sub_f32 v28, 0, v14
    v_sub_f32 v29, 0, v14
    v_mov_b32 v30, v15
    buffer_load_dwordx4 a[108:111], v2, s[24:27], s63 offen offset:1024
    v_mov_b32 v31, v15
    v_pk_add_f32 v[48:49], v[48:49], v[28:29]
    v_pk_mul_f32 v[64:65], v[64:65], v[30:31]
    v_pk_fma_f32 v[48:49], v[48:49], v[64:65], v[80:81]
    v_cvt_pk_bf16_f32 v20, v48, v49
    v_pk_add_f32 v[50:51], v[50:51], v[28:29]
    v_pk_mul_f32 v[66:67], v[66:67], v[30:31]
    v_pk_fma_f32 v[50:51], v[50:51], v[66:67], v[82:83]
    buffer_load_dwordx4 a[112:115], v2, s[24:27], s59 offen offset:2048
    v_cvt_pk_bf16_f32 v21, v50, v51
    v_pk_add_f32 v[52:53], v[52:53], v[28:29]
    v_pk_mul_f32 v[68:69], v[68:69], v[30:31]
    v_pk_fma_f32 v[52:53], v[52:53], v[68:69], v[84:85]
    v_cvt_pk_bf16_f32 v22, v52, v53
    v_pk_add_f32 v[54:55], v[54:55], v[28:29]
    v_pk_mul_f32 v[70:71], v[70:71], v[30:31]
    v_pk_fma_f32 v[54:55], v[54:55], v[70:71], v[86:87]
    buffer_load_dwordx4 a[116:119], v2, s[24:27], s63 offen offset:2048
    v_cvt_pk_bf16_f32 v23, v54, v55
    v_pk_add_f32 v[56:57], v[56:57], v[28:29]
    v_pk_mul_f32 v[72:73], v[72:73], v[30:31]
    v_pk_fma_f32 v[56:57], v[56:57], v[72:73], v[88:89]
    v_cvt_pk_bf16_f32 v24, v56, v57
    v_pk_add_f32 v[58:59], v[58:59], v[28:29]
    v_pk_mul_f32 v[74:75], v[74:75], v[30:31]
    v_pk_fma_f32 v[58:59], v[58:59], v[74:75], v[90:91]
    buffer_load_dwordx4 a[120:123], v2, s[24:27], s59 offen offset:3072
    v_cvt_pk_bf16_f32 v25, v58, v59
    v_pk_add_f32 v[60:61], v[60:61], v[28:29]
    v_pk_mul_f32 v[76:77], v[76:77], v[30:31]
    v_pk_fma_f32 v[60:61], v[60:61], v[76:77], v[92:93]
    v_cvt_pk_bf16_f32 v26, v60, v61
    v_pk_add_f32 v[62:63], v[62:63], v[28:29]
    v_pk_mul_f32 v[78:79], v[78:79], v[30:31]
    v_pk_fma_f32 v[62:63], v[62:63], v[78:79], v[94:95]
    buffer_load_dwordx4 a[124:127], v2, s[24:27], s63 offen offset:3072
    v_cvt_pk_bf16_f32 v27, v62, v63
    s_lshl_b32 s48, s34, 11
    v_add_u32 v16, s48, v2
    ds_write_b128 v16, v[20:23] offset:0
    ds_write_b128 v16, v[24:27] offset:1024
    v_mov_b32 v14, 0
    v_mov_b32 v15, 0
    v_mov_b32 v18, 0
    v_mov_b32 v19, 0
    v_dot2_f32_bf16 v14, v20, s53, v14
    v_dot2_f32_bf16 v15, v20, v20, v15
    v_dot2_f32_bf16 v18, v21, s53, v18
    v_dot2_f32_bf16 v19, v21, v21, v19
    v_dot2_f32_bf16 v14, v22, s53, v14
    v_dot2_f32_bf16 v15, v22, v22, v15
    v_dot2_f32_bf16 v18, v23, s53, v18
    v_dot2_f32_bf16 v19, v23, v23, v19
    v_dot2_f32_bf16 v14, v24, s53, v14
    v_dot2_f32_bf16 v15, v24, v24, v15
    v_dot2_f32_bf16 v18, v25, s53, v18
    v_dot2_f32_bf16 v19, v25, v25, v19
    v_dot2_f32_bf16 v14, v26, s53, v14
    v_dot2_f32_bf16 v15, v26, v26, v15
    v_dot2_f32_bf16 v18, v27, s53, v18
    v_dot2_f32_bf16 v19, v27, v27, v19
    s_nop 2
    v_add_f32 v14, v14, v18
    v_add_f32 v15, v15, v19
    v_mov_b32 v18, v14
    v_mov_b32 v19, v15
    s_nop 0
    v_permlane16_swap_b32 v14, v18
    v_permlane16_swap_b32 v15, v19
    v_add_f32 v14, v14, v18
    v_add_f32 v15, v15, v19
    v_mov_b32 v18, v14
    v_mov_b32 v19, v15
    s_nop 0
    v_permlane32_swap_b32 v14, v18
    v_permlane32_swap_b32 v15, v19
    v_add_f32 v14, v14, v18
    v_add_f32 v15, v15, v19
    v_lshlrev_b32 v17, 3, v12
    s_lshl_b32 s48, s34, 7
    s_add_u32 s48, s48, 17408
    v_add_u32 v18, s48, v17
    ds_write_b64 v18, v[14:15]
    s_add_u32 s43, s41, 0x1600000
    s_add_u32 s43, s43, s54
    buffer_store_dwordx4 v[20:23], v3, s[24:27], s43 offen offset:0 sc0 sc1
    buffer_store_dwordx4 v[24:27], v3, s[24:27], s43 offen offset:2048 sc0 sc1
    v_lshrrev_b32 v16, 4, v1
    s_waitcnt lgkmcnt(0)
    s_barrier
    ds_read_b128 v[64:67], v2 offset:0
    ds_read_b128 v[68:71], v2 offset:1024
    ds_read_b128 v[72:75], v2 offset:2048
    ds_read_b128 v[76:79], v2 offset:3072
    ds_read_b128 v[80:83], v2 offset:4096
    ds_read_b128 v[84:87], v2 offset:5120
    ds_read_b128 v[88:91], v2 offset:6144
    ds_read_b128 v[92:95], v2 offset:7168
    ds_read_b128 v[96:99], v2 offset:8192
    s_waitcnt vmcnt(33) lgkmcnt(8)
    v_mfma_f32_16x16x32_bf16 v[48:51], a[0:3], v[64:67], 0
    ds_read_b128 v[100:103], v2 offset:9216
    s_waitcnt vmcnt(32)
    v_mfma_f32_16x16x32_bf16 v[52:55], a[4:7], v[64:67], 0
    ds_read_b128 v[104:107], v2 offset:10240
    s_waitcnt vmcnt(31) lgkmcnt(9)
    v_mfma_f32_16x16x32_bf16 v[48:51], a[8:11], v[68:71], v[48:51]
    ds_read_b128 v[108:111], v2 offset:11264
    ds_read_b128 v[112:115], v2 offset:12288
    s_waitcnt vmcnt(30)
    v_mfma_f32_16x16x32_bf16 v[52:55], a[12:15], v[68:71], v[52:55]
    ds_read_b128 v[116:119], v2 offset:13312
    s_waitcnt vmcnt(29) lgkmcnt(11)
    v_mfma_f32_16x16x32_bf16 v[48:51], a[16:19], v[72:75], v[48:51]
    ds_read_b128 v[120:123], v2 offset:14336
    s_waitcnt vmcnt(28)
    v_mfma_f32_16x16x32_bf16 v[52:55], a[20:23], v[72:75], v[52:55]
    ds_read_b128 v[124:127], v2 offset:15360
    ds_read_b64 v[32:33], v17 offset:17408
    s_waitcnt vmcnt(27) lgkmcnt(13)
    v_mfma_f32_16x16x32_bf16 v[48:51], a[24:27], v[76:79], v[48:51]
    ds_read_b64 v[34:35], v17 offset:17536
    s_waitcnt vmcnt(26)
    v_mfma_f32_16x16x32_bf16 v[52:55], a[28:31], v[76:79], v[52:55]
    ds_read_b64 v[36:37], v17 offset:17664
    s_waitcnt vmcnt(25) lgkmcnt(14)
    v_mfma_f32_16x16x32_bf16 v[48:51], a[32:35], v[80:83], v[48:51]
    ds_read_b64 v[38:39], v17 offset:17792
    ds_read_b64 v[40:41], v17 offset:17920
    s_waitcnt vmcnt(24)
    v_mfma_f32_16x16x32_bf16 v[52:55], a[36:39], v[80:83], v[52:55]
    ds_read_b64 v[42:43], v17 offset:18048
    s_waitcnt vmcnt(23) lgkmcnt(15)
    v_mfma_f32_16x16x32_bf16 v[48:51], a[40:43], v[84:87], v[48:51]
    ds_read_b64 v[44:45], v17 offset:18176
    s_waitcnt vmcnt(22)
    v_mfma_f32_16x16x32_bf16 v[52:55], a[44:47], v[84:87], v[52:55]
    ds_read_b64 v[46:47], v17 offset:18304
    s_waitcnt lgkmcnt(3)
    v_add_f32 v32, v32, v40
    s_waitcnt vmcnt(21)
    v_mfma_f32_16x16x32_bf16 v[48:51], a[48:51], v[88:91], v[48:51]
    v_add_f32 v33, v33, v41
    s_waitcnt vmcnt(20)
    v_mfma_f32_16x16x32_bf16 v[52:55], a[52:55], v[88:91], v[52:55]
    s_waitcnt lgkmcnt(2)
    v_add_f32 v34, v34, v42
    s_waitcnt vmcnt(19)
    v_mfma_f32_16x16x32_bf16 v[48:51], a[56:59], v[92:95], v[48:51]
    v_add_f32 v35, v35, v43
    s_waitcnt vmcnt(18)
    v_mfma_f32_16x16x32_bf16 v[52:55], a[60:63], v[92:95], v[52:55]
    s_waitcnt lgkmcnt(1)
    v_add_f32 v36, v36, v44
    v_add_f32 v37, v37, v45
    s_waitcnt vmcnt(17)
    v_mfma_f32_16x16x32_bf16 v[48:51], a[64:67], v[96:99], v[48:51]
    s_waitcnt lgkmcnt(0)
    v_add_f32 v38, v38, v46
    s_waitcnt vmcnt(16)
    v_mfma_f32_16x16x32_bf16 v[52:55], a[68:71], v[96:99], v[52:55]
    v_add_f32 v39, v39, v47
    s_waitcnt vmcnt(15)
    v_mfma_f32_16x16x32_bf16 v[48:51], a[72:75], v[100:103], v[48:51]
    v_add_f32 v32, v32, v36
    s_waitcnt vmcnt(14)
    v_mfma_f32_16x16x32_bf16 v[52:55], a[76:79], v[100:103], v[52:55]
    v_add_f32 v33, v33, v37
    v_add_f32 v34, v34, v38
    s_waitcnt vmcnt(13)
    v_mfma_f32_16x16x32_bf16 v[48:51], a[80:83], v[104:107], v[48:51]
    v_add_f32 v35, v35, v39
    s_waitcnt vmcnt(12)
    v_mfma_f32_16x16x32_bf16 v[52:55], a[84:87], v[104:107], v[52:55]
    v_add_f32 v32, v32, v34
    s_waitcnt vmcnt(11)
    v_mfma_f32_16x16x32_bf16 v[48:51], a[88:91], v[108:111], v[48:51]
    v_add_f32 v33, v33, v35
    s_waitcnt vmcnt(10)
    v_mfma_f32_16x16x32_bf16 v[52:55], a[92:95], v[108:111], v[52:55]
    v_mul_f32 v14, 0x3b000000, v32
    v_mul_f32 v15, 0x3b000000, v33
    s_waitcnt vmcnt(9)
    v_mfma_f32_16x16x32_bf16 v[48:51], a[96:99], v[112:115], v[48:51]
    v_fma_f32 v15, -v14, v14, v15
    s_waitcnt vmcnt(8)
    v_mfma_f32_16x16x32_bf16 v[52:55], a[100:103], v[112:115], v[52:55]
    v_max_f32 v15, 0, v15
    s_waitcnt vmcnt(7)
    v_mfma_f32_16x16x32_bf16 v[48:51], a[104:107], v[116:119], v[48:51]
    v_cvt_pk_bf16_f32 v14, 0, v14
    s_waitcnt vmcnt(6)
TP1:
    s_cbranch_execz TP5
    v_mfma_f32_16x16x32_bf16 v[52:55], a[108:111], v[116:119], v[52:55]
    v_cvt_pk_bf16_f32 v15, 0, v15
    v_add_f32 v15, 0x3727c5ac, v15
    s_waitcnt vmcnt(5)
    v_mfma_f32_16x16x32_bf16 v[48:51], a[112:115], v[120:123], v[48:51]
    v_cvt_pk_bf16_f32 v15, 0, v15
    s_waitcnt vmcnt(4)
    v_mfma_f32_16x16x32_bf16 v[52:55], a[116:119], v[120:123], v[52:55]
    v_sqrt_f32 v15, v15
    s_waitcnt vmcnt(3)
    v_mfma_f32_16x16x32_bf16 v[48:51], a[120:123], v[124:127], v[48:51]
    v_cvt_pk_bf16_f32 v15, 0, v15
    s_waitcnt vmcnt(2)
    v_mfma_f32_16x16x32_bf16 v[52:55], a[124:127], v[124:127], v[52:55]
    v_rcp_f32 v15, v15
    s_mov_b32 s50, 0xbdd2d3e8
    v_mov_b32 v19, 0xc0135761
    s_nop 1
    v_fma_f32 v48, -v14, v4, v48
    v_fma_f32 v49, -v14, v5, v49
    v_fma_f32 v50, -v14, v6, v50
    v_fma_f32 v51, -v14, v7, v51
    v_fma_f32 v52, -v14, v8, v52
    v_fma_f32 v53, -v14, v9, v53
    v_fma_f32 v54, -v14, v10, v54
    v_fma_f32 v55, -v14, v11, v55
    v_mul_f32 v48, v48, v15
    v_mul_f32 v49, v49, v15
    v_mul_f32 v50, v50, v15
    v_mul_f32 v51, v51, v15
    v_mul_f32 v52, v52, v15
    v_mul_f32 v53, v53, v15
    v_mul_f32 v54, v54, v15
    v_mul_f32 v55, v55, v15
    v_mul_f32 v32, v48, v48
    v_mul_f32 v33, v49, v49
    v_mul_f32 v34, v50, v50
    v_mul_f32 v35, v51, v51
    v_mul_f32 v36, v52, v52
    v_mul_f32 v37, v53, v53
    v_mul_f32 v38, v54, v54
    v_mul_f32 v39, v55, v55
    v_fma_f32 v32, v32, s50, v19
    v_fma_f32 v33, v33, s50, v19
    v_fma_f32 v34, v34, s50, v19
    v_fma_f32 v35, v35, s50, v19
    v_fma_f32 v36, v36, s50, v19
    v_fma_f32 v37, v37, s50, v19
    v_fma_f32 v38, v38, s50, v19
    v_fma_f32 v39, v39, s50, v19
    v_mul_f32 v32, v32, v48
    v_mul_f32 v33, v33, v49
    v_mul_f32 v34, v34, v50
    v_mul_f32 v35, v35, v51
    v_mul_f32 v36, v36, v52
    v_mul_f32 v37, v37, v53
    v_mul_f32 v38, v38, v54
    v_mul_f32 v39, v39, v55
    v_exp_f32 v32, v32
    v_exp_f32 v33, v33
    v_exp_f32 v34, v34
    v_exp_f32 v35, v35
    v_exp_f32 v36, v36
    v_exp_f32 v37, v37
    v_exp_f32 v38, v38
    v_exp_f32 v39, v39
    v_add_f32 v32, 1.0, v32
    v_add_f32 v33, 1.0, v33
    v_add_f32 v34, 1.0, v34
    v_add_f32 v35, 1.0, v35
    v_add_f32 v36, 1.0, v36
    v_add_f32 v37, 1.0, v37
    v_add_f32 v38, 1.0, v38
    v_add_f32 v39, 1.0, v39
    v_rcp_f32 v32, v32
    v_rcp_f32 v33, v33
    v_rcp_f32 v34, v34
    v_rcp_f32 v35, v35
    v_rcp_f32 v36, v36
    v_rcp_f32 v37, v37
    v_rcp_f32 v38, v38
    v_rcp_f32 v39, v39
    v_mul_f32 v48, v48, v32
    v_mul_f32 v49, v49, v33
    v_mul_f32 v50, v50, v34
    v_mul_f32 v51, v51, v35
    v_mul_f32 v52, v52, v36
    v_mul_f32 v53, v53, v37
    v_mul_f32 v54, v54, v38
    v_mul_f32 v55, v55, v39
    v_cvt_pk_bf16_f32 v20, v48, v49
    v_cvt_pk_bf16_f32 v21, v50, v51
    v_cvt_pk_bf16_f32 v22, v52, v53
    v_cvt_pk_bf16_f32 v23, v54, v55
    v_and_b32 v13, 1, v16
    v_lshl_add_u32 v13, v13, 5, v12
    v_add_u32 v13, s37, v13
    v_lshlrev_b32 v13, 4, v13
    v_lshrrev_b32 v17, 1, v16
    v_lshl_add_u32 v13, v17, 10, v13
    s_lshl_b32 s48, s45, 11
    s_add_u32 s48, s48, s40
    s_add_u32 s48, s48, 0x1800000
    buffer_store_dwordx4 v[20:23], v13, s[24:27], s48 offen sc0 sc1
    s_endpgm
K2_B:
    s_add_u32 s43, s42, 0x0
    buffer_load_dwordx4 v[64:67], v3, s[24:27], s43 offen offset:0
    s_add_u32 s43, s42, 0x0
    buffer_load_dwordx4 v[68:71], v3, s[24:27], s43 offen offset:2048
    v_lshlrev_b32 v15, 10, v12
    v_lshl_add_u32 v15, v13, 5, v15
    v_lshl_add_u32 v15, v14, 4, v15
    s_lshl_b32 s43, s35, 14
    s_lshl_b32 s44, s34, 7
    s_add_u32 s43, s43, s44
    buffer_load_dwordx4 v[20:23], v15, s[8:11], s43 offen offset:0
    buffer_load_dwordx4 v[24:27], v15, s[8:11], s43 offen offset:64
    v_lshlrev_b32 v16, 6, v13
    v_lshl_add_u32 v16, v14, 5, v16
    s_lshl_b32 s44, s34, 8
    s_add_u32 s44, s44, 0x200000
    v_lshrrev_b32 v28, 4, v1
    v_lshlrev_b32 v28, 11, v28
    v_lshl_add_u32 v28, v12, 4, v28
    s_lshl_b32 s48, s34, 8
    v_add_u32 v28, s48, v28
    s_lshl_b32 s45, s36, 3
    s_add_u32 s45, s45, s34
    s_lshl_b32 s48, s45, 7
    s_add_u32 s48, s48, 0x2000
    v_and_b32 v29, 7, v1
    v_lshl_add_u32 v29, v29, 4, s48
    v_cmp_gt_u32 vcc, 48, v1
    s_nop 1
    v_cndmask_b32 v28, v29, v28, vcc
    s_lshl_b32 s48, s34, 11
    s_mov_b32 m0, s48
    s_mov_b32 s43, 0x200000
    buffer_load_dwordx4 v28, s[24:27], s43 offen lds
    v_add_u32 v16, s48, v16
    s_lshl_b32 s45, s36, 3
    s_add_u32 s45, s45, s34
    s_lshl_b32 s46, s45, 15
    s_add_u32 s46, s46, 0x280000
    s_add_u32 s56, s46, 0
    s_add_u32 s57, s46, 4096
    s_add_u32 s58, s46, 8192
    s_add_u32 s59, s46, 12288
    s_add_u32 s60, s46, 16384
    s_add_u32 s61, s46, 20480
    s_add_u32 s62, s46, 24576
    s_add_u32 s63, s46, 28672
    s_add_u32 s43, s42, 0x200000
    buffer_load_dwordx4 v[72:75], v3, s[24:27], s43 offen offset:0
    s_add_u32 s43, s42, 0x200000
    buffer_load_dwordx4 v[76:79], v3, s[24:27], s43 offen offset:2048
    s_add_u32 s43, s42, 0x400000
    buffer_load_dwordx4 v[80:83], v3, s[24:27], s43 offen offset:0
    s_add_u32 s43, s42, 0x400000
    buffer_load_dwordx4 v[84:87], v3, s[24:27], s43 offen offset:2048
    s_add_u32 s43, s42, 0x600000
    buffer_load_dwordx4 v[88:91], v3, s[24:27], s43 offen offset:0
    s_add_u32 s43, s42, 0x600000
    buffer_load_dwordx4 v[92:95], v3, s[24:27], s43 offen offset:2048
    s_add_u32 s43, s42, 0x800000
    buffer_load_dwordx4 v[96:99], v3, s[24:27], s43 offen offset:0
    s_add_u32 s43, s42, 0x800000
    buffer_load_dwordx4 v[100:103], v3, s[24:27], s43 offen offset:2048
    v_and_b32 v17, 31, v1
    v_and_b32 v18, 0x13, v17
    v_bfe_u32 v19, v17, 2, 1
    v_lshl_or_b32 v18, v19, 3, v18
    v_bfe_u32 v19, v17, 3, 1
    v_lshl_or_b32 v18, v19, 2, v18
    v_lshrrev_b32 v17, 5, v1
    v_lshlrev_b32 v17, 3, v17
    v_sub_u32 v18, v18, v17
    v_mov_b32 v4, 0
    v_cmp_eq_u32 vcc, 0, v18
    v_mov_b32 v19, 0x3f80
    s_nop 0
    v_cndmask_b32 v4, v4, v19, vcc
    v_cmp_eq_u32 vcc, 1, v18
    v_mov_b32 v19, 0x3f800000
    s_nop 0
    v_cndmask_b32 v4, v4, v19, vcc
    v_mov_b32 v5, 0
    v_cmp_eq_u32 vcc, 2, v18
    v_mov_b32 v19, 0x3f80
    s_nop 0
    v_cndmask_b32 v5, v5, v19, vcc
    v_cmp_eq_u32 vcc, 3, v18
    v_mov_b32 v19, 0x3f800000
    s_nop 0
    v_cndmask_b32 v5, v5, v19, vcc
    v_mov_b32 v6, 0
    v_cmp_eq_u32 vcc, 4, v18
    v_mov_b32 v19, 0x3f80
    s_nop 0
    v_cndmask_b32 v6, v6, v19, vcc
    v_cmp_eq_u32 vcc, 5, v18
    v_mov_b32 v19, 0x3f800000
    s_nop 0
    v_cndmask_b32 v6, v6, v19, vcc
    v_mov_b32 v7, 0
    v_cmp_eq_u32 vcc, 6, v18
    v_mov_b32 v19, 0x3f80
    s_nop 0
    v_cndmask_b32 v7, v7, v19, vcc
    v_cmp_eq_u32 vcc, 7, v18
    v_mov_b32 v19, 0x3f800000
    s_nop 0
    v_cndmask_b32 v7, v7, v19, vcc
    v_mov_b32 v8, 0
    v_cmp_eq_u32 vcc, 16, v18
    v_mov_b32 v19, 0x3f80
    s_nop 0
    v_cndmask_b32 v8, v8, v19, vcc
    v_cmp_eq_u32 vcc, 17, v18
    v_mov_b32 v19, 0x3f800000
    s_nop 0
    v_cndmask_b32 v8, v8, v19, vcc
    v_mov_b32 v9, 0
    v_cmp_eq_u32 vcc, 18, v18
    v_mov_b32 v19, 0x3f80
    s_nop 0
    v_cndmask_b32 v9, v9, v19, vcc
    v_cmp_eq_u32 vcc, 19, v18
    v_mov_b32 v19, 0x3f800000
    s_nop 0
    v_cndmask_b32 v9, v9, v19, vcc
    v_mov_b32 v10, 0
    v_cmp_eq_u32 vcc, 20, v18
    v_mov_b32 v19, 0x3f80
    s_nop 0
    v_cndmask_b32 v10, v10, v19, vcc
    v_cmp_eq_u32 vcc, 21, v18
    v_mov_b32 v19, 0x3f800000
    s_nop 0
    v_cndmask_b32 v10, v10, v19, vcc
    v_mov_b32 v11, 0
    v_cmp_eq_u32 vcc, 22, v18
    v_mov_b32 v19, 0x3f80
    s_nop 0
    v_cndmask_b32 v11, v11, v19, vcc
    v_cmp_eq_u32 vcc, 23, v18
    v_mov_b32 v19, 0x3f800000
    s_nop 0
    v_cndmask_b32 v11, v11, v19, vcc
    s_waitcnt vmcnt(8)
    ds_read_b128 v[32:35], v16 offset:0
    ds_read_b128 v[36:39], v16 offset:16
    ds_read_b128 v[40:43], v16 offset:128
    ds_read_b128 v[44:47], v16 offset:144
    s_add_u32 s43, s42, 0xa00000
    buffer_load_dwordx4 v[104:107], v3, s[24:27], s43 offen offset:0
    s_add_u32 s43, s42, 0xa00000
    buffer_load_dwordx4 v[108:111], v3, s[24:27], s43 offen offset:2048
    s_add_u32 s43, s42, 0xc00000
    buffer_load_dwordx4 v[112:115], v3, s[24:27], s43 offen offset:0
    s_add_u32 s43, s42, 0xc00000
    buffer_load_dwordx4 v[116:119], v3, s[24:27], s43 offen offset:2048
    s_add_u32 s43, s42, 0xe00000
    buffer_load_dwordx4 v[120:123], v3, s[24:27], s43 offen offset:0
    s_add_u32 s43, s42, 0xe00000
    buffer_load_dwordx4 v[124:127], v3, s[24:27], s43 offen offset:2048
    s_mov_b32 s52, 0xffff0000
    s_mov_b32 s53, 0x3f803f80
    v_mfma_f32_32x32x16_bf16 v[48:63], v[4:7], v[64:67], 0
    v_mfma_f32_32x32x16_bf16 v[48:63], v[8:11], v[68:71], v[48:63]
    s_waitcnt vmcnt(13)
    v_mfma_f32_32x32x16_bf16 v[48:63], v[4:7], v[72:75], v[48:63]
    s_waitcnt vmcnt(12)
    v_mfma_f32_32x32x16_bf16 v[48:63], v[8:11], v[76:79], v[48:63]
    s_waitcnt vmcnt(11)
    v_mfma_f32_32x32x16_bf16 v[48:63], v[4:7], v[80:83], v[48:63]
    s_waitcnt vmcnt(10)
    v_mfma_f32_32x32x16_bf16 v[48:63], v[8:11], v[84:87], v[48:63]
    s_waitcnt vmcnt(9)
    v_mfma_f32_32x32x16_bf16 v[48:63], v[4:7], v[88:91], v[48:63]
    s_waitcnt vmcnt(8)
    v_mfma_f32_32x32x16_bf16 v[48:63], v[8:11], v[92:95], v[48:63]
    s_waitcnt vmcnt(7)
    v_mfma_f32_32x32x16_bf16 v[48:63], v[4:7], v[96:99], v[48:63]
    s_waitcnt vmcnt(6)
    v_mfma_f32_32x32x16_bf16 v[48:63], v[8:11], v[100:103], v[48:63]
    s_waitcnt vmcnt(5)
    v_mfma_f32_32x32x16_bf16 v[48:63], v[4:7], v[104:107], v[48:63]
    s_waitcnt vmcnt(4)
    v_mfma_f32_32x32x16_bf16 v[48:63], v[8:11], v[108:111], v[48:63]
    s_waitcnt vmcnt(3)
    v_mfma_f32_32x32x16_bf16 v[48:63], v[4:7], v[112:115], v[48:63]
    s_waitcnt vmcnt(2)
    v_mfma_f32_32x32x16_bf16 v[48:63], v[8:11], v[116:119], v[48:63]
    s_waitcnt vmcnt(1)
    v_mfma_f32_32x32x16_bf16 v[48:63], v[4:7], v[120:123], v[48:63]
    s_waitcnt vmcnt(0)
    v_mfma_f32_32x32x16_bf16 v[48:63], v[8:11], v[124:127], v[48:63]
    s_nop 7
    ds_read_b128 v[64:67], v16 offset:512
    v_lshlrev_b32 v28, 16, v20
    ds_read_b128 v[68:71], v16 offset:528
    ds_read_b128 v[72:75], v16 offset:640
    ds_read_b128 v[76:79], v16 offset:656
    v_and_b32 v29, s52, v20
    ds_read_b128 v[80:83], v16 offset:256
    ds_read_b128 v[84:87], v16 offset:272
    ds_read_b128 v[88:91], v16 offset:384
    s_waitcnt lgkmcnt(10)
    v_pk_fma_f32 v[48:49], v[48:49], v[32:33], v[28:29]
    ds_read_b128 v[92:95], v16 offset:400
    v_lshrrev_b32 v13, 4, v1
    s_lshl_b32 s48, s34, 11
    v_lshl_add_u32 v13, v13, 5, s48
    ds_read_b128 v[4:7], v13 offset:768
    v_cvt_pk_bf16_f32 v20, v48, v49
    ds_read_b128 v[8:11], v13 offset:784
    v_lshlrev_b32 v48, 16, v20
    v_and_b32 v49, s52, v20
    v_lshlrev_b32 v30, 16, v21
    v_and_b32 v31, s52, v21
    v_pk_fma_f32 v[50:51], v[50:51], v[34:35], v[30:31]
    v_cvt_pk_bf16_f32 v21, v50, v51
    v_lshlrev_b32 v50, 16, v21
    v_and_b32 v51, s52, v21
    v_lshlrev_b32 v28, 16, v22
    buffer_load_dwordx4 a[0:3], v2, s[24:27], s56 offen offset:0
    v_and_b32 v29, s52, v22
    s_waitcnt lgkmcnt(12)
    v_pk_fma_f32 v[52:53], v[52:53], v[36:37], v[28:29]
    v_cvt_pk_bf16_f32 v22, v52, v53
    v_lshlrev_b32 v52, 16, v22
    v_and_b32 v53, s52, v22
    v_lshlrev_b32 v30, 16, v23
    v_and_b32 v31, s52, v23
    v_pk_fma_f32 v[54:55], v[54:55], v[38:39], v[30:31]
    v_cvt_pk_bf16_f32 v23, v54, v55
    buffer_load_dwordx4 a[4:7], v2, s[24:27], s60 offen offset:0
    v_lshlrev_b32 v54, 16, v23
    v_and_b32 v55, s52, v23
    v_lshlrev_b32 v28, 16, v24
    v_and_b32 v29, s52, v24
    s_waitcnt lgkmcnt(11)
    v_pk_fma_f32 v[56:57], v[56:57], v[40:41], v[28:29]
    v_cvt_pk_bf16_f32 v24, v56, v57
    v_lshlrev_b32 v56, 16, v24
    v_and_b32 v57, s52, v24
    v_lshlrev_b32 v30, 16, v25
    buffer_load_dwordx4 a[8:11], v2, s[24:27], s56 offen offset:1024
    v_and_b32 v31, s52, v25
    v_pk_fma_f32 v[58:59], v[58:59], v[42:43], v[30:31]
    v_cvt_pk_bf16_f32 v25, v58, v59
    v_lshlrev_b32 v58, 16, v25
    v_and_b32 v59, s52, v25
    v_lshlrev_b32 v28, 16, v26
    v_and_b32 v29, s52, v26
    s_waitcnt lgkmcnt(10)
    v_pk_fma_f32 v[60:61], v[60:61], v[44:45], v[28:29]
    v_cvt_pk_bf16_f32 v26, v60, v61
    buffer_load_dwordx4 a[12:15], v2, s[24:27], s60 offen offset:1024
    v_lshlrev_b32 v60, 16, v26
    v_and_b32 v61, s52, v26
    v_lshlrev_b32 v30, 16, v27
    v_and_b32 v31, s52, v27
    v_pk_fma_f32 v[62:63], v[62:63], v[46:47], v[30:31]
    v_cvt_pk_bf16_f32 v27, v62, v63
    v_lshlrev_b32 v62, 16, v27
    v_and_b32 v63, s52, v27
    v_mov_b32 v14, 0
    buffer_load_dwordx4 a[16:19], v2, s[24:27], s56 offen offset:2048
    v_mov_b32 v15, 0
    v_mov_b32 v18, 0
    v_mov_b32 v19, 0
    v_dot2_f32_bf16 v14, v20, s53, v14
    v_dot2_f32_bf16 v15, v20, v20, v15
    v_dot2_f32_bf16 v18, v21, s53, v18
    v_dot2_f32_bf16 v19, v21, v21, v19
    v_dot2_f32_bf16 v14, v22, s53, v14
    v_dot2_f32_bf16 v15, v22, v22, v15
    buffer_load_dwordx4 a[20:23], v2, s[24:27], s60 offen offset:2048
    v_dot2_f32_bf16 v18, v23, s53, v18
    v_dot2_f32_bf16 v19, v23, v23, v19
    v_dot2_f32_bf16 v14, v24, s53, v14
    v_dot2_f32_bf16 v15, v24, v24, v15
    v_dot2_f32_bf16 v18, v25, s53, v18
    v_dot2_f32_bf16 v19, v25, v25, v19
    v_dot2_f32_bf16 v14, v26, s53, v14
    v_dot2_f32_bf16 v15, v26, v26, v15
    v_dot2_f32_bf16 v18, v27, s53, v18
    buffer_load_dwordx4 a[24:27], v2, s[24:27], s56 offen offset:3072
    v_dot2_f32_bf16 v19, v27, v27, v19
    s_nop 2
    v_add_f32 v14, v14, v18
    v_add_f32 v15, v15, v19
    v_mov_b32 v18, v14
    v_mov_b32 v19, v15
    s_nop 0
    v_permlane16_swap_b32 v14, v18
    v_permlane16_swap_b32 v15, v19
    v_add_f32 v14, v14, v18
    buffer_load_dwordx4 a[28:31], v2, s[24:27], s60 offen offset:3072
    v_add_f32 v15, v15, v19
    v_mov_b32 v18, v14
    v_mov_b32 v19, v15
    s_nop 0
    v_permlane32_swap_b32 v14, v18
    v_permlane32_swap_b32 v15, v19
    v_add_f32 v14, v14, v18
    v_add_f32 v15, v15, v19
    v_lshlrev_b32 v17, 3, v12
    s_lshl_b32 s48, s34, 7
    buffer_load_dwordx4 a[32:35], v2, s[24:27], s57 offen offset:0
    s_add_u32 s48, s48, 16384
    v_add_u32 v18, s48, v17
    ds_write_b64 v18, v[14:15]
    s_lshr_b32 s47, s34, 2
    s_cmp_eq_u32 s47, s36
    s_cselect_b32 s54, 0, 0x10000000
    s_add_u32 s43, s41, 0x1400000
    s_add_u32 s43, s43, s54
    buffer_store_dwordx4 v[20:23], v3, s[24:27], s43 offen offset:0 sc0 sc1
    buffer_load_dwordx4 a[36:39], v2, s[24:27], s61 offen offset:0
    buffer_store_dwordx4 v[24:27], v3, s[24:27], s43 offen offset:2048 sc0 sc1
    s_waitcnt lgkmcnt(0)
    s_barrier
    ds_read_b64 v[32:33], v17 offset:16384
    ds_read_b64 v[34:35], v17 offset:16512
    ds_read_b64 v[36:37], v17 offset:16640
    ds_read_b64 v[38:39], v17 offset:16768
    ds_read_b64 v[40:41], v17 offset:16896
    ds_read_b64 v[42:43], v17 offset:17024
    buffer_load_dwordx4 a[40:43], v2, s[24:27], s57 offen offset:1024
    ds_read_b64 v[44:45], v17 offset:17152
    ds_read_b64 v[46:47], v17 offset:17280
    s_waitcnt lgkmcnt(3)
    v_pk_add_f32 v[32:33], v[32:33], v[40:41]
    s_waitcnt lgkmcnt(2)
    v_pk_add_f32 v[34:35], v[34:35], v[42:43]
    s_waitcnt lgkmcnt(1)
    v_pk_add_f32 v[36:37], v[36:37], v[44:45]
    s_waitcnt lgkmcnt(0)
    v_pk_add_f32 v[38:39], v[38:39], v[46:47]
    v_pk_add_f32 v[32:33], v[32:33], v[36:37]
    v_pk_add_f32 v[34:35], v[34:35], v[38:39]
    v_pk_add_f32 v[32:33], v[32:33], v[34:35]
    buffer_load_dwordx4 a[44:47], v2, s[24:27], s61 offen offset:1024
    v_mul_f32 v14, 0x3b000000, v32
    v_mul_f32 v15, 0x3b000000, v33
    v_fma_f32 v15, -v14, v14, v15
    v_max_f32 v15, 0, v15
    v_cvt_pk_bf16_f32 v14, 0, v14
    v_cvt_pk_bf16_f32 v15, 0, v15
    v_add_f32 v15, 0x3727c5ac, v15
    v_cvt_pk_bf16_f32 v15, 0, v15
    v_sqrt_f32 v15, v15
    buffer_load_dwordx4 a[48:51], v2, s[24:27], s57 offen offset:2048
    v_cvt_pk_bf16_f32 v15, 0, v15
    v_rcp_f32 v15, v15
    v_sub_f32 v28, 0, v14
    v_sub_f32 v29, 0, v14
    v_mov_b32 v30, v15
    v_mov_b32 v31, v15
    v_pk_add_f32 v[48:49], v[48:49], v[28:29]
    v_pk_mul_f32 v[64:65], v[64:65], v[30:31]
    v_pk_fma_f32 v[48:49], v[48:49], v[64:65], v[80:81]
    buffer_load_dwordx4 a[52:55], v2, s[24:27], s61 offen offset:2048
    v_cvt_pk_bf16_f32 v20, v48, v49
    v_pk_add_f32 v[50:51], v[50:51], v[28:29]
    v_pk_mul_f32 v[66:67], v[66:67], v[30:31]
    v_pk_fma_f32 v[50:51], v[50:51], v[66:67], v[82:83]
    v_cvt_pk_bf16_f32 v21, v50, v51
    v_pk_add_f32 v[52:53], v[52:53], v[28:29]
    v_pk_mul_f32 v[68:69], v[68:69], v[30:31]
    v_pk_fma_f32 v[52:53], v[52:53], v[68:69], v[84:85]
    v_cvt_pk_bf16_f32 v22, v52, v53
    buffer_load_dwordx4 a[56:59], v2, s[24:27], s57 offen offset:3072
    v_pk_add_f32 v[54:55], v[54:55], v[28:29]
    v_pk_mul_f32 v[70:71], v[70:71], v[30:31]
    v_pk_fma_f32 v[54:55], v[54:55], v[70:71], v[86:87]
    v_cvt_pk_bf16_f32 v23, v54, v55
    v_pk_add_f32 v[56:57], v[56:57], v[28:29]
    v_pk_mul_f32 v[72:73], v[72:73], v[30:31]
    v_pk_fma_f32 v[56:57], v[56:57], v[72:73], v[88:89]
    v_cvt_pk_bf16_f32 v24, v56, v57
    v_pk_add_f32 v[58:59], v[58:59], v[28:29]
    buffer_load_dwordx4 a[60:63], v2, s[24:27], s61 offen offset:3072
    v_pk_mul_f32 v[74:75], v[74:75], v[30:31]
    v_pk_fma_f32 v[58:59], v[58:59], v[74:75], v[90:91]
    v_cvt_pk_bf16_f32 v25, v58, v59
    v_pk_add_f32 v[60:61], v[60:61], v[28:29]
    v_pk_mul_f32 v[76:77], v[76:77], v[30:31]
    v_pk_fma_f32 v[60:61], v[60:61], v[76:77], v[92:93]
    v_cvt_pk_bf16_f32 v26, v60, v61
    v_pk_add_f32 v[62:63], v[62:63], v[28:29]
    v_pk_mul_f32 v[78:79], v[78:79], v[30:31]
    buffer_load_dwordx4 a[64:67], v2, s[24:27], s58 offen offset:0
    v_pk_fma_f32 v[62:63], v[62:63], v[78:79], v[94:95]
    v_cvt_pk_bf16_f32 v27, v62, v63
    s_lshl_b32 s48, s34, 11
    v_add_u32 v16, s48, v2
    ds_write_b128 v16, v[20:23] offset:0
    ds_write_b128 v16, v[24:27] offset:1024
    v_mov_b32 v14, 0
    v_mov_b32 v15, 0
    v_mov_b32 v18, 0
    buffer_load_dwordx4 a[68:71], v2, s[24:27], s62 offen offset:0
    v_mov_b32 v19, 0
    v_dot2_f32_bf16 v14, v20, s53, v14
    v_dot2_f32_bf16 v15, v20, v20, v15
    v_dot2_f32_bf16 v18, v21, s53, v18
    v_dot2_f32_bf16 v19, v21, v21, v19
    v_dot2_f32_bf16 v14, v22, s53, v14
    v_dot2_f32_bf16 v15, v22, v22, v15
    v_dot2_f32_bf16 v18, v23, s53, v18
    v_dot2_f32_bf16 v19, v23, v23, v19
    buffer_load_dwordx4 a[72:75], v2, s[24:27], s58 offen offset:1024
    v_dot2_f32_bf16 v14, v24, s53, v14
    v_dot2_f32_bf16 v15, v24, v24, v15
    v_dot2_f32_bf16 v18, v25, s53, v18
    v_dot2_f32_bf16 v19, v25, v25, v19
    v_dot2_f32_bf16 v14, v26, s53, v14
    v_dot2_f32_bf16 v15, v26, v26, v15
    v_dot2_f32_bf16 v18, v27, s53, v18
    v_dot2_f32_bf16 v19, v27, v27, v19
    s_nop 2
    buffer_load_dwordx4 a[76:79], v2, s[24:27], s62 offen offset:1024
    v_add_f32 v14, v14, v18
    v_add_f32 v15, v15, v19
    v_mov_b32 v18, v14
    v_mov_b32 v19, v15
    s_nop 0
    v_permlane16_swap_b32 v14, v18
    v_permlane16_swap_b32 v15, v19
    v_add_f32 v14, v14, v18
    v_add_f32 v15, v15, v19
    v_mov_b32 v18, v14
    buffer_load_dwordx4 a[80:83], v2, s[24:27], s58 offen offset:2048
    v_mov_b32 v19, v15
    v_permlane32_swap_b32 v14, v18
    s_nop 0
    v_permlane32_swap_b32 v15, v19
    v_add_f32 v14, v14, v18
    v_add_f32 v15, v15, v19
    v_lshlrev_b32 v17, 3, v12
    s_lshl_b32 s48, s34, 7
    s_add_u32 s48, s48, 17408
    v_add_u32 v18, s48, v17
    buffer_load_dwordx4 a[84:87], v2, s[24:27], s62 offen offset:2048
    ds_write_b64 v18, v[14:15]
    s_add_u32 s43, s41, 0x1600000
    s_add_u32 s43, s43, s54
    buffer_store_dwordx4 v[20:23], v3, s[24:27], s43 offen offset:0 sc0 sc1
    buffer_store_dwordx4 v[24:27], v3, s[24:27], s43 offen offset:2048 sc0 sc1
    v_lshrrev_b32 v16, 4, v1
    s_waitcnt lgkmcnt(0)
    s_barrier
    buffer_load_dwordx4 a[88:91], v2, s[24:27], s58 offen offset:3072
    buffer_load_dwordx4 a[92:95], v2, s[24:27], s62 offen offset:3072
    buffer_load_dwordx4 a[96:99], v2, s[24:27], s59 offen offset:0
    buffer_load_dwordx4 a[100:103], v2, s[24:27], s63 offen offset:0
    buffer_load_dwordx4 a[104:107], v2, s[24:27], s59 offen offset:1024
    buffer_load_dwordx4 a[108:111], v2, s[24:27], s63 offen offset:1024
    buffer_load_dwordx4 a[112:115], v2, s[24:27], s59 offen offset:2048
    buffer_load_dwordx4 a[116:119], v2, s[24:27], s63 offen offset:2048
    buffer_load_dwordx4 a[120:123], v2, s[24:27], s59 offen offset:3072
    buffer_load_dwordx4 a[124:127], v2, s[24:27], s63 offen offset:3072
    ds_read_b128 v[64:67], v2 offset:0
    ds_read_b128 v[68:71], v2 offset:1024
    ds_read_b128 v[72:75], v2 offset:2048
    ds_read_b128 v[76:79], v2 offset:3072
    ds_read_b128 v[80:83], v2 offset:4096
    ds_read_b128 v[84:87], v2 offset:5120
    ds_read_b128 v[88:91], v2 offset:6144
    ds_read_b128 v[92:95], v2 offset:7168
    ds_read_b128 v[96:99], v2 offset:8192
    s_waitcnt vmcnt(35) lgkmcnt(8)
    v_mfma_f32_16x16x32_bf16 v[48:51], a[0:3], v[64:67], 0
    ds_read_b128 v[100:103], v2 offset:9216
    s_waitcnt vmcnt(34)
    v_mfma_f32_16x16x32_bf16 v[52:55], a[4:7], v[64:67], 0
    ds_read_b128 v[104:107], v2 offset:10240
    s_waitcnt vmcnt(33) lgkmcnt(9)
    v_mfma_f32_16x16x32_bf16 v[48:51], a[8:11], v[68:71], v[48:51]
    ds_read_b128 v[108:111], v2 offset:11264
    ds_read_b128 v[112:115], v2 offset:12288
    s_waitcnt vmcnt(32)
    v_mfma_f32_16x16x32_bf16 v[52:55], a[12:15], v[68:71], v[52:55]
    ds_read_b128 v[116:119], v2 offset:13312
    s_waitcnt vmcnt(31) lgkmcnt(11)
    v_mfma_f32_16x16x32_bf16 v[48:51], a[16:19], v[72:75], v[48:51]
    ds_read_b128 v[120:123], v2 offset:14336
    s_waitcnt vmcnt(30)
    v_mfma_f32_16x16x32_bf16 v[52:55], a[20:23], v[72:75], v[52:55]
    ds_read_b128 v[124:127], v2 offset:15360
    ds_read_b64 v[32:33], v17 offset:17408
    s_waitcnt vmcnt(29) lgkmcnt(13)
    v_mfma_f32_16x16x32_bf16 v[48:51], a[24:27], v[76:79], v[48:51]
    ds_read_b64 v[34:35], v17 offset:17536
    s_waitcnt vmcnt(28)
    v_mfma_f32_16x16x32_bf16 v[52:55], a[28:31], v[76:79], v[52:55]
    ds_read_b64 v[36:37], v17 offset:17664
    s_waitcnt vmcnt(27) lgkmcnt(14)
    v_mfma_f32_16x16x32_bf16 v[48:51], a[32:35], v[80:83], v[48:51]
    ds_read_b64 v[38:39], v17 offset:17792
    ds_read_b64 v[40:41], v17 offset:17920
    s_waitcnt vmcnt(25)
    v_mfma_f32_16x16x32_bf16 v[52:55], a[36:39], v[80:83], v[52:55]
    ds_read_b64 v[42:43], v17 offset:18048
    s_waitcnt vmcnt(23) lgkmcnt(15)
    v_mfma_f32_16x16x32_bf16 v[48:51], a[40:43], v[84:87], v[48:51]
    ds_read_b64 v[44:45], v17 offset:18176
    s_waitcnt vmcnt(22)
    v_mfma_f32_16x16x32_bf16 v[52:55], a[44:47], v[84:87], v[52:55]
    ds_read_b64 v[46:47], v17 offset:18304
    s_waitcnt lgkmcnt(3)
    v_add_f32 v32, v32, v40
    s_waitcnt vmcnt(21)
    v_mfma_f32_16x16x32_bf16 v[48:51], a[48:51], v[88:91], v[48:51]
    v_add_f32 v33, v33, v41
    s_waitcnt vmcnt(20)
    v_mfma_f32_16x16x32_bf16 v[52:55], a[52:55], v[88:91], v[52:55]
    s_waitcnt lgkmcnt(2)
    v_add_f32 v34, v34, v42
    s_waitcnt vmcnt(19)
    v_mfma_f32_16x16x32_bf16 v[48:51], a[56:59], v[92:95], v[48:51]
    v_add_f32 v35, v35, v43
    s_waitcnt vmcnt(18)
    v_mfma_f32_16x16x32_bf16 v[52:55], a[60:63], v[92:95], v[52:55]
    s_waitcnt lgkmcnt(1)
    v_add_f32 v36, v36, v44
    v_add_f32 v37, v37, v45
    s_waitcnt vmcnt(17)
    v_mfma_f32_16x16x32_bf16 v[48:51], a[64:67], v[96:99], v[48:51]
    s_waitcnt lgkmcnt(0)
    v_add_f32 v38, v38, v46
    s_waitcnt vmcnt(16)
    v_mfma_f32_16x16x32_bf16 v[52:55], a[68:71], v[96:99], v[52:55]
    v_add_f32 v39, v39, v47
    s_waitcnt vmcnt(15)
    v_mfma_f32_16x16x32_bf16 v[48:51], a[72:75], v[100:103], v[48:51]
    v_add_f32 v32, v32, v36
    s_waitcnt vmcnt(14)
    v_mfma_f32_16x16x32_bf16 v[52:55], a[76:79], v[100:103], v[52:55]
    v_add_f32 v33, v33, v37
    v_add_f32 v34, v34, v38
    s_waitcnt vmcnt(13)
    v_mfma_f32_16x16x32_bf16 v[48:51], a[80:83], v[104:107], v[48:51]
    v_add_f32 v35, v35, v39
    s_waitcnt vmcnt(12)
    v_mfma_f32_16x16x32_bf16 v[52:55], a[84:87], v[104:107], v[52:55]
    v_add_f32 v32, v32, v34
    s_waitcnt vmcnt(9)
    v_mfma_f32_16x16x32_bf16 v[48:51], a[88:91], v[108:111], v[48:51]
    v_add_f32 v33, v33, v35
    s_waitcnt vmcnt(8)
    v_mfma_f32_16x16x32_bf16 v[52:55], a[92:95], v[108:111], v[52:55]
    v_mul_f32 v14, 0x3b000000, v32
    v_mul_f32 v15, 0x3b000000, v33
    s_waitcnt vmcnt(7)
    v_mfma_f32_16x16x32_bf16 v[48:51], a[96:99], v[112:115], v[48:51]
    v_fma_f32 v15, -v14, v14, v15
    s_waitcnt vmcnt(6)
    v_mfma_f32_16x16x32_bf16 v[52:55], a[100:103], v[112:115], v[52:55]
    v_max_f32 v15, 0, v15
    s_waitcnt vmcnt(5)
    v_mfma_f32_16x16x32_bf16 v[48:51], a[104:107], v[116:119], v[48:51]
    v_cvt_pk_bf16_f32 v14, 0, v14
    s_waitcnt vmcnt(4)
    v_mfma_f32_16x16x32_bf16 v[52:55], a[108:111], v[116:119], v[52:55]
    v_cvt_pk_bf16_f32 v15, 0, v15
    v_add_f32 v15, 0x3727c5ac, v15
    s_waitcnt vmcnt(3)
    v_mfma_f32_16x16x32_bf16 v[48:51], a[112:115], v[120:123], v[48:51]
    v_cvt_pk_bf16_f32 v15, 0, v15
    s_waitcnt vmcnt(2)
    v_mfma_f32_16x16x32_bf16 v[52:55], a[116:119], v[120:123], v[52:55]
    v_sqrt_f32 v15, v15
    s_waitcnt vmcnt(1)
    v_mfma_f32_16x16x32_bf16 v[48:51], a[120:123], v[124:127], v[48:51]
    v_cvt_pk_bf16_f32 v15, 0, v15
    s_waitcnt vmcnt(0)
    v_mfma_f32_16x16x32_bf16 v[52:55], a[124:127], v[124:127], v[52:55]
TP2:
    s_cbranch_execz K1_end
    v_rcp_f32 v15, v15
    s_mov_b32 s50, 0xbdd2d3e8
    v_mov_b32 v19, 0xc0135761
    s_nop 1
    v_fma_f32 v48, -v14, v4, v48
    v_fma_f32 v49, -v14, v5, v49
    v_fma_f32 v50, -v14, v6, v50
    v_fma_f32 v51, -v14, v7, v51
    v_fma_f32 v52, -v14, v8, v52
    v_fma_f32 v53, -v14, v9, v53
    v_fma_f32 v54, -v14, v10, v54
    v_fma_f32 v55, -v14, v11, v55
    v_mul_f32 v48, v48, v15
    v_mul_f32 v49, v49, v15
    v_mul_f32 v50, v50, v15
    v_mul_f32 v51, v51, v15
    v_mul_f32 v52, v52, v15
    v_mul_f32 v53, v53, v15
    v_mul_f32 v54, v54, v15
    v_mul_f32 v55, v55, v15
    v_mul_f32 v32, v48, v48
    v_mul_f32 v33, v49, v49
    v_mul_f32 v34, v50, v50
    v_mul_f32 v35, v51, v51
    v_mul_f32 v36, v52, v52
    v_mul_f32 v37, v53, v53
    v_mul_f32 v38, v54, v54
    v_mul_f32 v39, v55, v55
    v_fma_f32 v32, v32, s50, v19
    v_fma_f32 v33, v33, s50, v19
    v_fma_f32 v34, v34, s50, v19
    v_fma_f32 v35, v35, s50, v19
    v_fma_f32 v36, v36, s50, v19
    v_fma_f32 v37, v37, s50, v19
    v_fma_f32 v38, v38, s50, v19
    v_fma_f32 v39, v39, s50, v19
    v_mul_f32 v32, v32, v48
    v_mul_f32 v33, v33, v49
    v_mul_f32 v34, v34, v50
    v_mul_f32 v35, v35, v51
    v_mul_f32 v36, v36, v52
    v_mul_f32 v37, v37, v53
    v_mul_f32 v38, v38, v54
    v_mul_f32 v39, v39, v55
    v_exp_f32 v32, v32
    v_exp_f32 v33, v33
    v_exp_f32 v34, v34
    v_exp_f32 v35, v35
    v_exp_f32 v36, v36
    v_exp_f32 v37, v37
    v_exp_f32 v38, v38
    v_exp_f32 v39, v39
    v_add_f32 v32, 1.0, v32
    v_add_f32 v33, 1.0, v33
    v_add_f32 v34, 1.0, v34
    v_add_f32 v35, 1.0, v35
    v_add_f32 v36, 1.0, v36
    v_add_f32 v37, 1.0, v37
    v_add_f32 v38, 1.0, v38
    v_add_f32 v39, 1.0, v39
    v_rcp_f32 v32, v32
    v_rcp_f32 v33, v33
    v_rcp_f32 v34, v34
    v_rcp_f32 v35, v35
    v_rcp_f32 v36, v36
    v_rcp_f32 v37, v37
    v_rcp_f32 v38, v38
    v_rcp_f32 v39, v39
    v_mul_f32 v48, v48, v32
    v_mul_f32 v49, v49, v33
    v_mul_f32 v50, v50, v34
    v_mul_f32 v51, v51, v35
    v_mul_f32 v52, v52, v36
    v_mul_f32 v53, v53, v37
    v_mul_f32 v54, v54, v38
    v_mul_f32 v55, v55, v39
    v_cvt_pk_bf16_f32 v20, v48, v49
    v_cvt_pk_bf16_f32 v21, v50, v51
    v_cvt_pk_bf16_f32 v22, v52, v53
    v_cvt_pk_bf16_f32 v23, v54, v55
    v_and_b32 v13, 1, v16
    v_lshl_add_u32 v13, v13, 5, v12
    v_add_u32 v13, s37, v13
    v_lshlrev_b32 v13, 4, v13
    v_lshrrev_b32 v17, 1, v16
    v_lshl_add_u32 v13, v17, 10, v13
    s_lshl_b32 s48, s45, 11
    s_add_u32 s48, s48, s40
    s_add_u32 s48, s48, 0x1800000
    buffer_store_dwordx4 v[20:23], v13, s[24:27], s48 offen sc0 sc1
    s_endpgm
K2_end:
    s_endpgm
.fill (45824 - (. - TBASE))/4, 4, 0xBF810000
.globl k3_kernel
.p2align 8
.type k3_kernel,@function
k3_kernel:
    s_cmp_ge_u32 s2, 256
    s_cbranch_scc1 K3_end
    s_load_dwordx2 s[12:13], s[0:1], 56
    s_load_dwordx2 s[24:25], s[0:1], 112
    v_and_b32 v1, 63, v0
    v_lshrrev_b32 v3, 6, v0
    v_lshlrev_b32 v2, 4, v1
    v_readfirstlane_b32 s34, v3
    s_and_b32 s35, s2, 7
    s_lshr_b32 s36, s2, 3
    s_lshl_b32 s35, s35, 2
    s_lshr_b32 s37, s36, 3
    s_add_u32 s35, s35, s37
    s_and_b32 s36, s36, 7
    s_and_b32 s38, s34, 1
    s_lshr_b32 s39, s34, 1
    s_lshl_b32 s40, s35, 1
    s_add_u32 s40, s40, s38
    s_mov_b32 s14, 524288
    s_mov_b32 s15, 0x00020000
    s_mov_b32 s26, 0x10000000
    s_mov_b32 s27, 0x00020000
    s_mov_b32 s18, 2097152
    s_mov_b32 s19, 0x00020000
    v_lshrrev_b32 v4, 3, v1
    v_and_b32 v5, 7, v1
    v_bfe_u32 v6, v1, 4, 1
    v_lshlrev_b32 v6, 2, v6
    v_xor_b32 v5, v5, v6
    v_lshlrev_b32 v5, 4, v5
    v_lshl_add_u32 v152, v4, 10, v5
    s_lshl_b32 s45, s34, 13
    s_lshl_b32 s46, s36, 7
    s_add_u32 s45, s45, s46
    s_lshl_b32 s46, s34, 10
    v_and_b32 v153, 31, v1
    s_lshl_b32 s47, s40, 5
    v_add_u32 v153, s47, v153
    v_and_b32 v8, 32, v1
    s_add_u32 s47, s39, 1
    v_subrev_u32 v9, s47, v153
    v_lshrrev_b32 v10, 5, v9
    v_lshlrev_b32 v10, 15, v10
    v_and_b32 v9, 31, v9
    v_add_u32 v9, v9, v8
    v_lshl_add_u32 v12, v9, 4, v10
    v_add_u32 v9, s47, v153
    v_lshrrev_b32 v10, 5, v9
    v_lshlrev_b32 v10, 15, v10
    v_and_b32 v9, 31, v9
    v_add_u32 v9, v9, v8
    v_lshl_add_u32 v13, v9, 4, v10
    s_lshl_b32 s51, s39, 14
    s_waitcnt lgkmcnt(0)
    s_add_u32 s16, s24, 0x1800000
    s_addc_u32 s17, s25, 0
    s_add_u32 m0, s46, 0
    s_add_u32 s47, s45, 0
    buffer_load_dwordx4 v152, s[12:15], s47 offen lds
    s_add_u32 m0, s46, 32768
    s_add_u32 s47, s45, 262144
    buffer_load_dwordx4 v152, s[12:15], s47 offen lds
    s_add_u32 m0, s46, 4096
    s_add_u32 s47, s45, 32768
    buffer_load_dwordx4 v152, s[12:15], s47 offen lds
    s_add_u32 m0, s46, 36864
    s_add_u32 s47, s45, 294912
    buffer_load_dwordx4 v152, s[12:15], s47 offen lds
    s_add_u32 s50, s51, 0
    buffer_load_dwordx4 v[88:91], v12, s[16:19], s50 offen offset:0
    buffer_load_dwordx4 v[92:95], v12, s[16:19], s50 offen offset:1024
    buffer_load_dwordx4 v[96:99], v12, s[16:19], s50 offen offset:2048
    buffer_load_dwordx4 v[100:103], v12, s[16:19], s50 offen offset:3072
    s_add_u32 m0, s46, 8192
    s_add_u32 s47, s45, 65536
    buffer_load_dwordx4 v152, s[12:15], s47 offen lds
    s_add_u32 m0, s46, 40960
    s_add_u32 s47, s45, 327680
    buffer_load_dwordx4 v152, s[12:15], s47 offen lds
    s_add_u32 m0, s46, 12288
    s_add_u32 s47, s45, 98304
    buffer_load_dwordx4 v152, s[12:15], s47 offen lds
    s_add_u32 m0, s46, 45056
    s_add_u32 s47, s45, 360448
    buffer_load_dwordx4 v152, s[12:15], s47 offen lds
    s_add_u32 s50, s51, 4096
    buffer_load_dwordx4 v[104:107], v12, s[16:19], s50 offen offset:0
    buffer_load_dwordx4 v[108:111], v12, s[16:19], s50 offen offset:1024
    buffer_load_dwordx4 v[112:115], v12, s[16:19], s50 offen offset:2048
    buffer_load_dwordx4 v[116:119], v12, s[16:19], s50 offen offset:3072
    s_lshl_b32 s48, s40, 15
    s_lshl_b32 s49, s36, 12
    s_add_u32 s48, s48, s49
    s_lshl_b32 s49, s39, 11
    s_add_u32 s48, s48, s49
    s_add_u32 s49, s48, 0x1600000
    v_lshrrev_b32 v10, 5, v1
    v_bfe_u32 v11, v1, 2, 2
    v_lshl_add_u32 v10, v10, 3, v11
    v_lshlrev_b32 v10, 7, v10
    v_bfe_u32 v11, v1, 4, 1
    v_lshl_add_u32 v10, v11, 5, v10
    v_and_b32 v11, 1, v1
    v_lshl_add_u32 v10, v11, 4, v10
    v_bfe_u32 v11, v1, 1, 1
    v_lshl_add_u32 v10, v11, 3, v10
    s_lshl_b32 s52, s39, 15
    v_add_u32 v10, s52, v10
    v_bfe_u32 v11, v1, 3, 1
    v_xor_b32 v11, s39, v11
    v_lshl_add_u32 v14, v11, 6, v10
    v_xor_b32 v15, 64, v14
    s_lshl_b32 s52, s34, 12
    v_add_u32 v154, s52, v2
    s_waitcnt vmcnt(12)
    s_barrier
    ds_read_b64_tr_b16 v[56:57], v14 offset:0
    ds_read_b64_tr_b16 v[58:59], v14 offset:512
    ds_read_b64_tr_b16 v[60:61], v15 offset:0
    ds_read_b64_tr_b16 v[62:63], v15 offset:512
    ds_read_b64_tr_b16 v[64:65], v14 offset:2048
    ds_read_b64_tr_b16 v[66:67], v14 offset:2560
    ds_read_b64_tr_b16 v[68:69], v15 offset:2048
    ds_read_b64_tr_b16 v[70:71], v15 offset:2560
    ds_read_b64_tr_b16 v[72:73], v14 offset:4096
    ds_read_b64_tr_b16 v[74:75], v14 offset:4608
    ds_read_b64_tr_b16 v[76:77], v15 offset:4096
    ds_read_b64_tr_b16 v[78:79], v15 offset:4608
    ds_read_b64_tr_b16 v[80:81], v14 offset:6144
    ds_read_b64_tr_b16 v[82:83], v14 offset:6656
    ds_read_b64_tr_b16 v[84:85], v15 offset:6144
    ds_read_b64_tr_b16 v[86:87], v15 offset:6656
    s_add_u32 m0, s46, 16384
    s_add_u32 s47, s45, 131072
    buffer_load_dwordx4 v152, s[12:15], s47 offen lds
    s_add_u32 m0, s46, 49152
    s_add_u32 s47, s45, 393216
    buffer_load_dwordx4 v152, s[12:15], s47 offen lds
    s_add_u32 m0, s46, 20480
    s_add_u32 s47, s45, 163840
    buffer_load_dwordx4 v152, s[12:15], s47 offen lds
    s_add_u32 m0, s46, 53248
    s_add_u32 s47, s45, 425984
    buffer_load_dwordx4 v152, s[12:15], s47 offen lds
    s_add_u32 s50, s51, 8192
    buffer_load_dwordx4 v[120:123], v13, s[16:19], s50 offen offset:0
    buffer_load_dwordx4 v[124:127], v13, s[16:19], s50 offen offset:1024
    buffer_load_dwordx4 v[128:131], v13, s[16:19], s50 offen offset:2048
    buffer_load_dwordx4 v[132:135], v13, s[16:19], s50 offen offset:3072
    s_waitcnt vmcnt(19) lgkmcnt(14)
    v_mfma_f32_32x32x16_bf16 v[24:39], v[56:59], v[88:91], 0
    s_waitcnt lgkmcnt(12)
    v_mfma_f32_32x32x16_bf16 v[40:55], v[60:63], v[88:91], 0
    s_waitcnt vmcnt(18) lgkmcnt(10)
    v_mfma_f32_32x32x16_bf16 v[24:39], v[64:67], v[92:95], v[24:39]
    s_waitcnt lgkmcnt(8)
    v_mfma_f32_32x32x16_bf16 v[40:55], v[68:71], v[92:95], v[40:55]
    s_waitcnt vmcnt(17) lgkmcnt(6)
    v_mfma_f32_32x32x16_bf16 v[24:39], v[72:75], v[96:99], v[24:39]
    s_waitcnt lgkmcnt(4)
    v_mfma_f32_32x32x16_bf16 v[40:55], v[76:79], v[96:99], v[40:55]
    s_waitcnt vmcnt(16) lgkmcnt(2)
    v_mfma_f32_32x32x16_bf16 v[24:39], v[80:83], v[100:103], v[24:39]
    s_waitcnt lgkmcnt(0)
    v_mfma_f32_32x32x16_bf16 v[40:55], v[84:87], v[100:103], v[40:55]
    s_waitcnt vmcnt(12)
    s_barrier
    ds_read_b64_tr_b16 v[56:57], v14 offset:8192
    ds_read_b64_tr_b16 v[58:59], v14 offset:8704
    ds_read_b64_tr_b16 v[60:61], v15 offset:8192
    ds_read_b64_tr_b16 v[62:63], v15 offset:8704
    ds_read_b64_tr_b16 v[64:65], v14 offset:10240
    ds_read_b64_tr_b16 v[66:67], v14 offset:10752
    ds_read_b64_tr_b16 v[68:69], v15 offset:10240
    ds_read_b64_tr_b16 v[70:71], v15 offset:10752
    ds_read_b64_tr_b16 v[72:73], v14 offset:12288
    ds_read_b64_tr_b16 v[74:75], v14 offset:12800
    ds_read_b64_tr_b16 v[76:77], v15 offset:12288
    ds_read_b64_tr_b16 v[78:79], v15 offset:12800
    ds_read_b64_tr_b16 v[80:81], v14 offset:14336
    ds_read_b64_tr_b16 v[82:83], v14 offset:14848
    ds_read_b64_tr_b16 v[84:85], v15 offset:14336
    ds_read_b64_tr_b16 v[86:87], v15 offset:14848
    s_add_u32 m0, s46, 24576
    s_add_u32 s47, s45, 196608
    buffer_load_dwordx4 v152, s[12:15], s47 offen lds
    s_add_u32 m0, s46, 57344
    s_add_u32 s47, s45, 458752
    buffer_load_dwordx4 v152, s[12:15], s47 offen lds
    s_add_u32 m0, s46, 28672
    s_add_u32 s47, s45, 229376
    buffer_load_dwordx4 v152, s[12:15], s47 offen lds
    s_add_u32 m0, s46, 61440
    s_add_u32 s47, s45, 491520
    buffer_load_dwordx4 v152, s[12:15], s47 offen lds
    s_add_u32 s50, s51, 12288
    buffer_load_dwordx4 v[136:139], v13, s[16:19], s50 offen offset:0
    buffer_load_dwordx4 v[140:143], v13, s[16:19], s50 offen offset:1024
    buffer_load_dwordx4 v[144:147], v13, s[16:19], s50 offen offset:2048
    buffer_load_dwordx4 v[148:151], v13, s[16:19], s50 offen offset:3072
    s_waitcnt vmcnt(19) lgkmcnt(14)
    v_mfma_f32_32x32x16_bf16 v[24:39], v[56:59], v[104:107], v[24:39]
    s_waitcnt lgkmcnt(12)
    v_mfma_f32_32x32x16_bf16 v[40:55], v[60:63], v[104:107], v[40:55]
    s_waitcnt vmcnt(18) lgkmcnt(10)
    v_mfma_f32_32x32x16_bf16 v[24:39], v[64:67], v[108:111], v[24:39]
    s_waitcnt lgkmcnt(8)
    v_mfma_f32_32x32x16_bf16 v[40:55], v[68:71], v[108:111], v[40:55]
    s_waitcnt vmcnt(17) lgkmcnt(6)
    v_mfma_f32_32x32x16_bf16 v[24:39], v[72:75], v[112:115], v[24:39]
    s_waitcnt lgkmcnt(4)
    v_mfma_f32_32x32x16_bf16 v[40:55], v[76:79], v[112:115], v[40:55]
    s_waitcnt vmcnt(16) lgkmcnt(2)
    v_mfma_f32_32x32x16_bf16 v[24:39], v[80:83], v[116:119], v[24:39]
    s_waitcnt lgkmcnt(0)
    v_mfma_f32_32x32x16_bf16 v[40:55], v[84:87], v[116:119], v[40:55]
    s_waitcnt vmcnt(12)
    s_barrier
    ds_read_b64_tr_b16 v[56:57], v14 offset:16384
    ds_read_b64_tr_b16 v[58:59], v14 offset:16896
    ds_read_b64_tr_b16 v[60:61], v15 offset:16384
    ds_read_b64_tr_b16 v[62:63], v15 offset:16896
    ds_read_b64_tr_b16 v[64:65], v14 offset:18432
    ds_read_b64_tr_b16 v[66:67], v14 offset:18944
    ds_read_b64_tr_b16 v[68:69], v15 offset:18432
    ds_read_b64_tr_b16 v[70:71], v15 offset:18944
    ds_read_b64_tr_b16 v[72:73], v14 offset:20480
    ds_read_b64_tr_b16 v[74:75], v14 offset:20992
    ds_read_b64_tr_b16 v[76:77], v15 offset:20480
    ds_read_b64_tr_b16 v[78:79], v15 offset:20992
    ds_read_b64_tr_b16 v[80:81], v14 offset:22528
    ds_read_b64_tr_b16 v[82:83], v14 offset:23040
    ds_read_b64_tr_b16 v[84:85], v15 offset:22528
    ds_read_b64_tr_b16 v[86:87], v15 offset:23040
    buffer_load_dwordx4 v[16:19], v2, s[24:27], s49 offen offset:0
    buffer_load_dwordx4 v[20:23], v2, s[24:27], s49 offen offset:1024
    s_waitcnt vmcnt(13) lgkmcnt(14)
    v_mfma_f32_32x32x16_bf16 v[24:39], v[56:59], v[120:123], v[24:39]
    s_waitcnt lgkmcnt(12)
    v_mfma_f32_32x32x16_bf16 v[40:55], v[60:63], v[120:123], v[40:55]
    s_waitcnt vmcnt(12) lgkmcnt(10)
    v_mfma_f32_32x32x16_bf16 v[24:39], v[64:67], v[124:127], v[24:39]
    s_waitcnt lgkmcnt(8)
    v_mfma_f32_32x32x16_bf16 v[40:55], v[68:71], v[124:127], v[40:55]
    s_waitcnt vmcnt(11) lgkmcnt(6)
    v_mfma_f32_32x32x16_bf16 v[24:39], v[72:75], v[128:131], v[24:39]
    s_waitcnt lgkmcnt(4)
    v_mfma_f32_32x32x16_bf16 v[40:55], v[76:79], v[128:131], v[40:55]
    s_waitcnt vmcnt(10) lgkmcnt(2)
    v_mfma_f32_32x32x16_bf16 v[24:39], v[80:83], v[132:135], v[24:39]
    s_waitcnt lgkmcnt(0)
    v_mfma_f32_32x32x16_bf16 v[40:55], v[84:87], v[132:135], v[40:55]
    s_waitcnt vmcnt(6)
    s_barrier
    ds_read_b64_tr_b16 v[56:57], v15 offset:24576
    ds_read_b64_tr_b16 v[58:59], v15 offset:25088
    ds_read_b64_tr_b16 v[60:61], v15 offset:26624
    ds_read_b64_tr_b16 v[62:63], v15 offset:27136
    ds_read_b64_tr_b16 v[64:65], v15 offset:28672
    ds_read_b64_tr_b16 v[66:67], v15 offset:29184
    ds_read_b64_tr_b16 v[68:69], v15 offset:30720
    ds_read_b64_tr_b16 v[70:71], v15 offset:31232
    ds_read_b64_tr_b16 v[72:73], v14 offset:24576
    ds_read_b64_tr_b16 v[74:75], v14 offset:25088
    ds_read_b64_tr_b16 v[76:77], v14 offset:26624
    ds_read_b64_tr_b16 v[78:79], v14 offset:27136
    ds_read_b64_tr_b16 v[80:81], v14 offset:28672
    ds_read_b64_tr_b16 v[82:83], v14 offset:29184
    ds_read_b64_tr_b16 v[84:85], v14 offset:30720
    ds_read_b64_tr_b16 v[86:87], v14 offset:31232
    s_waitcnt vmcnt(5) lgkmcnt(14)
    v_mfma_f32_32x32x16_bf16 v[40:55], v[56:59], v[136:139], v[40:55]
    s_waitcnt vmcnt(4) lgkmcnt(12)
    v_mfma_f32_32x32x16_bf16 v[40:55], v[60:63], v[140:143], v[40:55]
    s_waitcnt vmcnt(3) lgkmcnt(10)
    v_mfma_f32_32x32x16_bf16 v[40:55], v[64:67], v[144:147], v[40:55]
    s_waitcnt vmcnt(2) lgkmcnt(8)
    v_mfma_f32_32x32x16_bf16 v[40:55], v[68:71], v[148:151], v[40:55]
    s_waitcnt lgkmcnt(6)
    v_mfma_f32_32x32x16_bf16 v[24:39], v[72:75], v[136:139], v[24:39]
    s_waitcnt lgkmcnt(4)
    v_mfma_f32_32x32x16_bf16 v[24:39], v[76:79], v[140:143], v[24:39]
    s_waitcnt lgkmcnt(2)
    v_mfma_f32_32x32x16_bf16 v[24:39], v[80:83], v[144:147], v[24:39]
    s_nop 5
    ds_write_b128 v154, v[40:43] offset:0
    ds_write_b128 v154, v[44:47] offset:1024
    ds_write_b128 v154, v[48:51] offset:2048
    ds_write_b128 v154, v[52:55] offset:3072
    s_waitcnt lgkmcnt(4)
    v_mfma_f32_32x32x16_bf16 v[24:39], v[84:87], v[148:151], v[24:39]
    v_xor_b32 v154, 0x2000, v154
    s_mov_b32 s52, 0xffff0000
    s_waitcnt vmcnt(1)
    v_lshlrev_b32 v88, 16, v16
    v_and_b32 v89, s52, v16
    v_lshlrev_b32 v90, 16, v17
    v_and_b32 v91, s52, v17
    v_lshlrev_b32 v92, 16, v18
    v_and_b32 v93, s52, v18
    v_lshlrev_b32 v94, 16, v19
    v_and_b32 v95, s52, v19
    s_waitcnt vmcnt(0)
    v_lshlrev_b32 v96, 16, v20
    v_and_b32 v97, s52, v20
    v_lshlrev_b32 v98, 16, v21
    v_and_b32 v99, s52, v21
    v_lshlrev_b32 v100, 16, v22
    v_and_b32 v101, s52, v22
    v_lshlrev_b32 v102, 16, v23
    v_and_b32 v103, s52, v23
    s_waitcnt lgkmcnt(0)
    s_barrier
    ds_read_b128 v[40:43], v154 offset:0
    ds_read_b128 v[44:47], v154 offset:1024
    ds_read_b128 v[48:51], v154 offset:2048
    ds_read_b128 v[52:55], v154 offset:3072
    s_waitcnt lgkmcnt(3)
    v_add_f32 v24, v24, v40
    v_add_f32 v25, v25, v41
    v_add_f32 v26, v26, v42
    v_add_f32 v27, v27, v43
    s_waitcnt lgkmcnt(2)
    v_add_f32 v28, v28, v44
    v_add_f32 v29, v29, v45
    v_add_f32 v30, v30, v46
    v_add_f32 v31, v31, v47
    v_cvt_pk_bf16_f32 v24, 0, v24
    v_cvt_pk_bf16_f32 v25, 0, v25
    v_cvt_pk_bf16_f32 v26, 0, v26
    v_cvt_pk_bf16_f32 v27, 0, v27
    v_cvt_pk_bf16_f32 v28, 0, v28
    v_cvt_pk_bf16_f32 v29, 0, v29
    v_cvt_pk_bf16_f32 v30, 0, v30
    v_cvt_pk_bf16_f32 v31, 0, v31
    v_add_f32 v24, v24, v88
    v_add_f32 v25, v25, v89
    v_add_f32 v26, v26, v90
    v_add_f32 v27, v27, v91
    v_add_f32 v28, v28, v92
    v_add_f32 v29, v29, v93
    v_add_f32 v30, v30, v94
    v_add_f32 v31, v31, v95
    v_cvt_pk_bf16_f32 v16, v24, v25
    v_cvt_pk_bf16_f32 v17, v26, v27
    v_cvt_pk_bf16_f32 v18, v28, v29
    v_cvt_pk_bf16_f32 v19, v30, v31
    s_add_u32 s49, s48, 0x1a00000
    buffer_store_dwordx4 v[16:19], v2, s[24:27], s49 offen offset:0 sc0 sc1
    s_waitcnt lgkmcnt(1)
    v_add_f32 v32, v32, v48
    v_add_f32 v33, v33, v49
    v_add_f32 v34, v34, v50
    v_add_f32 v35, v35, v51
    s_waitcnt lgkmcnt(0)
    v_add_f32 v36, v36, v52
    v_add_f32 v37, v37, v53
    v_add_f32 v38, v38, v54
    v_add_f32 v39, v39, v55
    v_cvt_pk_bf16_f32 v32, 0, v32
    v_cvt_pk_bf16_f32 v33, 0, v33
    v_cvt_pk_bf16_f32 v34, 0, v34
    v_cvt_pk_bf16_f32 v35, 0, v35
    v_cvt_pk_bf16_f32 v36, 0, v36
    v_cvt_pk_bf16_f32 v37, 0, v37
    v_cvt_pk_bf16_f32 v38, 0, v38
    v_cvt_pk_bf16_f32 v39, 0, v39
    v_add_f32 v32, v32, v96
    v_add_f32 v33, v33, v97
    v_add_f32 v34, v34, v98
    v_add_f32 v35, v35, v99
    v_add_f32 v36, v36, v100
    v_add_f32 v37, v37, v101
    v_add_f32 v38, v38, v102
    v_add_f32 v39, v39, v103
    v_cvt_pk_bf16_f32 v20, v32, v33
    v_cvt_pk_bf16_f32 v21, v34, v35
    v_cvt_pk_bf16_f32 v22, v36, v37
    v_cvt_pk_bf16_f32 v23, v38, v39
    buffer_store_dwordx4 v[20:23], v2, s[24:27], s49 offen offset:1024 sc0 sc1
    s_mov_b32 s53, 0x3f803f80
    v_mov_b32 v4, 0
    v_mov_b32 v5, 0
    v_mov_b32 v6, 0
    v_mov_b32 v7, 0
    v_dot2_f32_bf16 v4, v16, s53, v4
    v_dot2_f32_bf16 v5, v16, v16, v5
    v_dot2_f32_bf16 v6, v17, s53, v6
    v_dot2_f32_bf16 v7, v17, v17, v7
    v_dot2_f32_bf16 v4, v18, s53, v4
    v_dot2_f32_bf16 v5, v18, v18, v5
    v_dot2_f32_bf16 v6, v19, s53, v6
    v_dot2_f32_bf16 v7, v19, v19, v7
    v_dot2_f32_bf16 v4, v20, s53, v4
    v_dot2_f32_bf16 v5, v20, v20, v5
    v_dot2_f32_bf16 v6, v21, s53, v6
    v_dot2_f32_bf16 v7, v21, v21, v7
    v_dot2_f32_bf16 v4, v22, s53, v4
    v_dot2_f32_bf16 v5, v22, v22, v5
    v_dot2_f32_bf16 v6, v23, s53, v6
    v_dot2_f32_bf16 v7, v23, v23, v7
    s_nop 1
    v_add_f32 v4, v4, v6
    v_add_f32 v5, v5, v7
    v_mov_b32 v6, v4
    v_mov_b32 v7, v5
    s_nop 0
    v_permlane32_swap_b32 v4, v6
    v_permlane32_swap_b32 v5, v7
    v_add_f32 v4, v4, v6
    v_add_f32 v5, v5, v7
    v_lshlrev_b32 v6, 3, v153
    s_lshl_b32 s49, s36, 15
    s_lshl_b32 s50, s39, 14
    s_add_u32 s49, s49, s50
    s_add_u32 s49, s49, 0x1c00000
    s_mov_b32 exec_hi, 0
    buffer_store_dwordx2 v[4:5], v6, s[24:27], s49 offen sc0 sc1
K3_end:
    s_endpgm
.fill (48640 - (. - TBASE))/4, 4, 0xBF810000
.globl k4_kernel
.p2align 8
.type k4_kernel,@function
k4_kernel:
    s_cmp_ge_u32 s2, 224
    s_cbranch_scc1 K4_end
    s_load_dwordx2 s[12:13], s[0:1], 64
    s_load_dwordx2 s[24:25], s[0:1], 112
    s_load_dwordx2 s[56:57], s[0:1], 72
    v_and_b32 v1, 63, v0
    v_lshrrev_b32 v3, 6, v0
    v_lshlrev_b32 v2, 4, v1
    v_readfirstlane_b32 s55, v3
    s_and_b32 s35, s2, 7
    s_lshr_b32 s36, s2, 3
    s_mul_i32 s37, s36, 37
    s_lshr_b32 s37, s37, 8
    s_mul_i32 s38, s37, 7
    s_sub_u32 s36, s36, s38
    s_and_b32 s38, s35, 1
    s_mul_i32 s38, s38, 7
    s_add_u32 s36, s36, s38
    s_lshr_b32 s35, s35, 1
    s_lshl_b32 s35, s35, 2
    s_add_u32 s35, s35, s37
    s_and_b32 s34, s55, 3
    s_lshl_b32 s40, s35, 2
    s_add_u32 s40, s40, s34
    s_mov_b32 s14, 1835008
    s_mov_b32 s15, 0x00020000
    s_mov_b32 s26, 0x10000000
    s_mov_b32 s27, 0x00020000
    s_lshl_b32 s49, s40, 15
    s_add_u32 s49, s49, 0x1a00000
    v_lshrrev_b32 v4, 3, v1
    v_and_b32 v5, 7, v1
    v_bfe_u32 v6, v1, 4, 1
    v_lshlrev_b32 v6, 2, v6
    v_xor_b32 v5, v5, v6
    v_lshlrev_b32 v5, 4, v5
    v_mul_u32_u24 v4, 3584, v4
    v_add_u32 v12, v5, v4
    s_mul_i32 s45, s34, 28672
    s_lshl_b32 s46, s36, 8
    s_add_u32 s45, s45, s46
    s_lshl_b32 s46, s34, 10
    v_and_b32 v4, 31, v1
    v_lshrrev_b32 v7, 5, v1
    v_lshlrev_b32 v7, 14, v7
    v_lshl_add_u32 v7, v4, 3, v7
    s_lshl_b32 s50, s40, 8
    s_add_u32 s50, s50, 0x1c00000
    s_cmp_lt_u32 s55, 4
    s_waitcnt lgkmcnt(0)
    s_cbranch_scc1 K4_c1
    s_setprio 3
    s_add_u32 m0, s46, 0
    s_add_u32 s48, s45, 0
    buffer_load_dwordx4 v12, s[12:15], s48 offen lds
    s_add_u32 m0, s46, 4096
    s_add_u32 s48, s45, 114688
    buffer_load_dwordx4 v12, s[12:15], s48 offen lds
    s_add_u32 m0, s46, 8192
    s_add_u32 s48, s45, 229376
    buffer_load_dwordx4 v12, s[12:15], s48 offen lds
    s_add_u32 m0, s46, 12288
    s_add_u32 s48, s45, 344064
    buffer_load_dwordx4 v12, s[12:15], s48 offen lds
    s_add_u32 m0, s46, 16384
    s_add_u32 s48, s45, 458752
    buffer_load_dwordx4 v12, s[12:15], s48 offen lds
    s_add_u32 m0, s46, 20480
    s_add_u32 s48, s45, 573440
    buffer_load_dwordx4 v12, s[12:15], s48 offen lds
    s_add_u32 m0, s46, 24576
    s_add_u32 s48, s45, 688128
    buffer_load_dwordx4 v12, s[12:15], s48 offen lds
    s_add_u32 m0, s46, 28672
    s_add_u32 s48, s45, 802816
    buffer_load_dwordx4 v12, s[12:15], s48 offen lds
    s_setprio 0
    s_branch K4_help
K4_c1:
    buffer_load_dwordx4 a[0:3], v2, s[24:27], s49 offen offset:0
    buffer_load_dwordx4 a[4:7], v2, s[24:27], s49 offen offset:1024
    buffer_load_dwordx4 a[8:11], v2, s[24:27], s49 offen offset:2048
    buffer_load_dwordx4 a[12:15], v2, s[24:27], s49 offen offset:3072
    s_add_u32 s49, s49, 4096
    buffer_load_dwordx4 a[16:19], v2, s[24:27], s49 offen offset:0
    buffer_load_dwordx4 a[20:23], v2, s[24:27], s49 offen offset:1024
    buffer_load_dwordx4 a[24:27], v2, s[24:27], s49 offen offset:2048
    buffer_load_dwordx4 a[28:31], v2, s[24:27], s49 offen offset:3072
    v_lshrrev_b32 v10, 5, v1
    v_bfe_u32 v11, v1, 2, 2
    v_lshl_add_u32 v10, v10, 3, v11
    v_lshlrev_b32 v10, 7, v10
    v_bfe_u32 v9, v1, 4, 1
    v_lshl_add_u32 v10, v9, 5, v10
    v_and_b32 v9, 1, v1
    v_lshl_add_u32 v10, v9, 4, v10
TP3:
    s_cbranch_execz K1_end
    v_bfe_u32 v9, v1, 1, 1
    v_lshl_add_u32 v10, v9, 3, v10
    v_bfe_u32 v11, v1, 3, 1
    v_lshl_add_u32 v12, v11, 6, v10
    v_xor_b32 v11, 1, v11
    v_lshl_add_u32 v13, v11, 6, v10
    v_and_b32 v4, 31, v1
    s_lshl_b32 s41, s34, 9
    s_add_u32 s41, s41, 131584
    v_lshl_add_u32 v22, v4, 4, s41
    v_lshrrev_b32 v20, 5, v1
    v_lshlrev_b32 v20, 5, v20
    v_add_u32 v20, 131072, v20
    s_lshl_b32 s41, s34, 13
    v_add_u32 v21, s41, v2
    s_mul_i32 s53, s40, 114688
    s_lshl_b32 s54, s36, 13
    s_add_u32 s53, s53, s54
    s_add_u32 s53, s53, 0x2000000
    v_add_u32 v20, 256, v20
    s_add_u32 s53, s53, 4096
    s_add_u32 s49, s49, 4096
    buffer_load_dwordx4 a[32:35], v2, s[24:27], s49 offen offset:0
    buffer_load_dwordx4 a[36:39], v2, s[24:27], s49 offen offset:1024
    buffer_load_dwordx4 a[40:43], v2, s[24:27], s49 offen offset:2048
    buffer_load_dwordx4 a[44:47], v2, s[24:27], s49 offen offset:3072
    s_add_u32 s49, s49, 4096
    buffer_load_dwordx4 a[48:51], v2, s[24:27], s49 offen offset:0
    buffer_load_dwordx4 a[52:55], v2, s[24:27], s49 offen offset:1024
    buffer_load_dwordx4 a[56:59], v2, s[24:27], s49 offen offset:2048
    buffer_load_dwordx4 a[60:63], v2, s[24:27], s49 offen offset:3072
    s_mov_b32 s44, 0
    s_setprio 2
K4_pass:
    s_barrier
    ds_read_b64_tr_b16 v[40:41], v12 offset:0
    ds_read_b64_tr_b16 v[42:43], v12 offset:512
    ds_read_b64_tr_b16 v[44:45], v13 offset:0
    ds_read_b64_tr_b16 v[46:47], v13 offset:512
    ds_read_b64_tr_b16 v[48:49], v12 offset:2048
    ds_read_b64_tr_b16 v[50:51], v12 offset:2560
    ds_read_b64_tr_b16 v[52:53], v13 offset:2048
    ds_read_b64_tr_b16 v[54:55], v13 offset:2560
    s_cmp_eq_u32 s44, 1
    s_cbranch_scc1 K4_nl0
    s_add_u32 s49, s49, 4096
    buffer_load_dwordx4 a[64:67], v2, s[24:27], s49 offen offset:0
    buffer_load_dwordx4 a[68:71], v2, s[24:27], s49 offen offset:1024
    buffer_load_dwordx4 a[72:75], v2, s[24:27], s49 offen offset:2048
    buffer_load_dwordx4 a[76:79], v2, s[24:27], s49 offen offset:3072
    s_add_u32 s49, s49, 4096
    buffer_load_dwordx4 a[80:83], v2, s[24:27], s49 offen offset:0
    buffer_load_dwordx4 a[84:87], v2, s[24:27], s49 offen offset:1024
    buffer_load_dwordx4 a[88:91], v2, s[24:27], s49 offen offset:2048
    buffer_load_dwordx4 a[92:95], v2, s[24:27], s49 offen offset:3072
    s_add_u32 s49, s49, 4096
    buffer_load_dwordx4 a[96:99], v2, s[24:27], s49 offen offset:0
    buffer_load_dwordx4 a[100:103], v2, s[24:27], s49 offen offset:1024
    buffer_load_dwordx4 a[104:107], v2, s[24:27], s49 offen offset:2048
    buffer_load_dwordx4 a[108:111], v2, s[24:27], s49 offen offset:3072
    s_add_u32 s49, s49, 4096
    buffer_load_dwordx4 a[112:115], v2, s[24:27], s49 offen offset:0
    buffer_load_dwordx4 a[116:119], v2, s[24:27], s49 offen offset:1024
    buffer_load_dwordx4 a[120:123], v2, s[24:27], s49 offen offset:2048
    buffer_load_dwordx4 a[124:127], v2, s[24:27], s49 offen offset:3072
K4_nl0:
    s_waitcnt vmcnt(31) lgkmcnt(6)
    v_mfma_f32_32x32x16_bf16 v[64:79], v[40:43], a[0:3], 0
    ds_read_b64_tr_b16 v[56:57], v12 offset:4096
    ds_read_b64_tr_b16 v[58:59], v12 offset:4608
    s_waitcnt lgkmcnt(6)
    v_mfma_f32_32x32x16_bf16 v[80:95], v[44:47], a[0:3], 0
    ds_read_b64_tr_b16 v[60:61], v13 offset:4096
    ds_read_b64_tr_b16 v[62:63], v13 offset:4608
    s_waitcnt vmcnt(30) lgkmcnt(6)
    v_mfma_f32_32x32x16_bf16 v[64:79], v[48:51], a[4:7], v[64:79]
    ds_read_b64_tr_b16 v[40:41], v12 offset:6144
    ds_read_b64_tr_b16 v[42:43], v12 offset:6656
    s_waitcnt lgkmcnt(6)
    v_mfma_f32_32x32x16_bf16 v[80:95], v[52:55], a[4:7], v[80:95]
    ds_read_b64_tr_b16 v[44:45], v13 offset:6144
    ds_read_b64_tr_b16 v[46:47], v13 offset:6656
    s_waitcnt vmcnt(29) lgkmcnt(6)
    v_mfma_f32_32x32x16_bf16 v[64:79], v[56:59], a[8:11], v[64:79]
    ds_read_b64_tr_b16 v[48:49], v12 offset:8192
    ds_read_b64_tr_b16 v[50:51], v12 offset:8704
    s_waitcnt lgkmcnt(6)
    v_mfma_f32_32x32x16_bf16 v[80:95], v[60:63], a[8:11], v[80:95]
    ds_read_b64_tr_b16 v[52:53], v13 offset:8192
    ds_read_b64_tr_b16 v[54:55], v13 offset:8704
    s_waitcnt vmcnt(28) lgkmcnt(6)
    v_mfma_f32_32x32x16_bf16 v[64:79], v[40:43], a[12:15], v[64:79]
    ds_read_b64_tr_b16 v[56:57], v12 offset:10240
    ds_read_b64_tr_b16 v[58:59], v12 offset:10752
    s_waitcnt lgkmcnt(6)
    v_mfma_f32_32x32x16_bf16 v[80:95], v[44:47], a[12:15], v[80:95]
    ds_read_b64_tr_b16 v[60:61], v13 offset:10240
    ds_read_b64_tr_b16 v[62:63], v13 offset:10752
    s_waitcnt vmcnt(27) lgkmcnt(6)
    v_mfma_f32_32x32x16_bf16 v[64:79], v[48:51], a[16:19], v[64:79]
    ds_read_b64_tr_b16 v[40:41], v12 offset:12288
    ds_read_b64_tr_b16 v[42:43], v12 offset:12800
    s_waitcnt lgkmcnt(6)
    v_mfma_f32_32x32x16_bf16 v[80:95], v[52:55], a[16:19], v[80:95]
    ds_read_b64_tr_b16 v[44:45], v13 offset:12288
    ds_read_b64_tr_b16 v[46:47], v13 offset:12800
    s_waitcnt vmcnt(26) lgkmcnt(6)
    v_mfma_f32_32x32x16_bf16 v[64:79], v[56:59], a[20:23], v[64:79]
    ds_read_b64_tr_b16 v[48:49], v12 offset:14336
    ds_read_b64_tr_b16 v[50:51], v12 offset:14848
    s_waitcnt lgkmcnt(6)
    v_mfma_f32_32x32x16_bf16 v[80:95], v[60:63], a[20:23], v[80:95]
    ds_read_b64_tr_b16 v[52:53], v13 offset:14336
    ds_read_b64_tr_b16 v[54:55], v13 offset:14848
    s_waitcnt vmcnt(25) lgkmcnt(6)
    v_mfma_f32_32x32x16_bf16 v[64:79], v[40:43], a[24:27], v[64:79]
    s_waitcnt lgkmcnt(4)
    v_mfma_f32_32x32x16_bf16 v[80:95], v[44:47], a[24:27], v[80:95]
    s_waitcnt vmcnt(24) lgkmcnt(2)
    v_mfma_f32_32x32x16_bf16 v[64:79], v[48:51], a[28:31], v[64:79]
    s_waitcnt lgkmcnt(0)
    v_mfma_f32_32x32x16_bf16 v[80:95], v[52:55], a[28:31], v[80:95]
    s_barrier
    ds_read_b64_tr_b16 v[40:41], v12 offset:16384
    ds_read_b64_tr_b16 v[42:43], v12 offset:16896
    ds_read_b64_tr_b16 v[44:45], v13 offset:16384
    ds_read_b64_tr_b16 v[46:47], v13 offset:16896
    ds_read_b64_tr_b16 v[48:49], v12 offset:18432
    ds_read_b64_tr_b16 v[50:51], v12 offset:18944
    ds_read_b64_tr_b16 v[52:53], v13 offset:18432
    ds_read_b64_tr_b16 v[54:55], v13 offset:18944
    s_waitcnt vmcnt(23) lgkmcnt(6)
    v_mfma_f32_32x32x16_bf16 v[64:79], v[40:43], a[32:35], v[64:79]
    ds_read_b64_tr_b16 v[56:57], v12 offset:20480
    ds_read_b64_tr_b16 v[58:59], v12 offset:20992
    s_waitcnt lgkmcnt(6)
    v_mfma_f32_32x32x16_bf16 v[80:95], v[44:47], a[32:35], v[80:95]
    ds_read_b64_tr_b16 v[60:61], v13 offset:20480
    ds_read_b64_tr_b16 v[62:63], v13 offset:20992
    s_waitcnt vmcnt(22) lgkmcnt(6)
    v_mfma_f32_32x32x16_bf16 v[64:79], v[48:51], a[36:39], v[64:79]
    ds_read_b64_tr_b16 v[40:41], v12 offset:22528
    ds_read_b64_tr_b16 v[42:43], v12 offset:23040
    s_waitcnt lgkmcnt(6)
    v_mfma_f32_32x32x16_bf16 v[80:95], v[52:55], a[36:39], v[80:95]
    ds_read_b64_tr_b16 v[44:45], v13 offset:22528
    ds_read_b64_tr_b16 v[46:47], v13 offset:23040
    s_waitcnt vmcnt(21) lgkmcnt(6)
    v_mfma_f32_32x32x16_bf16 v[64:79], v[56:59], a[40:43], v[64:79]
    ds_read_b64_tr_b16 v[48:49], v12 offset:24576
    ds_read_b64_tr_b16 v[50:51], v12 offset:25088
    s_waitcnt lgkmcnt(6)
    v_mfma_f32_32x32x16_bf16 v[80:95], v[60:63], a[40:43], v[80:95]
    ds_read_b64_tr_b16 v[52:53], v13 offset:24576
    ds_read_b64_tr_b16 v[54:55], v13 offset:25088
    s_waitcnt vmcnt(20) lgkmcnt(6)
    v_mfma_f32_32x32x16_bf16 v[64:79], v[40:43], a[44:47], v[64:79]
    ds_read_b64_tr_b16 v[56:57], v12 offset:26624
    ds_read_b64_tr_b16 v[58:59], v12 offset:27136
    s_waitcnt lgkmcnt(6)
    v_mfma_f32_32x32x16_bf16 v[80:95], v[44:47], a[44:47], v[80:95]
    ds_read_b64_tr_b16 v[60:61], v13 offset:26624
    ds_read_b64_tr_b16 v[62:63], v13 offset:27136
    s_waitcnt vmcnt(19) lgkmcnt(6)
    v_mfma_f32_32x32x16_bf16 v[64:79], v[48:51], a[48:51], v[64:79]
    ds_read_b64_tr_b16 v[40:41], v12 offset:28672
    ds_read_b64_tr_b16 v[42:43], v12 offset:29184
    s_waitcnt lgkmcnt(6)
    v_mfma_f32_32x32x16_bf16 v[80:95], v[52:55], a[48:51], v[80:95]
    ds_read_b64_tr_b16 v[44:45], v13 offset:28672
    ds_read_b64_tr_b16 v[46:47], v13 offset:29184
    s_waitcnt vmcnt(18) lgkmcnt(6)
    v_mfma_f32_32x32x16_bf16 v[64:79], v[56:59], a[52:55], v[64:79]
    ds_read_b64_tr_b16 v[48:49], v12 offset:30720
    ds_read_b64_tr_b16 v[50:51], v12 offset:31232
    s_waitcnt lgkmcnt(6)
    v_mfma_f32_32x32x16_bf16 v[80:95], v[60:63], a[52:55], v[80:95]
    ds_read_b64_tr_b16 v[52:53], v13 offset:30720
    ds_read_b64_tr_b16 v[54:55], v13 offset:31232
    s_waitcnt vmcnt(17) lgkmcnt(6)
    v_mfma_f32_32x32x16_bf16 v[64:79], v[40:43], a[56:59], v[64:79]
    s_waitcnt lgkmcnt(4)
    v_mfma_f32_32x32x16_bf16 v[80:95], v[44:47], a[56:59], v[80:95]
    s_waitcnt vmcnt(16) lgkmcnt(2)
    v_mfma_f32_32x32x16_bf16 v[64:79], v[48:51], a[60:63], v[64:79]
    s_waitcnt lgkmcnt(0)
    v_mfma_f32_32x32x16_bf16 v[80:95], v[52:55], a[60:63], v[80:95]
    s_cmp_eq_u32 s44, 1
    s_cbranch_scc1 K4_nb2
    s_barrier
K4_nb2:
    ds_read_b64_tr_b16 v[40:41], v12 offset:32768
    ds_read_b64_tr_b16 v[42:43], v12 offset:33280
    ds_read_b64_tr_b16 v[44:45], v13 offset:32768
    ds_read_b64_tr_b16 v[46:47], v13 offset:33280
    ds_read_b64_tr_b16 v[48:49], v12 offset:34816
    ds_read_b64_tr_b16 v[50:51], v12 offset:35328
    ds_read_b64_tr_b16 v[52:53], v13 offset:34816
    ds_read_b64_tr_b16 v[54:55], v13 offset:35328
    s_waitcnt vmcnt(15) lgkmcnt(6)
    v_mfma_f32_32x32x16_bf16 v[64:79], v[40:43], a[64:67], v[64:79]
    ds_read_b64_tr_b16 v[56:57], v12 offset:36864
    ds_read_b64_tr_b16 v[58:59], v12 offset:37376
    s_waitcnt lgkmcnt(6)
    v_mfma_f32_32x32x16_bf16 v[80:95], v[44:47], a[64:67], v[80:95]
    ds_read_b64_tr_b16 v[60:61], v13 offset:36864
    ds_read_b64_tr_b16 v[62:63], v13 offset:37376
    s_waitcnt vmcnt(14) lgkmcnt(6)
    v_mfma_f32_32x32x16_bf16 v[64:79], v[48:51], a[68:71], v[64:79]
    ds_read_b64_tr_b16 v[40:41], v12 offset:38912
    ds_read_b64_tr_b16 v[42:43], v12 offset:39424
    s_waitcnt lgkmcnt(6)
    v_mfma_f32_32x32x16_bf16 v[80:95], v[52:55], a[68:71], v[80:95]
    ds_read_b64_tr_b16 v[44:45], v13 offset:38912
    ds_read_b64_tr_b16 v[46:47], v13 offset:39424
    s_waitcnt vmcnt(13) lgkmcnt(6)
    v_mfma_f32_32x32x16_bf16 v[64:79], v[56:59], a[72:75], v[64:79]
    ds_read_b64_tr_b16 v[48:49], v12 offset:40960
    ds_read_b64_tr_b16 v[50:51], v12 offset:41472
    s_waitcnt lgkmcnt(6)
    v_mfma_f32_32x32x16_bf16 v[80:95], v[60:63], a[72:75], v[80:95]
    ds_read_b64_tr_b16 v[52:53], v13 offset:40960
    ds_read_b64_tr_b16 v[54:55], v13 offset:41472
    s_waitcnt vmcnt(12) lgkmcnt(6)
    v_mfma_f32_32x32x16_bf16 v[64:79], v[40:43], a[76:79], v[64:79]
    ds_read_b64_tr_b16 v[56:57], v12 offset:43008
    ds_read_b64_tr_b16 v[58:59], v12 offset:43520
    s_waitcnt lgkmcnt(6)
    v_mfma_f32_32x32x16_bf16 v[80:95], v[44:47], a[76:79], v[80:95]
    ds_read_b64_tr_b16 v[60:61], v13 offset:43008
    ds_read_b64_tr_b16 v[62:63], v13 offset:43520
    s_waitcnt vmcnt(11) lgkmcnt(6)
    v_mfma_f32_32x32x16_bf16 v[64:79], v[48:51], a[80:83], v[64:79]
    ds_read_b64_tr_b16 v[40:41], v12 offset:45056
    ds_read_b64_tr_b16 v[42:43], v12 offset:45568
    s_waitcnt lgkmcnt(6)
    v_mfma_f32_32x32x16_bf16 v[80:95], v[52:55], a[80:83], v[80:95]
    ds_read_b64_tr_b16 v[44:45], v13 offset:45056
    ds_read_b64_tr_b16 v[46:47], v13 offset:45568
    s_waitcnt vmcnt(10) lgkmcnt(6)
    v_mfma_f32_32x32x16_bf16 v[64:79], v[56:59], a[84:87], v[64:79]
    ds_read_b64_tr_b16 v[48:49], v12 offset:47104
    ds_read_b64_tr_b16 v[50:51], v12 offset:47616
    s_waitcnt lgkmcnt(6)
    v_mfma_f32_32x32x16_bf16 v[80:95], v[60:63], a[84:87], v[80:95]
    ds_read_b64_tr_b16 v[52:53], v13 offset:47104
    ds_read_b64_tr_b16 v[54:55], v13 offset:47616
    s_waitcnt vmcnt(9) lgkmcnt(6)
    v_mfma_f32_32x32x16_bf16 v[64:79], v[40:43], a[88:91], v[64:79]
    s_waitcnt lgkmcnt(4)
    v_mfma_f32_32x32x16_bf16 v[80:95], v[44:47], a[88:91], v[80:95]
    s_waitcnt vmcnt(8) lgkmcnt(2)
    v_mfma_f32_32x32x16_bf16 v[64:79], v[48:51], a[92:95], v[64:79]
    s_waitcnt lgkmcnt(0)
    v_mfma_f32_32x32x16_bf16 v[80:95], v[52:55], a[92:95], v[80:95]
    s_cmp_eq_u32 s44, 1
    s_cbranch_scc1 K4_nb3
    s_barrier
K4_nb3:
    ds_read_b64_tr_b16 v[40:41], v12 offset:49152
    ds_read_b64_tr_b16 v[42:43], v12 offset:49664
    ds_read_b64_tr_b16 v[44:45], v13 offset:49152
    ds_read_b64_tr_b16 v[46:47], v13 offset:49664
    ds_read_b64_tr_b16 v[48:49], v12 offset:51200
    ds_read_b64_tr_b16 v[50:51], v12 offset:51712
    ds_read_b64_tr_b16 v[52:53], v13 offset:51200
    ds_read_b64_tr_b16 v[54:55], v13 offset:51712
    s_waitcnt vmcnt(7) lgkmcnt(6)
    v_mfma_f32_32x32x16_bf16 v[64:79], v[40:43], a[96:99], v[64:79]
    ds_read_b64_tr_b16 v[56:57], v12 offset:53248
    ds_read_b64_tr_b16 v[58:59], v12 offset:53760
    s_waitcnt lgkmcnt(6)
    v_mfma_f32_32x32x16_bf16 v[80:95], v[44:47], a[96:99], v[80:95]
    ds_read_b64_tr_b16 v[60:61], v13 offset:53248
    ds_read_b64_tr_b16 v[62:63], v13 offset:53760
    s_waitcnt vmcnt(6) lgkmcnt(6)
    v_mfma_f32_32x32x16_bf16 v[64:79], v[48:51], a[100:103], v[64:79]
    ds_read_b64_tr_b16 v[40:41], v12 offset:55296
    ds_read_b64_tr_b16 v[42:43], v12 offset:55808
    s_waitcnt lgkmcnt(6)
    v_mfma_f32_32x32x16_bf16 v[80:95], v[52:55], a[100:103], v[80:95]
    ds_read_b64_tr_b16 v[44:45], v13 offset:55296
    ds_read_b64_tr_b16 v[46:47], v13 offset:55808
    s_waitcnt vmcnt(5) lgkmcnt(6)
    v_mfma_f32_32x32x16_bf16 v[64:79], v[56:59], a[104:107], v[64:79]
    ds_read_b64_tr_b16 v[48:49], v13 offset:57344
    ds_read_b64_tr_b16 v[50:51], v13 offset:57856
    s_waitcnt lgkmcnt(6)
    v_mfma_f32_32x32x16_bf16 v[80:95], v[60:63], a[104:107], v[80:95]
    ds_read_b64_tr_b16 v[52:53], v13 offset:59392
    ds_read_b64_tr_b16 v[54:55], v13 offset:59904
    s_waitcnt vmcnt(4) lgkmcnt(6)
    v_mfma_f32_32x32x16_bf16 v[64:79], v[40:43], a[108:111], v[64:79]
    ds_read_b64_tr_b16 v[56:57], v13 offset:61440
    ds_read_b64_tr_b16 v[58:59], v13 offset:61952
    s_waitcnt lgkmcnt(6)
    v_mfma_f32_32x32x16_bf16 v[80:95], v[44:47], a[108:111], v[80:95]
    ds_read_b64_tr_b16 v[60:61], v13 offset:63488
    ds_read_b64_tr_b16 v[62:63], v13 offset:64000
    s_waitcnt vmcnt(3) lgkmcnt(6)
    v_mfma_f32_32x32x16_bf16 v[80:95], v[48:51], a[112:115], v[80:95]
    ds_read_b64_tr_b16 v[40:41], v12 offset:57344
    ds_read_b64_tr_b16 v[42:43], v12 offset:57856
    s_waitcnt vmcnt(2) lgkmcnt(6)
    v_mfma_f32_32x32x16_bf16 v[80:95], v[52:55], a[116:119], v[80:95]
    ds_read_b64_tr_b16 v[44:45], v12 offset:59392
    ds_read_b64_tr_b16 v[46:47], v12 offset:59904
    s_waitcnt vmcnt(1) lgkmcnt(6)
    v_mfma_f32_32x32x16_bf16 v[80:95], v[56:59], a[120:123], v[80:95]
    ds_read_b64_tr_b16 v[48:49], v12 offset:61440
    ds_read_b64_tr_b16 v[50:51], v12 offset:61952
    s_waitcnt vmcnt(0) lgkmcnt(6)
    v_mfma_f32_32x32x16_bf16 v[80:95], v[60:63], a[124:127], v[80:95]
    ds_read_b64_tr_b16 v[52:53], v12 offset:63488
    ds_read_b64_tr_b16 v[54:55], v12 offset:64000
    s_waitcnt lgkmcnt(6)
    v_mfma_f32_32x32x16_bf16 v[64:79], v[40:43], a[112:115], v[64:79]
    s_waitcnt lgkmcnt(4)
    v_mfma_f32_32x32x16_bf16 v[64:79], v[44:47], a[116:119], v[64:79]
    s_waitcnt lgkmcnt(2)
    v_mfma_f32_32x32x16_bf16 v[64:79], v[48:51], a[120:123], v[64:79]
    s_nop 3
    ds_write_b128 v21, v[80:83] offset:4096
    ds_write_b128 v21, v[84:87] offset:5120
    ds_write_b128 v21, v[88:91] offset:6144
    ds_write_b128 v21, v[92:95] offset:7168
    s_waitcnt lgkmcnt(4)
    v_mfma_f32_32x32x16_bf16 v[64:79], v[52:55], a[124:127], v[64:79]
    s_cmp_eq_u32 s44, 1
    s_cbranch_scc1 K4_done
    s_nop 9
    ds_write_b128 v21, v[64:67] offset:0
    ds_write_b128 v21, v[68:71] offset:1024
    ds_write_b128 v21, v[72:75] offset:2048
    ds_write_b128 v21, v[76:79] offset:3072
    v_add_u32 v12, 65536, v12
    v_add_u32 v13, 65536, v13
    s_mov_b32 s44, 1
    s_waitcnt lgkmcnt(0)
    s_branch K4_pass
K4_done:
    ds_read_b128 v[16:19], v22
    s_setprio 0
    s_waitcnt lgkmcnt(0)
    s_barrier
    s_nop 7
    s_call_b64 s[62:63], K4_epk
    s_endpgm
K4_epi:
    ds_read_b128 v[32:35], v20 offset:0
    ds_read_b128 v[36:39], v20 offset:16
    s_waitcnt lgkmcnt(1)
    s_nop 8
    v_fma_f32 v64, -v16, v32, v64
    v_fma_f32 v65, -v16, v33, v65
    v_fma_f32 v66, -v16, v34, v66
    v_fma_f32 v67, -v16, v35, v67
    s_waitcnt lgkmcnt(0)
    v_fma_f32 v68, -v16, v36, v68
    v_fma_f32 v69, -v16, v37, v69
    v_fma_f32 v70, -v16, v38, v70
    v_fma_f32 v71, -v16, v39, v71
    v_mul_f32 v4, v64, v64
    v_mul_f32 v5, v65, v65
    v_mul_f32 v6, v66, v66
    v_mul_f32 v7, v67, v67
    v_mul_f32 v8, v68, v68
    v_mul_f32 v9, v69, v69
    v_mul_f32 v10, v70, v70
    v_mul_f32 v11, v71, v71
    v_fma_f32 v4, v4, v18, v17
    v_fma_f32 v5, v5, v18, v17
    v_fma_f32 v6, v6, v18, v17
    v_fma_f32 v7, v7, v18, v17
    v_fma_f32 v8, v8, v18, v17
    v_fma_f32 v9, v9, v18, v17
    v_fma_f32 v10, v10, v18, v17
    v_fma_f32 v11, v11, v18, v17
    v_mul_f32 v4, v4, v64
    v_mul_f32 v5, v5, v65
    v_mul_f32 v6, v6, v66
    v_mul_f32 v7, v7, v67
    v_mul_f32 v8, v8, v68
    v_mul_f32 v9, v9, v69
    v_mul_f32 v10, v10, v70
    v_mul_f32 v11, v11, v71
    v_exp_f32 v4, v4
    v_exp_f32 v5, v5
    v_exp_f32 v6, v6
    v_exp_f32 v7, v7
    v_exp_f32 v8, v8
    v_exp_f32 v9, v9
    v_exp_f32 v10, v10
    v_exp_f32 v11, v11
    v_fma_f32 v4, v4, v19, v19
    v_fma_f32 v5, v5, v19, v19
    v_fma_f32 v6, v6, v19, v19
    v_fma_f32 v7, v7, v19, v19
    v_fma_f32 v8, v8, v19, v19
    v_fma_f32 v9, v9, v19, v19
    v_fma_f32 v10, v10, v19, v19
    v_fma_f32 v11, v11, v19, v19
    v_rcp_f32 v4, v4
    v_rcp_f32 v5, v5
    v_rcp_f32 v6, v6
    v_rcp_f32 v7, v7
    v_rcp_f32 v8, v8
    v_rcp_f32 v9, v9
    v_rcp_f32 v10, v10
    v_rcp_f32 v11, v11
    v_mul_f32 v64, v64, v4
    v_mul_f32 v65, v65, v5
    v_mul_f32 v66, v66, v6
    v_mul_f32 v67, v67, v7
    v_mul_f32 v68, v68, v8
    v_mul_f32 v69, v69, v9
    v_mul_f32 v70, v70, v10
    v_mul_f32 v71, v71, v11
    v_cvt_pk_bf16_f32 v24, v64, v65
    v_cvt_pk_bf16_f32 v25, v66, v67
    v_cvt_pk_bf16_f32 v26, v68, v69
    v_cvt_pk_bf16_f32 v27, v70, v71
    buffer_store_dwordx4 v[24:27], v2, s[24:27], s53 offen offset:0 sc0 sc1
    ds_read_b128 v[32:35], v20 offset:64
    ds_read_b128 v[36:39], v20 offset:80
    s_waitcnt lgkmcnt(1)
    v_fma_f32 v72, -v16, v32, v72
    v_fma_f32 v73, -v16, v33, v73
    v_fma_f32 v74, -v16, v34, v74
    v_fma_f32 v75, -v16, v35, v75
    s_waitcnt lgkmcnt(0)
    v_fma_f32 v76, -v16, v36, v76
    v_fma_f32 v77, -v16, v37, v77
    v_fma_f32 v78, -v16, v38, v78
    v_fma_f32 v79, -v16, v39, v79
    v_mul_f32 v4, v72, v72
    v_mul_f32 v5, v73, v73
    v_mul_f32 v6, v74, v74
    v_mul_f32 v7, v75, v75
    v_mul_f32 v8, v76, v76
    v_mul_f32 v9, v77, v77
    v_mul_f32 v10, v78, v78
    v_mul_f32 v11, v79, v79
    v_fma_f32 v4, v4, v18, v17
    v_fma_f32 v5, v5, v18, v17
    v_fma_f32 v6, v6, v18, v17
    v_fma_f32 v7, v7, v18, v17
    v_fma_f32 v8, v8, v18, v17
    v_fma_f32 v9, v9, v18, v17
    v_fma_f32 v10, v10, v18, v17
    v_fma_f32 v11, v11, v18, v17
    v_mul_f32 v4, v4, v72
    v_mul_f32 v5, v5, v73
    v_mul_f32 v6, v6, v74
    v_mul_f32 v7, v7, v75
    v_mul_f32 v8, v8, v76
    v_mul_f32 v9, v9, v77
    v_mul_f32 v10, v10, v78
    v_mul_f32 v11, v11, v79
    v_exp_f32 v4, v4
    v_exp_f32 v5, v5
    v_exp_f32 v6, v6
    v_exp_f32 v7, v7
    v_exp_f32 v8, v8
    v_exp_f32 v9, v9
    v_exp_f32 v10, v10
    v_exp_f32 v11, v11
    v_fma_f32 v4, v4, v19, v19
    v_fma_f32 v5, v5, v19, v19
    v_fma_f32 v6, v6, v19, v19
    v_fma_f32 v7, v7, v19, v19
    v_fma_f32 v8, v8, v19, v19
    v_fma_f32 v9, v9, v19, v19
    v_fma_f32 v10, v10, v19, v19
    v_fma_f32 v11, v11, v19, v19
    v_rcp_f32 v4, v4
    v_rcp_f32 v5, v5
    v_rcp_f32 v6, v6
    v_rcp_f32 v7, v7
    v_rcp_f32 v8, v8
    v_rcp_f32 v9, v9
    v_rcp_f32 v10, v10
    v_rcp_f32 v11, v11
    v_mul_f32 v72, v72, v4
    v_mul_f32 v73, v73, v5
    v_mul_f32 v74, v74, v6
    v_mul_f32 v75, v75, v7
    v_mul_f32 v76, v76, v8
    v_mul_f32 v77, v77, v9
    v_mul_f32 v78, v78, v10
    v_mul_f32 v79, v79, v11
    v_cvt_pk_bf16_f32 v28, v72, v73
    v_cvt_pk_bf16_f32 v29, v74, v75
    v_cvt_pk_bf16_f32 v30, v76, v77
    v_cvt_pk_bf16_f32 v31, v78, v79
    buffer_store_dwordx4 v[28:31], v2, s[24:27], s53 offen offset:1024 sc0 sc1
    s_nop 1
    s_setpc_b64 s[62:63]
K4_epk:
    v_sub_f32 v44, 0, v16
    v_sub_f32 v45, 0, v16
    v_mov_b32 v46, v17
    v_mov_b32 v47, v17
    v_mov_b32 v48, v18
    v_mov_b32 v49, v18
    v_mov_b32 v50, v19
    v_mov_b32 v51, v19
    ds_read_b128 v[32:35], v20 offset:0
    ds_read_b128 v[36:39], v20 offset:16
    s_waitcnt lgkmcnt(1)
    v_pk_fma_f32 v[64:65], v[44:45], v[32:33], v[64:65]
    v_pk_fma_f32 v[66:67], v[44:45], v[34:35], v[66:67]
    s_waitcnt lgkmcnt(0)
    v_pk_fma_f32 v[68:69], v[44:45], v[36:37], v[68:69]
    v_pk_fma_f32 v[70:71], v[44:45], v[38:39], v[70:71]
    v_pk_mul_f32 v[4:5], v[64:65], v[64:65]
    v_pk_mul_f32 v[6:7], v[66:67], v[66:67]
    v_pk_mul_f32 v[8:9], v[68:69], v[68:69]
    v_pk_mul_f32 v[10:11], v[70:71], v[70:71]
    v_pk_fma_f32 v[4:5], v[4:5], v[48:49], v[46:47]
    v_pk_fma_f32 v[6:7], v[6:7], v[48:49], v[46:47]
    v_pk_fma_f32 v[8:9], v[8:9], v[48:49], v[46:47]
    v_pk_fma_f32 v[10:11], v[10:11], v[48:49], v[46:47]
    v_pk_mul_f32 v[4:5], v[4:5], v[64:65]
    v_pk_mul_f32 v[6:7], v[6:7], v[66:67]
    v_pk_mul_f32 v[8:9], v[8:9], v[68:69]
    v_pk_mul_f32 v[10:11], v[10:11], v[70:71]
    v_exp_f32 v4, v4
    v_exp_f32 v5, v5
    v_exp_f32 v6, v6
    v_exp_f32 v7, v7
    v_exp_f32 v8, v8
    v_exp_f32 v9, v9
    v_exp_f32 v10, v10
    v_exp_f32 v11, v11
    v_pk_fma_f32 v[4:5], v[4:5], v[50:51], v[50:51]
    v_pk_fma_f32 v[6:7], v[6:7], v[50:51], v[50:51]
    v_pk_fma_f32 v[8:9], v[8:9], v[50:51], v[50:51]
    v_pk_fma_f32 v[10:11], v[10:11], v[50:51], v[50:51]
    v_rcp_f32 v4, v4
    v_rcp_f32 v5, v5
    v_rcp_f32 v6, v6
    v_rcp_f32 v7, v7
    v_rcp_f32 v8, v8
    v_rcp_f32 v9, v9
    v_rcp_f32 v10, v10
    v_rcp_f32 v11, v11
    v_pk_mul_f32 v[64:65], v[64:65], v[4:5]
    v_pk_mul_f32 v[66:67], v[66:67], v[6:7]
    v_pk_mul_f32 v[68:69], v[68:69], v[8:9]
    v_pk_mul_f32 v[70:71], v[70:71], v[10:11]
    v_cvt_pk_bf16_f32 v24, v64, v65
    v_cvt_pk_bf16_f32 v25, v66, v67
    v_cvt_pk_bf16_f32 v26, v68, v69
    v_cvt_pk_bf16_f32 v27, v70, v71
    buffer_store_dwordx4 v[24:27], v2, s[24:27], s53 offen offset:0 sc0 sc1
    ds_read_b128 v[32:35], v20 offset:64
    ds_read_b128 v[36:39], v20 offset:80
    s_waitcnt lgkmcnt(1)
    v_pk_fma_f32 v[72:73], v[44:45], v[32:33], v[72:73]
    v_pk_fma_f32 v[74:75], v[44:45], v[34:35], v[74:75]
    s_waitcnt lgkmcnt(0)
    v_pk_fma_f32 v[76:77], v[44:45], v[36:37], v[76:77]
    v_pk_fma_f32 v[78:79], v[44:45], v[38:39], v[78:79]
    v_pk_mul_f32 v[4:5], v[72:73], v[72:73]
    v_pk_mul_f32 v[6:7], v[74:75], v[74:75]
    v_pk_mul_f32 v[8:9], v[76:77], v[76:77]
    v_pk_mul_f32 v[10:11], v[78:79], v[78:79]
    v_pk_fma_f32 v[4:5], v[4:5], v[48:49], v[46:47]
    v_pk_fma_f32 v[6:7], v[6:7], v[48:49], v[46:47]
    v_pk_fma_f32 v[8:9], v[8:9], v[48:49], v[46:47]
    v_pk_fma_f32 v[10:11], v[10:11], v[48:49], v[46:47]
    v_pk_mul_f32 v[4:5], v[4:5], v[72:73]
    v_pk_mul_f32 v[6:7], v[6:7], v[74:75]
    v_pk_mul_f32 v[8:9], v[8:9], v[76:77]
    v_pk_mul_f32 v[10:11], v[10:11], v[78:79]
    v_exp_f32 v4, v4
    v_exp_f32 v5, v5
    v_exp_f32 v6, v6
    v_exp_f32 v7, v7
    v_exp_f32 v8, v8
    v_exp_f32 v9, v9
    v_exp_f32 v10, v10
    v_exp_f32 v11, v11
    v_pk_fma_f32 v[4:5], v[4:5], v[50:51], v[50:51]
    v_pk_fma_f32 v[6:7], v[6:7], v[50:51], v[50:51]
    v_pk_fma_f32 v[8:9], v[8:9], v[50:51], v[50:51]
    v_pk_fma_f32 v[10:11], v[10:11], v[50:51], v[50:51]
    v_rcp_f32 v4, v4
    v_rcp_f32 v5, v5
    v_rcp_f32 v6, v6
    v_rcp_f32 v7, v7
    v_rcp_f32 v8, v8
    v_rcp_f32 v9, v9
    v_rcp_f32 v10, v10
    v_rcp_f32 v11, v11
    v_pk_mul_f32 v[72:73], v[72:73], v[4:5]
    v_pk_mul_f32 v[74:75], v[74:75], v[6:7]
    v_pk_mul_f32 v[76:77], v[76:77], v[8:9]
    v_pk_mul_f32 v[78:79], v[78:79], v[10:11]
    v_cvt_pk_bf16_f32 v28, v72, v73
    v_cvt_pk_bf16_f32 v29, v74, v75
    v_cvt_pk_bf16_f32 v30, v76, v77
    v_cvt_pk_bf16_f32 v31, v78, v79
    buffer_store_dwordx4 v[28:31], v2, s[24:27], s53 offen offset:1024 sc0 sc1
    s_nop 1
    s_setpc_b64 s[62:63]
K4_help:
    s_lshl_b32 s51, s36, 9
    s_add_u32 s51, s51, 0x202800
    v_lshrrev_b32 v14, 5, v1
    v_mul_u32_u24 v14, 7168, v14
    v_lshl_add_u32 v14, v4, 2, v14
    s_lshl_b32 s51, s36, 9
    s_lshl_b32 s41, s34, 7
    s_add_u32 s51, s51, s41
    s_add_u32 s51, s51, 0x260000
    s_add_u32 s41, s41, 131072
    v_lshl_add_u32 v15, v4, 2, s41
    s_lshl_b32 s41, s34, 9
    s_add_u32 s41, s41, 131584
    v_lshl_add_u32 v13, v4, 4, s41
    v_lshrrev_b32 v20, 5, v1
    v_lshlrev_b32 v20, 5, v20
    v_add_u32 v20, 131072, v20
    s_lshl_b32 s41, s34, 13
    v_add_u32 v21, s41, v2
    s_mul_i32 s53, s40, 114688
    s_lshl_b32 s54, s36, 13
    s_add_u32 s53, s53, s54
    s_add_u32 s53, s53, 0x2000000
    s_waitcnt vmcnt(4)
    s_barrier
    s_add_u32 m0, s46, 32768
    s_add_u32 s48, s45, 917504
    buffer_load_dwordx4 v12, s[12:15], s48 offen lds
    s_add_u32 m0, s46, 36864
    s_add_u32 s48, s45, 1032192
    buffer_load_dwordx4 v12, s[12:15], s48 offen lds
    s_add_u32 m0, s46, 40960
    s_add_u32 s48, s45, 1146880
    buffer_load_dwordx4 v12, s[12:15], s48 offen lds
TP4:
    s_cbranch_execz K1_end
    s_add_u32 m0, s46, 45056
    s_add_u32 s48, s45, 1261568
    buffer_load_dwordx4 v12, s[12:15], s48 offen lds
    s_add_u32 m0, s46, 49152
    s_add_u32 s48, s45, 1376256
    buffer_load_dwordx4 v12, s[12:15], s48 offen lds
    s_add_u32 m0, s46, 53248
    s_add_u32 s48, s45, 1490944
    buffer_load_dwordx4 v12, s[12:15], s48 offen lds
    s_add_u32 m0, s46, 57344
    s_add_u32 s48, s45, 1605632
    buffer_load_dwordx4 v12, s[12:15], s48 offen lds
    s_add_u32 m0, s46, 61440
    s_add_u32 s48, s45, 1720320
    buffer_load_dwordx4 v12, s[12:15], s48 offen lds
    buffer_load_dwordx2 v[96:97], v7, s[24:27], s50 offen
    s_add_u32 s50, s50, 32768
    buffer_load_dwordx2 v[98:99], v7, s[24:27], s50 offen
    s_add_u32 s50, s50, 32768
    buffer_load_dwordx2 v[100:101], v7, s[24:27], s50 offen
    s_add_u32 s50, s50, 32768
    buffer_load_dwordx2 v[102:103], v7, s[24:27], s50 offen
    s_add_u32 s50, s50, 32768
    buffer_load_dwordx2 v[104:105], v7, s[24:27], s50 offen
    s_add_u32 s50, s50, 32768
    buffer_load_dwordx2 v[106:107], v7, s[24:27], s50 offen
    s_add_u32 s50, s50, 32768
    buffer_load_dwordx2 v[108:109], v7, s[24:27], s50 offen
    s_add_u32 s50, s50, 32768
    buffer_load_dwordx2 v[110:111], v7, s[24:27], s50 offen
    buffer_load_dword v48, v14, s[24:27], s51 offen
    s_add_u32 s51, s51, 14336
    buffer_load_dword v49, v14, s[24:27], s51 offen
    s_add_u32 s51, s51, 14336
    buffer_load_dword v50, v14, s[24:27], s51 offen
    s_add_u32 s51, s51, 14336
    buffer_load_dword v51, v14, s[24:27], s51 offen
    s_waitcnt vmcnt(20)
    s_barrier
    s_add_u32 m0, s46, 65536
    s_add_u32 s48, s45, 128
    buffer_load_dwordx4 v12, s[12:15], s48 offen lds
    s_add_u32 m0, s46, 69632
    s_add_u32 s48, s45, 114816
    buffer_load_dwordx4 v12, s[12:15], s48 offen lds
    s_add_u32 m0, s46, 73728
    s_add_u32 s48, s45, 229504
    buffer_load_dwordx4 v12, s[12:15], s48 offen lds
    s_add_u32 m0, s46, 77824
    s_add_u32 s48, s45, 344192
    buffer_load_dwordx4 v12, s[12:15], s48 offen lds
    s_add_u32 m0, s46, 81920
    s_add_u32 s48, s45, 458880
    buffer_load_dwordx4 v12, s[12:15], s48 offen lds
    s_add_u32 m0, s46, 86016
    s_add_u32 s48, s45, 573568
    buffer_load_dwordx4 v12, s[12:15], s48 offen lds
    s_add_u32 m0, s46, 90112
    s_add_u32 s48, s45, 688256
    buffer_load_dwordx4 v12, s[12:15], s48 offen lds
    s_add_u32 m0, s46, 94208
    s_add_u32 s48, s45, 802944
    buffer_load_dwordx4 v12, s[12:15], s48 offen lds
    s_waitcnt vmcnt(24)
    s_barrier
    s_add_u32 m0, s46, 98304
    s_add_u32 s48, s45, 917632
    buffer_load_dwordx4 v12, s[12:15], s48 offen lds
    s_add_u32 m0, s46, 102400
    s_add_u32 s48, s45, 1032320
    buffer_load_dwordx4 v12, s[12:15], s48 offen lds
    s_add_u32 m0, s46, 106496
    s_add_u32 s48, s45, 1147008
    buffer_load_dwordx4 v12, s[12:15], s48 offen lds
    s_add_u32 m0, s46, 110592
    s_add_u32 s48, s45, 1261696
    buffer_load_dwordx4 v12, s[12:15], s48 offen lds
    s_add_u32 m0, s46, 114688
    s_add_u32 s48, s45, 1376384
    buffer_load_dwordx4 v12, s[12:15], s48 offen lds
    s_add_u32 m0, s46, 118784
    s_add_u32 s48, s45, 1491072
    buffer_load_dwordx4 v12, s[12:15], s48 offen lds
    s_add_u32 m0, s46, 122880
    s_add_u32 s48, s45, 1605760
    buffer_load_dwordx4 v12, s[12:15], s48 offen lds
    s_add_u32 m0, s46, 126976
    s_add_u32 s48, s45, 1720448
    buffer_load_dwordx4 v12, s[12:15], s48 offen lds
    s_waitcnt vmcnt(23)
    v_add_f32 v96, v96, v104
    v_add_f32 v97, v97, v105
    s_waitcnt vmcnt(22)
    v_add_f32 v98, v98, v106
    v_add_f32 v99, v99, v107
    s_waitcnt vmcnt(21)
    v_add_f32 v100, v100, v108
    v_add_f32 v101, v101, v109
    s_waitcnt vmcnt(20)
    v_add_f32 v102, v102, v110
    v_add_f32 v103, v103, v111
    v_add_f32 v96, v96, v100
    v_add_f32 v97, v97, v101
    v_add_f32 v98, v98, v102
    v_add_f32 v99, v99, v103
    v_add_f32 v96, v96, v98
    v_add_f32 v97, v97, v99
    v_mov_b32 v16, v96
    v_mov_b32 v19, v97
    s_nop 0
    v_permlane32_swap_b32 v16, v96
    v_permlane32_swap_b32 v19, v97
    v_add_f32 v16, v16, v96
    v_add_f32 v19, v19, v97
    v_mul_f32 v16, 0x3b000000, v16
    v_mul_f32 v19, 0x3b000000, v19
    v_fma_f32 v19, -v16, v16, v19
    v_max_f32 v19, 0, v19
    v_cvt_pk_bf16_f32 v16, 0, v16
    v_cvt_pk_bf16_f32 v19, 0, v19
    v_add_f32 v19, 0x3727c5ac, v19
    v_cvt_pk_bf16_f32 v19, 0, v19
    v_sqrt_f32 v19, v19
    s_nop 0
    v_cvt_pk_bf16_f32 v19, 0, v19
    v_rcp_f32 v6, v19
    s_nop 0
    v_mul_f32 v17, 0xc0135761, v6
    v_mul_f32 v18, v6, v6
    v_mul_f32 v18, v18, v17
    v_mul_f32 v18, 0x3d372713, v18
    ds_write_b128 v13, v[16:19]
    s_waitcnt vmcnt(18)
    v_add_f32 v48, v48, v49
    s_waitcnt vmcnt(16)
    v_add_f32 v50, v50, v51
    v_add_f32 v48, v48, v50
    v_mov_b32 v49, v48
    s_nop 1
    v_permlane32_swap_b32 v48, v49
    v_add_f32 v48, v48, v49
    ds_write_b32 v15, v48
    s_barrier
    s_waitcnt vmcnt(12) lgkmcnt(0)
    s_barrier
    ds_read_b128 v[64:67], v21 offset:0
    ds_read_b128 v[68:71], v21 offset:1024
    ds_read_b128 v[72:75], v21 offset:2048
    ds_read_b128 v[76:79], v21 offset:3072
    ds_read_b128 v[80:83], v21 offset:4096
    ds_read_b128 v[84:87], v21 offset:5120
    ds_read_b128 v[88:91], v21 offset:6144
    ds_read_b128 v[92:95], v21 offset:7168
    s_waitcnt vmcnt(0) lgkmcnt(0)
    s_barrier
    s_setprio 0
    s_call_b64 s[62:63], K4_epi
    v_mov_b32 v64, v80
    v_mov_b32 v65, v81
    v_mov_b32 v66, v82
    v_mov_b32 v67, v83
    v_mov_b32 v68, v84
    v_mov_b32 v69, v85
    v_mov_b32 v70, v86
    v_mov_b32 v71, v87
    v_mov_b32 v72, v88
    v_mov_b32 v73, v89
    v_mov_b32 v74, v90
    v_mov_b32 v75, v91
    v_mov_b32 v76, v92
    v_mov_b32 v77, v93
    v_mov_b32 v78, v94
    v_mov_b32 v79, v95
    v_add_u32 v20, 128, v20
    s_add_u32 s53, s53, 2048
    s_call_b64 s[62:63], K4_epi
    v_add_u32 v20, 256, v20
    s_add_u32 s53, s53, 4096
    s_barrier
    ds_read_b128 v[64:67], v21 offset:4096
    ds_read_b128 v[68:71], v21 offset:5120
    ds_read_b128 v[72:75], v21 offset:6144
    ds_read_b128 v[76:79], v21 offset:7168
    s_waitcnt lgkmcnt(0)
    s_call_b64 s[62:63], K4_epk
K4_end:
    s_endpgm
.fill (54528 - (. - TBASE))/4, 4, 0xBF810000
.globl k5_kernel
.p2align 8
.type k5_kernel,@function
k5_kernel:
    s_cmp_ge_u32 s2, 256
    s_cbranch_scc1 K5_end
    s_load_dwordx2 s[12:13], s[0:1], 72
    s_load_dwordx2 s[24:25], s[0:1], 112
    s_load_dwordx2 s[8:9], s[0:1], 96
    v_and_b32 v1, 63, v0
    v_lshrrev_b32 v3, 6, v0
    s_nop 0
    v_readfirstlane_b32 s34, v3
    s_and_b32 s35, s2, 7
    s_lshr_b32 s36, s2, 3
    s_lshl_b32 s35, s35, 2
    s_lshr_b32 s37, s36, 3
    s_add_u32 s35, s35, s37
    s_and_b32 s36, s36, 7
    s_and_b32 s38, s34, 1
    s_lshr_b32 s39, s34, 1
    s_lshl_b32 s40, s35, 1
    s_add_u32 s40, s40, s38
    v_and_b32 v7, 15, v1
    v_lshrrev_b32 v8, 4, v1
    v_lshlrev_b32 v2, 4, v7
    v_lshl_add_u32 v2, v8, 9, v2
    s_mov_b32 s14, 0x1c0000
    s_mov_b32 s15, 0x00020000
    s_mov_b32 s10, 0x200000
    s_mov_b32 s11, 0x00020000
    s_mov_b32 s26, 0x10000000
    s_mov_b32 s27, 0x00020000
    v_bfe_u32 v4, v1, 3, 2
    v_lshrrev_b32 v5, 5, v1
    v_lshl_add_u32 v4, v5, 3, v4
    v_and_b32 v5, 7, v1
    v_lshlrev_b32 v6, 1, v8
    v_xor_b32 v5, v5, v6
    v_lshlrev_b32 v5, 4, v5
    v_lshl_add_u32 v5, v4, 10, v5
    s_mul_i32 s45, s39, 458752
    s_lshl_b32 s46, s36, 7
    s_add_u32 s45, s45, s46
    s_lshl_b32 s46, s38, 14
    s_add_u32 s45, s45, s46
    s_lshl_b32 s46, s39, 13
    s_lshl_b32 s47, s38, 10
    s_add_u32 s46, s46, s47
    s_mul_i32 s49, s40, 114688
    s_mul_i32 s50, s39, 28672
    s_add_u32 s49, s49, s50
    s_add_u32 s49, s49, 0x2000000
    s_mul_i32 s54, s36, 0
    s_mul_i32 s55, s37, 2
    s_add_u32 s54, s54, s55
    s_mul_i32 s55, s54, 37
    s_lshr_b32 s55, s55, 8
    s_mul_i32 s55, s55, 7
    s_sub_u32 s54, s54, s55
    s_waitcnt lgkmcnt(0)
    s_lshl_b32 s55, s54, 16
    s_add_u32 s55, s55, s45
    s_add_u32 m0, s46, 0
    s_add_u32 s48, s55, 0
    buffer_load_dwordx4 v5, s[12:15], s48 offen lds
    s_add_u32 m0, s46, 2048
    s_add_u32 s48, s55, 4096
    buffer_load_dwordx4 v5, s[12:15], s48 offen lds
    s_add_u32 m0, s46, 4096
    s_add_u32 s48, s55, 32768
    buffer_load_dwordx4 v5, s[12:15], s48 offen lds
    s_add_u32 m0, s46, 6144
    s_add_u32 s48, s55, 36864
    buffer_load_dwordx4 v5, s[12:15], s48 offen lds
    s_lshl_b32 s50, s54, 12
    s_add_u32 s50, s50, s49
    s_add_u32 s54, s54, 1
    s_cmp_eq_u32 s54, 7
    s_cselect_b32 s54, 0, s54
    buffer_load_dwordx4 v[96:99], v2, s[24:27], s50 offen offset:0
    buffer_load_dwordx4 v[100:103], v2, s[24:27], s50 offen offset:256
    buffer_load_dwordx4 v[104:107], v2, s[24:27], s50 offen offset:2048
    buffer_load_dwordx4 v[108:111], v2, s[24:27], s50 offen offset:2304
    s_lshl_b32 s55, s54, 16
    s_add_u32 s55, s55, s45
    s_add_u32 m0, s46, 32768
    s_add_u32 s48, s55, 0
    buffer_load_dwordx4 v5, s[12:15], s48 offen lds
    s_add_u32 m0, s46, 34816
    s_add_u32 s48, s55, 4096
    buffer_load_dwordx4 v5, s[12:15], s48 offen lds
    s_add_u32 m0, s46, 36864
    s_add_u32 s48, s55, 32768
    buffer_load_dwordx4 v5, s[12:15], s48 offen lds
    s_add_u32 m0, s46, 38912
    s_add_u32 s48, s55, 36864
    buffer_load_dwordx4 v5, s[12:15], s48 offen lds
    s_lshl_b32 s50, s54, 12
    s_add_u32 s50, s50, s49
    s_add_u32 s54, s54, 1
    s_cmp_eq_u32 s54, 7
    s_cselect_b32 s54, 0, s54
    buffer_load_dwordx4 v[112:115], v2, s[24:27], s50 offen offset:0
    buffer_load_dwordx4 v[116:119], v2, s[24:27], s50 offen offset:256
    buffer_load_dwordx4 v[120:123], v2, s[24:27], s50 offen offset:2048
    buffer_load_dwordx4 v[124:127], v2, s[24:27], s50 offen offset:2304
    v_lshrrev_b32 v10, 2, v1
    v_lshlrev_b32 v10, 7, v10
    v_and_b32 v11, 3, v1
    v_lshl_add_u32 v10, v11, 3, v10
    s_lshl_b32 s50, s39, 13
    v_add_u32 v10, s50, v10
    v_bfe_u32 v11, v1, 3, 2
    v_xor_b32 v9, 0, v11
    v_lshl_add_u32 v12, v9, 5, v10
    v_xor_b32 v9, 1, v11
    v_lshl_add_u32 v13, v9, 5, v10
    v_xor_b32 v9, 2, v11
    v_lshl_add_u32 v212, v9, 5, v10
    v_xor_b32 v9, 3, v11
    v_lshl_add_u32 v213, v9, 5, v10
    v_xor_b32 v8, v8, v7
    s_lshl_b32 s50, s34, 13
    s_add_u32 s50, s50, 65536
    v_lshl_add_u32 v7, v7, 8, s50
    v_xor_b32 v9, 0, v8
    v_lshl_add_u32 v214, v9, 4, v7
    v_xor_b32 v9, 4, v8
    v_lshl_add_u32 v215, v9, 4, v7
    v_xor_b32 v9, 8, v8
    v_lshl_add_u32 v216, v9, 4, v7
    v_xor_b32 v9, 12, v8
    v_lshl_add_u32 v217, v9, 4, v7
    s_waitcnt vmcnt(12)
    s_barrier
    ds_read_b64_tr_b16 v[64:65], v12 offset:0
    ds_read_b64_tr_b16 v[66:67], v12 offset:2048
    s_lshl_b32 s55, s54, 16
    s_add_u32 s55, s55, s45
    s_add_u32 m0, s46, 65536
    s_add_u32 s48, s55, 0
    buffer_load_dwordx4 v5, s[12:15], s48 offen lds
    ds_read_b64_tr_b16 v[68:69], v13 offset:0
    ds_read_b64_tr_b16 v[70:71], v13 offset:2048
    ds_read_b64_tr_b16 v[72:73], v212 offset:0
    s_add_u32 m0, s46, 67584
    s_add_u32 s48, s55, 4096
    buffer_load_dwordx4 v5, s[12:15], s48 offen lds
    ds_read_b64_tr_b16 v[74:75], v212 offset:2048
    ds_read_b64_tr_b16 v[76:77], v213 offset:0
    ds_read_b64_tr_b16 v[78:79], v213 offset:2048
    s_waitcnt vmcnt(13) lgkmcnt(6)
    v_mfma_f32_16x16x32_bf16 v[32:35], v[64:67], v[96:99], 0
    s_add_u32 m0, s46, 69632
    s_add_u32 s48, s55, 32768
    buffer_load_dwordx4 v5, s[12:15], s48 offen lds
    ds_read_b64_tr_b16 v[80:81], v12 offset:4096
    s_waitcnt vmcnt(13)
    v_mfma_f32_16x16x32_bf16 v[48:51], v[64:67], v[100:103], 0
    ds_read_b64_tr_b16 v[82:83], v12 offset:6144
    s_add_u32 m0, s46, 71680
    s_add_u32 s48, s55, 36864
    buffer_load_dwordx4 v5, s[12:15], s48 offen lds
    s_waitcnt lgkmcnt(6)
    v_mfma_f32_16x16x32_bf16 v[36:39], v[68:71], v[96:99], 0
    ds_read_b64_tr_b16 v[84:85], v13 offset:4096
    v_mfma_f32_16x16x32_bf16 v[52:55], v[68:71], v[100:103], 0
    ds_read_b64_tr_b16 v[86:87], v13 offset:6144
    s_lshl_b32 s50, s54, 12
    s_add_u32 s50, s50, s49
    s_add_u32 s54, s54, 1
    s_cmp_eq_u32 s54, 7
    s_cselect_b32 s54, 0, s54
    s_waitcnt lgkmcnt(6)
    v_mfma_f32_16x16x32_bf16 v[40:43], v[72:75], v[96:99], 0
    ds_read_b64_tr_b16 v[88:89], v212 offset:4096
    v_mfma_f32_16x16x32_bf16 v[56:59], v[72:75], v[100:103], 0
    ds_read_b64_tr_b16 v[90:91], v212 offset:6144
    buffer_load_dwordx4 v[128:131], v2, s[24:27], s50 offen offset:0
    s_waitcnt lgkmcnt(6)
    v_mfma_f32_16x16x32_bf16 v[44:47], v[76:79], v[96:99], 0
    ds_read_b64_tr_b16 v[92:93], v213 offset:4096
    v_mfma_f32_16x16x32_bf16 v[60:63], v[76:79], v[100:103], 0
    buffer_load_dwordx4 v[132:135], v2, s[24:27], s50 offen offset:256
    ds_read_b64_tr_b16 v[94:95], v213 offset:6144
    s_waitcnt vmcnt(15) lgkmcnt(6)
    v_mfma_f32_16x16x32_bf16 v[32:35], v[80:83], v[104:107], v[32:35]
    s_waitcnt vmcnt(14)
    v_mfma_f32_16x16x32_bf16 v[48:51], v[80:83], v[108:111], v[48:51]
    s_waitcnt lgkmcnt(4)
    v_mfma_f32_16x16x32_bf16 v[36:39], v[84:87], v[104:107], v[36:39]
    buffer_load_dwordx4 v[136:139], v2, s[24:27], s50 offen offset:2048
    v_mfma_f32_16x16x32_bf16 v[52:55], v[84:87], v[108:111], v[52:55]
    s_waitcnt lgkmcnt(2)
    v_mfma_f32_16x16x32_bf16 v[40:43], v[88:91], v[104:107], v[40:43]
    v_mfma_f32_16x16x32_bf16 v[56:59], v[88:91], v[108:111], v[56:59]
    buffer_load_dwordx4 v[140:143], v2, s[24:27], s50 offen offset:2304
    s_waitcnt lgkmcnt(0)
    v_mfma_f32_16x16x32_bf16 v[44:47], v[92:95], v[104:107], v[44:47]
    v_mfma_f32_16x16x32_bf16 v[60:63], v[92:95], v[108:111], v[60:63]
    s_waitcnt vmcnt(12)
    s_barrier
    ds_read_b64_tr_b16 v[64:65], v12 offset:32768
    ds_read_b64_tr_b16 v[66:67], v12 offset:34816
    s_lshl_b32 s55, s54, 16
    s_add_u32 s55, s55, s45
    s_add_u32 m0, s46, 98304
    s_add_u32 s48, s55, 0
    buffer_load_dwordx4 v5, s[12:15], s48 offen lds
    ds_read_b64_tr_b16 v[68:69], v13 offset:32768
    ds_read_b64_tr_b16 v[70:71], v13 offset:34816
    ds_read_b64_tr_b16 v[72:73], v212 offset:32768
    ds_read_b64_tr_b16 v[74:75], v212 offset:34816
    s_add_u32 m0, s46, 100352
    s_add_u32 s48, s55, 4096
    buffer_load_dwordx4 v5, s[12:15], s48 offen lds
    ds_read_b64_tr_b16 v[76:77], v213 offset:32768
    ds_read_b64_tr_b16 v[78:79], v213 offset:34816
    s_waitcnt vmcnt(13) lgkmcnt(6)
    v_mfma_f32_16x16x32_bf16 v[32:35], v[64:67], v[112:115], v[32:35]
    ds_read_b64_tr_b16 v[80:81], v12 offset:36864
    s_add_u32 m0, s46, 102400
    s_add_u32 s48, s55, 32768
    buffer_load_dwordx4 v5, s[12:15], s48 offen lds
    s_waitcnt vmcnt(13)
    v_mfma_f32_16x16x32_bf16 v[48:51], v[64:67], v[116:119], v[48:51]
    ds_read_b64_tr_b16 v[82:83], v12 offset:38912
    s_waitcnt lgkmcnt(6)
    v_mfma_f32_16x16x32_bf16 v[36:39], v[68:71], v[112:115], v[36:39]
    ds_read_b64_tr_b16 v[84:85], v13 offset:36864
    s_add_u32 m0, s46, 104448
    s_add_u32 s48, s55, 36864
    buffer_load_dwordx4 v5, s[12:15], s48 offen lds
    v_mfma_f32_16x16x32_bf16 v[52:55], v[68:71], v[116:119], v[52:55]
    ds_read_b64_tr_b16 v[86:87], v13 offset:38912
    s_waitcnt lgkmcnt(6)
    v_mfma_f32_16x16x32_bf16 v[40:43], v[72:75], v[112:115], v[40:43]
    ds_read_b64_tr_b16 v[88:89], v212 offset:36864
    s_lshl_b32 s50, s54, 12
    s_add_u32 s50, s50, s49
    s_add_u32 s54, s54, 1
    s_cmp_eq_u32 s54, 7
    s_cselect_b32 s54, 0, s54
    v_mfma_f32_16x16x32_bf16 v[56:59], v[72:75], v[116:119], v[56:59]
    ds_read_b64_tr_b16 v[90:91], v212 offset:38912
    s_waitcnt lgkmcnt(6)
    v_mfma_f32_16x16x32_bf16 v[44:47], v[76:79], v[112:115], v[44:47]
    ds_read_b64_tr_b16 v[92:93], v213 offset:36864
    buffer_load_dwordx4 v[144:147], v2, s[24:27], s50 offen offset:0
    v_mfma_f32_16x16x32_bf16 v[60:63], v[76:79], v[116:119], v[60:63]
    ds_read_b64_tr_b16 v[94:95], v213 offset:38912
    s_waitcnt vmcnt(14) lgkmcnt(6)
    v_mfma_f32_16x16x32_bf16 v[32:35], v[80:83], v[120:123], v[32:35]
    s_waitcnt vmcnt(13)
    v_mfma_f32_16x16x32_bf16 v[48:51], v[80:83], v[124:127], v[48:51]
    buffer_load_dwordx4 v[148:151], v2, s[24:27], s50 offen offset:256
    s_waitcnt lgkmcnt(4)
    v_mfma_f32_16x16x32_bf16 v[36:39], v[84:87], v[120:123], v[36:39]
    v_mfma_f32_16x16x32_bf16 v[52:55], v[84:87], v[124:127], v[52:55]
    s_waitcnt lgkmcnt(2)
    v_mfma_f32_16x16x32_bf16 v[40:43], v[88:91], v[120:123], v[40:43]
    v_mfma_f32_16x16x32_bf16 v[56:59], v[88:91], v[124:127], v[56:59]
    buffer_load_dwordx4 v[152:155], v2, s[24:27], s50 offen offset:2048
    s_waitcnt lgkmcnt(0)
    v_mfma_f32_16x16x32_bf16 v[44:47], v[92:95], v[120:123], v[44:47]
    v_mfma_f32_16x16x32_bf16 v[60:63], v[92:95], v[124:127], v[60:63]
    v_add_u32 v12, 65536, v12
    v_add_u32 v13, 65536, v13
    buffer_load_dwordx4 v[156:159], v2, s[24:27], s50 offen offset:2304
    v_add_u32 v212, 65536, v212
    v_add_u32 v213, 65536, v213
    s_waitcnt vmcnt(12)
    s_barrier
    ds_read_b64_tr_b16 v[64:65], v12 offset:0
    ds_read_b64_tr_b16 v[66:67], v12 offset:2048
    s_lshl_b32 s55, s54, 16
    s_add_u32 s55, s55, s45
    s_add_u32 m0, s46, 131072
    s_add_u32 s48, s55, 0
    buffer_load_dwordx4 v5, s[12:15], s48 offen lds
    ds_read_b64_tr_b16 v[68:69], v13 offset:0
    ds_read_b64_tr_b16 v[70:71], v13 offset:2048
    ds_read_b64_tr_b16 v[72:73], v212 offset:0
    s_add_u32 m0, s46, 133120
    s_add_u32 s48, s55, 4096
    buffer_load_dwordx4 v5, s[12:15], s48 offen lds
    ds_read_b64_tr_b16 v[74:75], v212 offset:2048
    ds_read_b64_tr_b16 v[76:77], v213 offset:0
    ds_read_b64_tr_b16 v[78:79], v213 offset:2048
    s_waitcnt vmcnt(13) lgkmcnt(6)
    v_mfma_f32_16x16x32_bf16 v[32:35], v[64:67], v[128:131], v[32:35]
    s_add_u32 m0, s46, 135168
    s_add_u32 s48, s55, 32768
    buffer_load_dwordx4 v5, s[12:15], s48 offen lds
    ds_read_b64_tr_b16 v[80:81], v12 offset:4096
    s_waitcnt vmcnt(13)
    v_mfma_f32_16x16x32_bf16 v[48:51], v[64:67], v[132:135], v[48:51]
    ds_read_b64_tr_b16 v[82:83], v12 offset:6144
    s_add_u32 m0, s46, 137216
    s_add_u32 s48, s55, 36864
    buffer_load_dwordx4 v5, s[12:15], s48 offen lds
    s_waitcnt lgkmcnt(6)
    v_mfma_f32_16x16x32_bf16 v[36:39], v[68:71], v[128:131], v[36:39]
    ds_read_b64_tr_b16 v[84:85], v13 offset:4096
    v_mfma_f32_16x16x32_bf16 v[52:55], v[68:71], v[132:135], v[52:55]
    ds_read_b64_tr_b16 v[86:87], v13 offset:6144
    s_lshl_b32 s50, s54, 12
    s_add_u32 s50, s50, s49
    s_add_u32 s54, s54, 1
    s_cmp_eq_u32 s54, 7
    s_cselect_b32 s54, 0, s54
    s_waitcnt lgkmcnt(6)
    v_mfma_f32_16x16x32_bf16 v[40:43], v[72:75], v[128:131], v[40:43]
    ds_read_b64_tr_b16 v[88:89], v212 offset:4096
    v_mfma_f32_16x16x32_bf16 v[56:59], v[72:75], v[132:135], v[56:59]
    ds_read_b64_tr_b16 v[90:91], v212 offset:6144
    buffer_load_dwordx4 v[160:163], v2, s[24:27], s50 offen offset:0
    s_waitcnt lgkmcnt(6)
    v_mfma_f32_16x16x32_bf16 v[44:47], v[76:79], v[128:131], v[44:47]
    ds_read_b64_tr_b16 v[92:93], v213 offset:4096
    v_mfma_f32_16x16x32_bf16 v[60:63], v[76:79], v[132:135], v[60:63]
    buffer_load_dwordx4 v[164:167], v2, s[24:27], s50 offen offset:256
    ds_read_b64_tr_b16 v[94:95], v213 offset:6144
    s_waitcnt vmcnt(15) lgkmcnt(6)
    v_mfma_f32_16x16x32_bf16 v[32:35], v[80:83], v[136:139], v[32:35]
    s_waitcnt vmcnt(14)
    v_mfma_f32_16x16x32_bf16 v[48:51], v[80:83], v[140:143], v[48:51]
    s_waitcnt lgkmcnt(4)
    v_mfma_f32_16x16x32_bf16 v[36:39], v[84:87], v[136:139], v[36:39]
    buffer_load_dwordx4 v[168:171], v2, s[24:27], s50 offen offset:2048
    v_mfma_f32_16x16x32_bf16 v[52:55], v[84:87], v[140:143], v[52:55]
    s_waitcnt lgkmcnt(2)
    v_mfma_f32_16x16x32_bf16 v[40:43], v[88:91], v[136:139], v[40:43]
    v_mfma_f32_16x16x32_bf16 v[56:59], v[88:91], v[140:143], v[56:59]
    buffer_load_dwordx4 v[172:175], v2, s[24:27], s50 offen offset:2304
    s_waitcnt lgkmcnt(0)
    v_mfma_f32_16x16x32_bf16 v[44:47], v[92:95], v[136:139], v[44:47]
    v_mfma_f32_16x16x32_bf16 v[60:63], v[92:95], v[140:143], v[60:63]
    s_waitcnt vmcnt(12)
    s_barrier
    ds_read_b64_tr_b16 v[64:65], v12 offset:32768
    ds_read_b64_tr_b16 v[66:67], v12 offset:34816
    s_lshl_b32 s55, s54, 16
    s_add_u32 s55, s55, s45
    s_add_u32 m0, s46, 0
    s_add_u32 s48, s55, 0
    buffer_load_dwordx4 v5, s[12:15], s48 offen lds
    ds_read_b64_tr_b16 v[68:69], v13 offset:32768
    ds_read_b64_tr_b16 v[70:71], v13 offset:34816
    ds_read_b64_tr_b16 v[72:73], v212 offset:32768
    ds_read_b64_tr_b16 v[74:75], v212 offset:34816
    s_add_u32 m0, s46, 2048
    s_add_u32 s48, s55, 4096
    buffer_load_dwordx4 v5, s[12:15], s48 offen lds
    ds_read_b64_tr_b16 v[76:77], v213 offset:32768
    ds_read_b64_tr_b16 v[78:79], v213 offset:34816
    s_waitcnt vmcnt(13) lgkmcnt(6)
    v_mfma_f32_16x16x32_bf16 v[32:35], v[64:67], v[144:147], v[32:35]
    ds_read_b64_tr_b16 v[80:81], v12 offset:36864
    s_add_u32 m0, s46, 4096
    s_add_u32 s48, s55, 32768
    buffer_load_dwordx4 v5, s[12:15], s48 offen lds
    s_waitcnt vmcnt(13)
    v_mfma_f32_16x16x32_bf16 v[48:51], v[64:67], v[148:151], v[48:51]
    ds_read_b64_tr_b16 v[82:83], v12 offset:38912
    s_waitcnt lgkmcnt(6)
    v_mfma_f32_16x16x32_bf16 v[36:39], v[68:71], v[144:147], v[36:39]
    ds_read_b64_tr_b16 v[84:85], v13 offset:36864
    s_add_u32 m0, s46, 6144
    s_add_u32 s48, s55, 36864
    buffer_load_dwordx4 v5, s[12:15], s48 offen lds
    v_mfma_f32_16x16x32_bf16 v[52:55], v[68:71], v[148:151], v[52:55]
    ds_read_b64_tr_b16 v[86:87], v13 offset:38912
    s_waitcnt lgkmcnt(6)
    v_mfma_f32_16x16x32_bf16 v[40:43], v[72:75], v[144:147], v[40:43]
    ds_read_b64_tr_b16 v[88:89], v212 offset:36864
    s_lshl_b32 s50, s54, 12
    s_add_u32 s50, s50, s49
    s_add_u32 s54, s54, 1
    s_cmp_eq_u32 s54, 7
    s_cselect_b32 s54, 0, s54
    v_mfma_f32_16x16x32_bf16 v[56:59], v[72:75], v[148:151], v[56:59]
    ds_read_b64_tr_b16 v[90:91], v212 offset:38912
    s_waitcnt lgkmcnt(6)
    v_mfma_f32_16x16x32_bf16 v[44:47], v[76:79], v[144:147], v[44:47]
    ds_read_b64_tr_b16 v[92:93], v213 offset:36864
    buffer_load_dwordx4 v[176:179], v2, s[24:27], s50 offen offset:0
    v_mfma_f32_16x16x32_bf16 v[60:63], v[76:79], v[148:151], v[60:63]
    ds_read_b64_tr_b16 v[94:95], v213 offset:38912
    s_waitcnt vmcnt(14) lgkmcnt(6)
    v_mfma_f32_16x16x32_bf16 v[32:35], v[80:83], v[152:155], v[32:35]
    s_waitcnt vmcnt(13)
    v_mfma_f32_16x16x32_bf16 v[48:51], v[80:83], v[156:159], v[48:51]
    buffer_load_dwordx4 v[180:183], v2, s[24:27], s50 offen offset:256
    s_waitcnt lgkmcnt(4)
    v_mfma_f32_16x16x32_bf16 v[36:39], v[84:87], v[152:155], v[36:39]
    v_mfma_f32_16x16x32_bf16 v[52:55], v[84:87], v[156:159], v[52:55]
    s_waitcnt lgkmcnt(2)
    v_mfma_f32_16x16x32_bf16 v[40:43], v[88:91], v[152:155], v[40:43]
    v_mfma_f32_16x16x32_bf16 v[56:59], v[88:91], v[156:159], v[56:59]
    buffer_load_dwordx4 v[184:187], v2, s[24:27], s50 offen offset:2048
    s_waitcnt lgkmcnt(0)
    v_mfma_f32_16x16x32_bf16 v[44:47], v[92:95], v[152:155], v[44:47]
    v_mfma_f32_16x16x32_bf16 v[60:63], v[92:95], v[156:159], v[60:63]
    v_add_u32 v12, 65536, v12
    v_add_u32 v13, 65536, v13
    buffer_load_dwordx4 v[188:191], v2, s[24:27], s50 offen offset:2304
    v_add_u32 v212, 65536, v212
    v_add_u32 v213, 65536, v213
    s_waitcnt vmcnt(12)
    s_barrier
    ds_read_b64_tr_b16 v[64:65], v12 offset:0
    ds_read_b64_tr_b16 v[66:67], v12 offset:2048
    s_lshl_b32 s55, s54, 16
    s_add_u32 s55, s55, s45
    s_add_u32 m0, s46, 32768
    s_add_u32 s48, s55, 0
    buffer_load_dwordx4 v5, s[12:15], s48 offen lds
    ds_read_b64_tr_b16 v[68:69], v13 offset:0
    ds_read_b64_tr_b16 v[70:71], v13 offset:2048
    ds_read_b64_tr_b16 v[72:73], v212 offset:0
    ds_read_b64_tr_b16 v[74:75], v212 offset:2048
    s_add_u32 m0, s46, 34816
    s_add_u32 s48, s55, 4096
    buffer_load_dwordx4 v5, s[12:15], s48 offen lds
    ds_read_b64_tr_b16 v[76:77], v213 offset:0
    ds_read_b64_tr_b16 v[78:79], v213 offset:2048
    s_waitcnt vmcnt(13) lgkmcnt(6)
    v_mfma_f32_16x16x32_bf16 v[32:35], v[64:67], v[160:163], v[32:35]
    ds_read_b64_tr_b16 v[80:81], v12 offset:4096
    s_add_u32 m0, s46, 36864
    s_add_u32 s48, s55, 32768
    buffer_load_dwordx4 v5, s[12:15], s48 offen lds
    s_waitcnt vmcnt(13)
    v_mfma_f32_16x16x32_bf16 v[48:51], v[64:67], v[164:167], v[48:51]
    ds_read_b64_tr_b16 v[82:83], v12 offset:6144
    s_waitcnt lgkmcnt(6)
    v_mfma_f32_16x16x32_bf16 v[36:39], v[68:71], v[160:163], v[36:39]
    ds_read_b64_tr_b16 v[84:85], v13 offset:4096
    s_add_u32 m0, s46, 38912
    s_add_u32 s48, s55, 36864
    buffer_load_dwordx4 v5, s[12:15], s48 offen lds
    v_mfma_f32_16x16x32_bf16 v[52:55], v[68:71], v[164:167], v[52:55]
TP5:
    s_cbranch_execz K1_end
    ds_read_b64_tr_b16 v[86:87], v13 offset:6144
    s_waitcnt lgkmcnt(6)
    v_mfma_f32_16x16x32_bf16 v[40:43], v[72:75], v[160:163], v[40:43]
    ds_read_b64_tr_b16 v[88:89], v212 offset:4096
    s_lshl_b32 s50, s54, 12
    s_add_u32 s50, s50, s49
    s_add_u32 s54, s54, 1
    s_cmp_eq_u32 s54, 7
    s_cselect_b32 s54, 0, s54
    v_mfma_f32_16x16x32_bf16 v[56:59], v[72:75], v[164:167], v[56:59]
    ds_read_b64_tr_b16 v[90:91], v212 offset:6144
    s_waitcnt lgkmcnt(6)
    v_mfma_f32_16x16x32_bf16 v[44:47], v[76:79], v[160:163], v[44:47]
    ds_read_b64_tr_b16 v[92:93], v213 offset:4096
    buffer_load_dwordx4 v[192:195], v2, s[24:27], s50 offen offset:0
    v_mfma_f32_16x16x32_bf16 v[60:63], v[76:79], v[164:167], v[60:63]
    ds_read_b64_tr_b16 v[94:95], v213 offset:6144
    s_waitcnt vmcnt(14) lgkmcnt(6)
    v_mfma_f32_16x16x32_bf16 v[32:35], v[80:83], v[168:171], v[32:35]
    s_waitcnt vmcnt(13)
    v_mfma_f32_16x16x32_bf16 v[48:51], v[80:83], v[172:175], v[48:51]
    buffer_load_dwordx4 v[196:199], v2, s[24:27], s50 offen offset:256
    s_waitcnt lgkmcnt(4)
    v_mfma_f32_16x16x32_bf16 v[36:39], v[84:87], v[168:171], v[36:39]
    v_mfma_f32_16x16x32_bf16 v[52:55], v[84:87], v[172:175], v[52:55]
    s_waitcnt lgkmcnt(2)
    v_mfma_f32_16x16x32_bf16 v[40:43], v[88:91], v[168:171], v[40:43]
    v_mfma_f32_16x16x32_bf16 v[56:59], v[88:91], v[172:175], v[56:59]
    buffer_load_dwordx4 v[200:203], v2, s[24:27], s50 offen offset:2048
    s_waitcnt lgkmcnt(0)
    v_mfma_f32_16x16x32_bf16 v[44:47], v[92:95], v[168:171], v[44:47]
    v_mfma_f32_16x16x32_bf16 v[60:63], v[92:95], v[172:175], v[60:63]
    v_subrev_u32 v12, 131072, v12
    v_subrev_u32 v13, 131072, v13
    buffer_load_dwordx4 v[204:207], v2, s[24:27], s50 offen offset:2304
    v_subrev_u32 v212, 131072, v212
    v_subrev_u32 v213, 131072, v213
    s_waitcnt vmcnt(12)
    s_barrier
    ds_read_b64_tr_b16 v[64:65], v12 offset:0
    s_lshl_b32 s51, s40, 15
    ds_read_b64_tr_b16 v[66:67], v12 offset:2048
    ds_read_b64_tr_b16 v[68:69], v13 offset:0
    s_lshl_b32 s52, s36, 12
    ds_read_b64_tr_b16 v[70:71], v13 offset:2048
    s_add_u32 s51, s51, s52
    ds_read_b64_tr_b16 v[72:73], v212 offset:0
    ds_read_b64_tr_b16 v[74:75], v212 offset:2048
    v_lshrrev_b32 v7, 3, v1
    s_lshl_b32 s52, s39, 3
    v_add_u32 v9, s52, v7
    ds_read_b64_tr_b16 v[76:77], v213 offset:0
    ds_read_b64_tr_b16 v[78:79], v213 offset:2048
    v_and_b32 v8, 1, v1
    v_lshl_add_u32 v7, v8, 5, v9
    v_lshlrev_b32 v7, 4, v7
    s_waitcnt vmcnt(11) lgkmcnt(6)
    v_mfma_f32_16x16x32_bf16 v[32:35], v[64:67], v[176:179], v[32:35]
    ds_read_b64_tr_b16 v[80:81], v12 offset:4096
    v_bfe_u32 v8, v1, 1, 2
    v_lshl_add_u32 v14, v8, 10, v7
    s_waitcnt vmcnt(10)
    v_mfma_f32_16x16x32_bf16 v[48:51], v[64:67], v[180:183], v[48:51]
    ds_read_b64_tr_b16 v[82:83], v12 offset:6144
    s_add_u32 s52, s51, 0x1400000
    s_waitcnt lgkmcnt(6)
    v_mfma_f32_16x16x32_bf16 v[36:39], v[68:71], v[176:179], v[36:39]
    buffer_load_dwordx4 v[16:19], v14, s[24:27], s52 offen
    ds_read_b64_tr_b16 v[84:85], v13 offset:4096
    v_mfma_f32_16x16x32_bf16 v[52:55], v[68:71], v[180:183], v[52:55]
    s_add_u32 s52, s51, 0x1a00000
    ds_read_b64_tr_b16 v[86:87], v13 offset:6144
    s_waitcnt lgkmcnt(6)
    v_mfma_f32_16x16x32_bf16 v[40:43], v[72:75], v[176:179], v[40:43]
    buffer_load_dwordx4 v[20:23], v14, s[24:27], s52 offen
    ds_read_b64_tr_b16 v[88:89], v212 offset:4096
    v_mfma_f32_16x16x32_bf16 v[56:59], v[72:75], v[180:183], v[56:59]
    v_and_b32 v7, 7, v1
    ds_read_b64_tr_b16 v[90:91], v212 offset:6144
    v_lshlrev_b32 v8, 1, v7
    v_and_b32 v10, 15, v9
    v_xor_b32 v8, v8, v10
    s_waitcnt lgkmcnt(6)
    v_mfma_f32_16x16x32_bf16 v[44:47], v[76:79], v[176:179], v[44:47]
    ds_read_b64_tr_b16 v[92:93], v213 offset:4096
    s_lshl_b32 s52, s38, 13
    s_add_u32 s52, s52, 65536
    v_lshl_add_u32 v9, v9, 8, s52
    v_lshl_add_u32 v15, v8, 4, v9
    v_xor_b32 v3, 16, v15
    v_mfma_f32_16x16x32_bf16 v[60:63], v[76:79], v[180:183], v[60:63]
    ds_read_b64_tr_b16 v[94:95], v213 offset:6144
    v_lshlrev_b32 v7, 5, v7
    s_waitcnt vmcnt(11) lgkmcnt(6)
    v_mfma_f32_16x16x32_bf16 v[32:35], v[80:83], v[184:187], v[32:35]
    s_waitcnt vmcnt(10)
    v_mfma_f32_16x16x32_bf16 v[48:51], v[80:83], v[188:191], v[48:51]
    s_lshl_b32 s52, s36, 8
    s_waitcnt lgkmcnt(4)
    v_mfma_f32_16x16x32_bf16 v[36:39], v[84:87], v[184:187], v[36:39]
    v_mfma_f32_16x16x32_bf16 v[52:55], v[84:87], v[188:191], v[52:55]
    s_add_u32 s52, s52, 0x201800
    s_waitcnt lgkmcnt(2)
    v_mfma_f32_16x16x32_bf16 v[40:43], v[88:91], v[184:187], v[40:43]
    buffer_load_dwordx4 v[24:27], v7, s[24:27], s52 offen
    v_mfma_f32_16x16x32_bf16 v[56:59], v[88:91], v[188:191], v[56:59]
    s_waitcnt lgkmcnt(0)
    v_mfma_f32_16x16x32_bf16 v[44:47], v[92:95], v[184:187], v[44:47]
    buffer_load_dwordx4 v[28:31], v7, s[24:27], s52 offen offset:16
    v_mfma_f32_16x16x32_bf16 v[60:63], v[92:95], v[188:191], v[60:63]
    s_waitcnt vmcnt(8)
    s_barrier
    ds_read_b64_tr_b16 v[64:65], v12 offset:32768
    ds_read_b64_tr_b16 v[66:67], v12 offset:34816
    ds_read_b64_tr_b16 v[68:69], v13 offset:32768
    ds_read_b64_tr_b16 v[70:71], v13 offset:34816
    ds_read_b64_tr_b16 v[72:73], v212 offset:32768
    ds_read_b64_tr_b16 v[74:75], v212 offset:34816
    ds_read_b64_tr_b16 v[76:77], v213 offset:32768
    ds_read_b64_tr_b16 v[78:79], v213 offset:34816
    s_waitcnt vmcnt(7) lgkmcnt(6)
    v_mfma_f32_16x16x32_bf16 v[32:35], v[64:67], v[192:195], v[32:35]
    ds_read_b64_tr_b16 v[80:81], v12 offset:36864
    s_waitcnt vmcnt(6)
    v_mfma_f32_16x16x32_bf16 v[48:51], v[64:67], v[196:199], v[48:51]
    ds_read_b64_tr_b16 v[82:83], v12 offset:38912
    s_waitcnt lgkmcnt(6)
    v_mfma_f32_16x16x32_bf16 v[36:39], v[68:71], v[192:195], v[36:39]
    ds_read_b64_tr_b16 v[84:85], v13 offset:36864
    v_mfma_f32_16x16x32_bf16 v[52:55], v[68:71], v[196:199], v[52:55]
    ds_read_b64_tr_b16 v[86:87], v13 offset:38912
    s_waitcnt lgkmcnt(6)
    v_mfma_f32_16x16x32_bf16 v[40:43], v[72:75], v[192:195], v[40:43]
    ds_read_b64_tr_b16 v[88:89], v212 offset:36864
    v_mfma_f32_16x16x32_bf16 v[56:59], v[72:75], v[196:199], v[56:59]
    ds_read_b64_tr_b16 v[90:91], v212 offset:38912
    s_waitcnt lgkmcnt(6)
    v_mfma_f32_16x16x32_bf16 v[44:47], v[76:79], v[192:195], v[44:47]
    ds_read_b64_tr_b16 v[92:93], v213 offset:36864
    v_mfma_f32_16x16x32_bf16 v[60:63], v[76:79], v[196:199], v[60:63]
    ds_read_b64_tr_b16 v[94:95], v213 offset:38912
    s_waitcnt vmcnt(5) lgkmcnt(6)
    v_mfma_f32_16x16x32_bf16 v[32:35], v[80:83], v[200:203], v[32:35]
    s_waitcnt vmcnt(4)
    v_mfma_f32_16x16x32_bf16 v[48:51], v[80:83], v[204:207], v[48:51]
    s_waitcnt lgkmcnt(4)
    v_mfma_f32_16x16x32_bf16 v[36:39], v[84:87], v[200:203], v[36:39]
    s_nop 3
    ds_write_b128 v214, v[32:35] offset:0
    v_mfma_f32_16x16x32_bf16 v[52:55], v[84:87], v[204:207], v[52:55]
    ds_write_b128 v214, v[48:51] offset:4096
    s_waitcnt lgkmcnt(4)
    v_mfma_f32_16x16x32_bf16 v[40:43], v[88:91], v[200:203], v[40:43]
    ds_write_b128 v215, v[36:39] offset:0
    v_mfma_f32_16x16x32_bf16 v[56:59], v[88:91], v[204:207], v[56:59]
    s_nop 2
    ds_write_b128 v215, v[52:55] offset:4096
    s_waitcnt lgkmcnt(4)
    v_mfma_f32_16x16x32_bf16 v[44:47], v[92:95], v[200:203], v[44:47]
    ds_write_b128 v216, v[40:43] offset:0
    v_mfma_f32_16x16x32_bf16 v[60:63], v[92:95], v[204:207], v[60:63]
    ds_write_b128 v216, v[56:59] offset:4096
    s_nop 4
    ds_write_b128 v217, v[44:47] offset:0
    s_nop 0
    ds_write_b128 v217, v[60:63] offset:4096
    s_mov_b32 s52, 0xffff0000
    s_waitcnt vmcnt(2)
    v_lshlrev_b32 v96, 16, v20
    v_lshlrev_b32 v104, 16, v16
    v_and_b32 v97, s52, v20
    v_and_b32 v105, s52, v16
    v_lshlrev_b32 v98, 16, v21
    v_lshlrev_b32 v106, 16, v17
    v_and_b32 v99, s52, v21
    v_and_b32 v107, s52, v17
    v_lshlrev_b32 v100, 16, v22
    v_lshlrev_b32 v108, 16, v18
    v_and_b32 v101, s52, v22
    v_and_b32 v109, s52, v18
    v_lshlrev_b32 v102, 16, v23
    v_lshlrev_b32 v110, 16, v19
    v_and_b32 v103, s52, v23
    v_and_b32 v111, s52, v19
    v_lshrrev_b32 v5, 3, v1
    v_lshlrev_b32 v5, 10, v5
    v_and_b32 v6, 7, v1
    v_lshl_add_u32 v5, v6, 4, v5
    s_lshl_b32 s50, s40, 15
    s_lshl_b32 s51, s36, 7
    s_add_u32 s50, s50, s51
    s_lshl_b32 s51, s39, 13
    s_add_u32 s50, s50, s51
    s_waitcnt lgkmcnt(0)
    s_barrier
    ds_read_b128 v[64:67], v15 offset:0
    ds_read_b128 v[68:71], v3 offset:0
    ds_read_b128 v[72:75], v15 offset:16384
    ds_read_b128 v[76:79], v3 offset:16384
    ds_read_b128 v[80:83], v15 offset:32768
    ds_read_b128 v[84:87], v3 offset:32768
    ds_read_b128 v[88:91], v15 offset:49152
    ds_read_b128 v[92:95], v3 offset:49152
    s_waitcnt lgkmcnt(5)
    v_pk_add_f32 v[64:65], v[64:65], v[72:73]
    v_pk_add_f32 v[66:67], v[66:67], v[74:75]
    s_waitcnt lgkmcnt(4)
    v_pk_add_f32 v[68:69], v[68:69], v[76:77]
    v_pk_add_f32 v[70:71], v[70:71], v[78:79]
    s_waitcnt lgkmcnt(1)
    v_pk_add_f32 v[80:81], v[80:81], v[88:89]
    v_pk_add_f32 v[82:83], v[82:83], v[90:91]
    s_waitcnt lgkmcnt(0)
    v_pk_add_f32 v[84:85], v[84:85], v[92:93]
    v_pk_add_f32 v[86:87], v[86:87], v[94:95]
    v_pk_add_f32 v[64:65], v[64:65], v[80:81]
    v_pk_add_f32 v[66:67], v[66:67], v[82:83]
    v_pk_add_f32 v[68:69], v[68:69], v[84:85]
    v_pk_add_f32 v[70:71], v[70:71], v[86:87]
    v_pk_add_f32 v[64:65], v[64:65], v[96:97]
    v_pk_add_f32 v[66:67], v[66:67], v[98:99]
    v_pk_add_f32 v[68:69], v[68:69], v[100:101]
    v_pk_add_f32 v[70:71], v[70:71], v[102:103]
    s_waitcnt vmcnt(1)
    v_pk_fma_f32 v[64:65], v[64:65], v[24:25], v[104:105]
    v_pk_fma_f32 v[66:67], v[66:67], v[26:27], v[106:107]
    s_waitcnt vmcnt(0)
    v_pk_fma_f32 v[68:69], v[68:69], v[28:29], v[108:109]
    v_pk_fma_f32 v[70:71], v[70:71], v[30:31], v[110:111]
    v_cvt_pk_bf16_f32 v32, v64, v65
    v_cvt_pk_bf16_f32 v33, v66, v67
    v_cvt_pk_bf16_f32 v34, v68, v69
    v_cvt_pk_bf16_f32 v35, v70, v71
    buffer_store_dwordx4 v[32:35], v5, s[8:11], s50 offen sc0 sc1
K5_end:
    s_endpgm
K1_fb:
    s_nop 15
    s_nop 15
    v_lshrrev_b32 v17, 4, v27
    v_and_b32 v18, 31, v17
    v_lshlrev_b32 v18, 8, v18
    v_lshrrev_b32 v17, 5, v17
    v_lshl_add_u32 v18, v17, 4, v18
    s_lshl_b32 s40, s28, 7
    v_add_u32 v10, s40, v18
    v_xor_b32 v11, 0x80, v10
    v_mov_b32 v12, 0xff800000
    s_sub_u32 s41, s31, s29
    s_mov_b32 s40, 0
K1_fb1:
    buffer_load_dwordx4 v[96:99], v10, s[4:7], s41 offen offset:0
    buffer_load_dwordx4 v[100:103], v10, s[4:7], s41 offen offset:32
    buffer_load_dwordx4 v[104:107], v10, s[4:7], s41 offen offset:64
    buffer_load_dwordx4 v[108:111], v10, s[4:7], s41 offen offset:96
    buffer_load_dwordx4 v[112:115], v11, s[4:7], s41 offen offset:0
    buffer_load_dwordx4 v[116:119], v11, s[4:7], s41 offen offset:32
    buffer_load_dwordx4 v[120:123], v11, s[4:7], s41 offen offset:64
    buffer_load_dwordx4 v[124:127], v11, s[4:7], s41 offen offset:96
    s_waitcnt vmcnt(0)
    v_mfma_f32_32x32x16_bf16 v[64:79], v[96:99], v[32:35], 0
    v_mfma_f32_32x32x16_bf16 v[64:79], v[100:103], v[36:39], v[64:79]
    v_mfma_f32_32x32x16_bf16 v[64:79], v[104:107], v[40:43], v[64:79]
    v_mfma_f32_32x32x16_bf16 v[64:79], v[108:111], v[44:47], v[64:79]
    v_mfma_f32_32x32x16_bf16 v[64:79], v[112:115], v[48:51], v[64:79]
    v_mfma_f32_32x32x16_bf16 v[64:79], v[116:119], v[52:55], v[64:79]
    v_mfma_f32_32x32x16_bf16 v[64:79], v[120:123], v[56:59], v[64:79]
    v_mfma_f32_32x32x16_bf16 v[64:79], v[124:127], v[60:63], v[64:79]
    s_nop 11
    v_max3_f32 v12, v64, v65, v12
    v_max3_f32 v12, v66, v67, v12
    v_max3_f32 v12, v68, v69, v12
    v_max3_f32 v12, v70, v71, v12
    v_max3_f32 v12, v72, v73, v12
    v_max3_f32 v12, v74, v75, v12
    v_max3_f32 v12, v76, v77, v12
    v_max3_f32 v12, v78, v79, v12
    s_add_u32 s41, s41, 8192
    s_add_u32 s40, s40, 1
    s_cmp_lt_u32 s40, 16
    s_nop 7
    s_cbranch_scc1 K1_fb1
    v_mov_b32 v18, v12
    s_nop 1
    v_permlane32_swap_b32 v12, v18
    v_max_f32 v12, v12, v18
    v_mul_f32 v22, s51, v12
    v_sub_f32 v22, 0, v22
    v_mov_b32 v160, 0
    v_mov_b32 v161, 0
    v_mov_b32 v162, 0
    v_mov_b32 v163, 0
    v_mov_b32 v164, 0
    v_mov_b32 v165, 0
    v_mov_b32 v166, 0
    v_mov_b32 v167, 0
    v_mov_b32 v168, 0
    v_mov_b32 v169, 0
    v_mov_b32 v170, 0
    v_mov_b32 v171, 0
    v_mov_b32 v172, 0
    v_mov_b32 v173, 0
    v_mov_b32 v174, 0
    v_mov_b32 v175, 0
    v_mov_b32 v176, 0
    v_mov_b32 v177, 0
    v_mov_b32 v178, 0
    v_mov_b32 v179, 0
    v_mov_b32 v180, 0
    v_mov_b32 v181, 0
    v_mov_b32 v182, 0
    v_mov_b32 v183, 0
    v_mov_b32 v184, 0
    v_mov_b32 v185, 0
    v_mov_b32 v186, 0
    v_mov_b32 v187, 0
    v_mov_b32 v188, 0
    v_mov_b32 v189, 0
    v_mov_b32 v190, 0
    v_mov_b32 v191, 0
    v_mov_b32 v192, 0
    v_mov_b32 v193, 0
    v_mov_b32 v194, 0
    v_mov_b32 v195, 0
    v_mov_b32 v196, 0
    v_mov_b32 v197, 0
    v_mov_b32 v198, 0
    v_mov_b32 v199, 0
    v_mov_b32 v200, 0
    v_mov_b32 v201, 0
    v_mov_b32 v202, 0
    v_mov_b32 v203, 0
    v_mov_b32 v204, 0
    v_mov_b32 v205, 0
    v_mov_b32 v206, 0
    v_mov_b32 v207, 0
    v_mov_b32 v208, 0
    v_mov_b32 v209, 0
    v_mov_b32 v210, 0
    v_mov_b32 v211, 0
    v_mov_b32 v212, 0
    v_mov_b32 v213, 0
    v_mov_b32 v214, 0
    v_mov_b32 v215, 0
    v_mov_b32 v216, 0
    v_mov_b32 v217, 0
    v_mov_b32 v218, 0
    v_mov_b32 v219, 0
    v_mov_b32 v220, 0
    v_mov_b32 v221, 0
    v_mov_b32 v222, 0
    v_mov_b32 v223, 0
    v_mov_b32 v23, 0
    v_mov_b32 v24, 0
    v_mov_b32 v25, 0
    v_mov_b32 v26, 0
    s_sub_u32 s41, s31, s29
    s_sub_u32 s42, s33, s29
    s_mov_b32 s40, 0
K1_fb2:
    buffer_load_dwordx4 v[96:99], v10, s[4:7], s41 offen offset:0
    buffer_load_dwordx4 v[100:103], v10, s[4:7], s41 offen offset:32
    buffer_load_dwordx4 v[104:107], v10, s[4:7], s41 offen offset:64
    buffer_load_dwordx4 v[108:111], v10, s[4:7], s41 offen offset:96
    buffer_load_dwordx4 v[112:115], v11, s[4:7], s41 offen offset:0
    buffer_load_dwordx4 v[116:119], v11, s[4:7], s41 offen offset:32
    buffer_load_dwordx4 v[120:123], v11, s[4:7], s41 offen offset:64
    buffer_load_dwordx4 v[124:127], v11, s[4:7], s41 offen offset:96
    s_add_u32 s43, s42, 4096
    buffer_load_dwordx4 v[128:131], v27, s[16:19], s42 offen offset:0
    buffer_load_dwordx4 v[132:135], v27, s[16:19], s42 offen offset:1024
    buffer_load_dwordx4 v[136:139], v27, s[16:19], s42 offen offset:2048
    buffer_load_dwordx4 v[140:143], v27, s[16:19], s42 offen offset:3072
    buffer_load_dwordx4 v[144:147], v27, s[16:19], s43 offen offset:0
    buffer_load_dwordx4 v[148:151], v27, s[16:19], s43 offen offset:1024
    buffer_load_dwordx4 v[152:155], v27, s[16:19], s43 offen offset:2048
    buffer_load_dwordx4 v[156:159], v27, s[16:19], s43 offen offset:3072
    s_waitcnt vmcnt(0)
    v_mfma_f32_32x32x16_bf16 v[64:79], v[96:99], v[32:35], 0
    v_mfma_f32_32x32x16_bf16 v[64:79], v[100:103], v[36:39], v[64:79]
    v_mfma_f32_32x32x16_bf16 v[64:79], v[104:107], v[40:43], v[64:79]
    v_mfma_f32_32x32x16_bf16 v[64:79], v[108:111], v[44:47], v[64:79]
    v_mfma_f32_32x32x16_bf16 v[64:79], v[112:115], v[48:51], v[64:79]
    v_mfma_f32_32x32x16_bf16 v[64:79], v[116:119], v[52:55], v[64:79]
    v_mfma_f32_32x32x16_bf16 v[64:79], v[120:123], v[56:59], v[64:79]
    v_mfma_f32_32x32x16_bf16 v[64:79], v[124:127], v[60:63], v[64:79]
    s_nop 11
    v_fma_f32 v64, v64, s51, v22
    v_fma_f32 v65, v65, s51, v22
    v_fma_f32 v66, v66, s51, v22
    v_fma_f32 v67, v67, s51, v22
    v_fma_f32 v68, v68, s51, v22
    v_fma_f32 v69, v69, s51, v22
    v_fma_f32 v70, v70, s51, v22
    v_fma_f32 v71, v71, s51, v22
    v_exp_f32 v64, v64
    v_exp_f32 v65, v65
    v_exp_f32 v66, v66
    v_exp_f32 v67, v67
    v_exp_f32 v68, v68
    v_exp_f32 v69, v69
    v_exp_f32 v70, v70
    v_exp_f32 v71, v71
    v_add_f32 v23, v23, v64
    v_add_f32 v23, v23, v65
    v_cvt_pk_bf16_f32 v64, v64, v65
    v_add_f32 v24, v24, v66
    v_add_f32 v24, v24, v67
    v_cvt_pk_bf16_f32 v65, v66, v67
    v_add_f32 v25, v25, v68
    v_add_f32 v25, v25, v69
    v_cvt_pk_bf16_f32 v66, v68, v69
    v_add_f32 v26, v26, v70
    v_add_f32 v26, v26, v71
    v_cvt_pk_bf16_f32 v67, v70, v71
    v_fma_f32 v72, v72, s51, v22
    v_fma_f32 v73, v73, s51, v22
    v_fma_f32 v74, v74, s51, v22
    v_fma_f32 v75, v75, s51, v22
    v_fma_f32 v76, v76, s51, v22
    v_fma_f32 v77, v77, s51, v22
    v_fma_f32 v78, v78, s51, v22
    v_fma_f32 v79, v79, s51, v22
    v_exp_f32 v72, v72
    v_exp_f32 v73, v73
    v_exp_f32 v74, v74
    v_exp_f32 v75, v75
    v_exp_f32 v76, v76
    v_exp_f32 v77, v77
    v_exp_f32 v78, v78
    v_exp_f32 v79, v79
    v_add_f32 v23, v23, v72
    v_add_f32 v23, v23, v73
    v_cvt_pk_bf16_f32 v72, v72, v73
    v_add_f32 v24, v24, v74
    v_add_f32 v24, v24, v75
    v_cvt_pk_bf16_f32 v73, v74, v75
    v_add_f32 v25, v25, v76
    v_add_f32 v25, v25, v77
    v_cvt_pk_bf16_f32 v74, v76, v77
    v_add_f32 v26, v26, v78
    v_add_f32 v26, v26, v79
    v_cvt_pk_bf16_f32 v75, v78, v79
    v_mfma_f32_32x32x16_bf16 v[160:175], v[128:131], v[64:67], v[160:175]
    v_mfma_f32_32x32x16_bf16 v[176:191], v[132:135], v[64:67], v[176:191]
    v_mfma_f32_32x32x16_bf16 v[192:207], v[136:139], v[64:67], v[192:207]
    v_mfma_f32_32x32x16_bf16 v[208:223], v[140:143], v[64:67], v[208:223]
    v_mfma_f32_32x32x16_bf16 v[160:175], v[144:147], v[72:75], v[160:175]
    v_mfma_f32_32x32x16_bf16 v[176:191], v[148:151], v[72:75], v[176:191]
    v_mfma_f32_32x32x16_bf16 v[192:207], v[152:155], v[72:75], v[192:207]
    v_mfma_f32_32x32x16_bf16 v[208:223], v[156:159], v[72:75], v[208:223]
    s_add_u32 s41, s41, 8192
    s_add_u32 s42, s42, 8192
    s_add_u32 s40, s40, 1
    s_cmp_lt_u32 s40, 16
    s_nop 15
    s_nop 15
    s_cbranch_scc1 K1_fb2
    v_add_f32 v23, v23, v24
    v_add_f32 v25, v25, v26
    v_add_f32 v23, v23, v25
    v_mov_b32 v24, v23
    s_nop 1
    v_permlane32_swap_b32 v23, v24
    v_add_f32 v24, v23, v24
    v_rcp_f32 v23, v24
    s_nop 15
    s_nop 15
    s_branch K1_fbr
CODE_END:
    s_endpgm
.section .rodata,"a"
.p2align 6
.amdhsa_kernel k0_kernel
  .amdhsa_next_free_vgpr 128
  .amdhsa_next_free_sgpr 96
  .amdhsa_accum_offset 128
  .amdhsa_group_segment_fixed_size 0
  .amdhsa_kernarg_size 120
  .amdhsa_user_sgpr_count 2
  .amdhsa_user_sgpr_kernarg_segment_ptr 1
  .amdhsa_system_sgpr_workgroup_id_x 1
  .amdhsa_float_denorm_mode_32 3
.end_amdhsa_kernel
.p2align 6
.amdhsa_kernel k1_kernel
  .amdhsa_next_free_vgpr 256
  .amdhsa_next_free_sgpr 102
  .amdhsa_accum_offset 256
  .amdhsa_group_segment_fixed_size 0
  .amdhsa_kernarg_size 120
  .amdhsa_user_sgpr_count 2
  .amdhsa_user_sgpr_kernarg_segment_ptr 1
  .amdhsa_system_sgpr_workgroup_id_x 1
  .amdhsa_float_denorm_mode_32 3
.end_amdhsa_kernel
.p2align 6
.amdhsa_kernel k2_kernel
  .amdhsa_next_free_vgpr 256
  .amdhsa_next_free_sgpr 96
  .amdhsa_accum_offset 128
  .amdhsa_group_segment_fixed_size 0
  .amdhsa_kernarg_size 120
  .amdhsa_user_sgpr_count 2
  .amdhsa_user_sgpr_kernarg_segment_ptr 1
  .amdhsa_system_sgpr_workgroup_id_x 1
  .amdhsa_float_denorm_mode_32 3
.end_amdhsa_kernel
.p2align 6
.amdhsa_kernel k3_kernel
  .amdhsa_next_free_vgpr 160
  .amdhsa_next_free_sgpr 96
  .amdhsa_accum_offset 160
  .amdhsa_group_segment_fixed_size 0
  .amdhsa_kernarg_size 120
  .amdhsa_user_sgpr_count 2
  .amdhsa_user_sgpr_kernarg_segment_ptr 1
  .amdhsa_system_sgpr_workgroup_id_x 1
  .amdhsa_float_denorm_mode_32 3
.end_amdhsa_kernel
.p2align 6
.amdhsa_kernel k4_kernel
  .amdhsa_next_free_vgpr 256
  .amdhsa_next_free_sgpr 96
  .amdhsa_accum_offset 128
  .amdhsa_group_segment_fixed_size 0
  .amdhsa_kernarg_size 120
  .amdhsa_user_sgpr_count 2
  .amdhsa_user_sgpr_kernarg_segment_ptr 1
  .amdhsa_system_sgpr_workgroup_id_x 1
  .amdhsa_float_denorm_mode_32 3
.end_amdhsa_kernel
.p2align 6
.amdhsa_kernel k5_kernel
  .amdhsa_next_free_vgpr 224
  .amdhsa_next_free_sgpr 96
  .amdhsa_accum_offset 224
  .amdhsa_group_segment_fixed_size 0
  .amdhsa_kernarg_size 120
  .amdhsa_user_sgpr_count 2
  .amdhsa_user_sgpr_kernarg_segment_ptr 1
  .amdhsa_system_sgpr_workgroup_id_x 1
  .amdhsa_float_denorm_mode_32 3
.end_amdhsa_kernel
```
